```python
import torch

def _softmax(x, axis=-1):
    return torch.softmax(x, dim=axis)

def _gelu(x):
    return torch.nn.functional.gelu(x, approximate='tanh')

def _silu(x):
    return torch.nn.functional.silu(x)

def _sigmoid(x):
    return torch.sigmoid(x)

def _layernorm(x, axis=-1, eps=1e-05):
    m = x.mean(dim=axis, keepdim=True)
    v = x.var(dim=axis, keepdim=True, unbiased=False)
    return (x - m) / torch.sqrt(v + eps)

def _scatter_add(tgt, idx, src, axis=0):
    return tgt.clone().index_add_(axis, idx, src)

def _segment_sum(src, seg, n):
    out = torch.zeros((n,) + src.shape[1:], dtype=src.dtype)
    return out.index_add_(0, seg, src)

def _pad(x, pw):
    flat = tuple((v for pair in reversed(pw) for v in pair))
    return torch.nn.functional.pad(x, flat)
kernel_name = 'adaLN_cond__ssm_conv_s4d__glu_gated_glu__prompt'

def setup_inputs():

    _w = lambda a: (lambda t: t.to(torch.bfloat16) if t.is_floating_point() else t)(torch.as_tensor(a))

    def _A_setup():
        Bsz, L, D, N = (1, 2048, 512, 128)
        return {'u': _w((lambda *s: torch.randn(*s, dtype=torch.bfloat16) * 0.05)(Bsz, L, D)), 'log_A_real': _w((lambda *s: torch.randn(*s, dtype=torch.bfloat16) * 3.2)(D, N) * 0.5), 'A_imag': _w((lambda *s: torch.randn(*s, dtype=torch.bfloat16) * 0.1)(D, N) * 3.14), 'C_real': _w((lambda *s: torch.randn(*s, dtype=torch.bfloat16) * 0.8)(D, N) / N ** 0.5), 'C_imag': _w((lambda *s: torch.randn(*s, dtype=torch.bfloat16) * 0.8)(D, N) / N ** 0.5), 'log_dt': _w((lambda *s: torch.randn(*s, dtype=torch.bfloat16) * 0.1)(D) * 0.5 - 4.0), 'D_skip': _w((lambda *s: torch.randn(*s, dtype=torch.bfloat16) * 0.1)(D))}
    _A_in = _A_setup()

    def _B_setup():
        B, S, D, F = (1, 2048, 512, 1376)
        return {'x': _w((lambda *s: torch.randn(*s, dtype=torch.bfloat16) * 0.05)(B, S, D)), 'w_gate': _w((lambda *s: torch.randn(*s, dtype=torch.bfloat16) * 0.1)(D, F)), 'w_up': _w((lambda *s: torch.randn(*s, dtype=torch.bfloat16) * 0.05)(D, F)), 'w_down': _w((lambda *s: torch.randn(*s, dtype=torch.bfloat16) * 0.05)(F, D))}
    _B_in = _B_setup()
    return {'A_u': _A_in['u'], 'A_log_A_real': _A_in['log_A_real'], 'A_A_imag': _A_in['A_imag'], 'A_C_real': _A_in['C_real'], 'A_C_imag': _A_in['C_imag'], 'A_log_dt': _A_in['log_dt'], 'A_D_skip': _A_in['D_skip'], 'B_x': _B_in['x'], 'B_w_gate': _B_in['w_gate'], 'B_w_up': _B_in['w_up'], 'B_w_down': _B_in['w_down'], 'c': _w((lambda *s: torch.randn(*s, dtype=torch.bfloat16) * 0.4)(1, 512) * 8.0), 'w_mod': _w((lambda *s: torch.randn(*s, dtype=torch.bfloat16) * 0.4)(512, 6 * 512) * 512 ** (-0.5) * 8.0)}

def reference(A_u, A_log_A_real, A_A_imag, A_C_real, A_C_imag, A_log_dt, A_D_skip, B_x, B_w_gate, B_w_up, B_w_down, c, w_mod):

    def _A_ref(u, log_A_real, A_imag, C_real, C_imag, log_dt, D_skip):
        L = u.shape[1]
        dt = torch.exp(log_dt)
        A = -torch.exp(log_A_real) + 1j * A_imag
        C = (C_real + 1j * C_imag) * dt[:, None]
        pos = (lambda x, dt: x.to(dt))(torch.arange(L), log_dt.dtype)
        P = torch.exp((A * dt[:, None])[:, :, None] * pos[None, None, :])
        K = 2.0 * torch.einsum('dn,dnl->dl', C, P).real
        L2 = 2 * L
        u_t = (lambda x, *d: x.permute(*d))(u, 0, 2, 1)
        Kf = (lambda x, *a, **k: torch.fft.rfft(x.float(), *a, **k))(K, L2)
        Uf = (lambda x, *a, **k: torch.fft.rfft(x.float(), *a, **k))(u_t, L2)
        y = (lambda x, *a, **k: torch.fft.irfft(x, *a, **k).to(torch.bfloat16))(Uf * Kf[None, :, :], L2)[:, :, :L]
        y = (lambda x, *d: x.permute(*d))(y, 0, 2, 1)
        return y + u * D_skip[None, None, :]

    def _B_ref(x, w_gate, w_up, w_down):
        g = torch.einsum('bsd,df->bsf', x, w_gate)
        u = torch.einsum('bsd,df->bsf', x, w_up)
        h = _sigmoid(g) * u
        return torch.einsum('bsf,fd->bsd', h, w_down)
    x = A_u
    mod = (_silu(c) @ w_mod).reshape(c.shape[0], 6, 1, -1)
    sa, ca, ga, sb, cb, gb = (mod[:, 0].clone(), mod[:, 1].clone(), mod[:, 2].clone(), mod[:, 3].clone(), mod[:, 4].clone(), mod[:, 5].clone())
    h = _layernorm(x, axis=-1) * (1 + ca) + sa
    x = x + ga * _A_ref(h, A_log_A_real, A_A_imag, A_C_real, A_C_imag, A_log_dt, A_D_skip)
    h = _layernorm(x, axis=-1) * (1 + cb) + sb
    x = x + gb * _B_ref(h, B_w_gate, B_w_up, B_w_down)
    return x
```

```asm
; @launch grid=(256,1,1) block=(256,1,1) lds=163840
.amdgcn_target "amdgcn-amd-amdhsa--gfx950"
.text
.globl adaLN_cond__ssm_conv_s4d__glu_gated_glu__prompt_kernel
.p2align 12
.p2align 8
.type adaLN_cond__ssm_conv_s4d__glu_gated_glu__prompt_kernel,@function
adaLN_cond__ssm_conv_s4d__glu_gated_glu__prompt_kernel:
s_cmp_ge_u32 s2, 256
s_cbranch_scc1 L_end
s_load_dwordx2 s[8:9], s[0:1], 0
s_load_dwordx2 s[4:5], s[0:1], 120
s_load_dwordx8 s[36:43], s[0:1], 8
s_load_dwordx4 s[44:47], s[0:1], 40
s_load_dwordx2 s[48:49], s[0:1], 88
s_load_dwordx2 s[24:25], s[0:1], 96
s_lshr_b32 s52, s2, 3
v_lshrrev_b32 v5, 6, v0
v_and_b32 v1, 63, v0
s_getpc_b64 s[94:95]
L_pc:
v_lshl_add_u32 v14, v1, 2, v5
v_lshl_add_u32 v14, v14, 5, s52
v_lshlrev_b32 v14, 7, v14
v_min_u32 v14, L_last-L_pc, v14
s_mov_b64 exec, 15
global_load_dword v31, v14, s[94:95]
s_mov_b64 exec, -1
v_readfirstlane_b32 s33, v5
v_lshlrev_b32 v2, 4, v1
s_mov_b32 s6, 268435456
s_mov_b32 s7, 0x20000
s_mov_b32 s10, 2097152
s_mov_b32 s11, 0x20000
s_mov_b32 s26, 3145728
s_mov_b32 s27, 0x20000
s_and_b32 s51, s2, 7
s_lshl_b32 s34, s52, 4
s_add_u32 s34, s34, s51
s_lshl_b32 s100, s51, 5
s_add_u32 s100, s100, s52
s_cmp_eq_u32 s33, 1
s_cbranch_scc1 L_w1
s_cmp_ge_u32 s33, 2
s_cbranch_scc1 L_kgen
s_lshl_b32 s53, s100, 13
s_add_u32 s54, s53, 4096
v_mov_b32 v8, 131072
v_mov_b32_e64 v12, 0
v_mov_b32_e64 v13, 0
v_mov_b32_e64 v14, 0
v_mov_b32 v15, 0
ds_write_b128 v8, v[12:15]
s_waitcnt lgkmcnt(0)
buffer_load_dword v30, off, s[4:7], 0 offset:0 sc1
buffer_load_dwordx4 v[32:35], v2, s[8:11], s53 offen offset:0
buffer_load_dwordx4 v[36:39], v2, s[8:11], s53 offen offset:1024
buffer_load_dwordx4 v[40:43], v2, s[8:11], s53 offen offset:2048
buffer_load_dwordx4 v[44:47], v2, s[8:11], s53 offen offset:3072
buffer_load_dwordx4 v[48:51], v2, s[8:11], s54 offen offset:0
buffer_load_dwordx4 v[52:55], v2, s[8:11], s54 offen offset:1024
buffer_load_dwordx4 v[56:59], v2, s[8:11], s54 offen offset:2048
buffer_load_dwordx4 v[60:63], v2, s[8:11], s54 offen offset:3072
s_barrier
s_branch L_common
s_nop 0
L_kgen:
s_sub_u32 s53, s33, 2
s_lshl_b32 s54, s53, 3
s_add_u32 s54, s54, s34
s_lshl_b32 s55, s54, 8
v_lshl_add_u32 v6, v1, 2, s55
s_lshl_b32 s55, s54, 1
v_mov_b32 v7, s55
s_waitcnt lgkmcnt(0)
global_load_ushort v12, v7, s[44:45]
global_load_dword v8, v6, s[36:37]
global_load_dword v9, v6, s[38:39]
global_load_dword v10, v6, s[40:41]
global_load_dword v11, v6, s[42:43]
global_load_ushort v13, v7, s[46:47]
s_barrier
s_branch L_common
s_nop 0
L_w1:
s_and_b32 s53, s2, 3
s_lshl_b32 s54, s53, 8
v_lshl_add_u32 v7, v1, 2, s54
v_lshrrev_b32 v8, 3, v1
v_mul_u32_u24 v8, 6144, v8
v_and_b32 v9, 7, v1
v_lshl_add_u32 v8, v9, 4, v8
s_cmp_lt_u32 s2, 192
s_cselect_b32 s59, 0, 1073741824
v_add_u32_e64 v8, s59, v8
s_mul_i32 s54, s53, 786432
s_lshr_b32 s55, s2, 2
s_lshl_b32 s56, s55, 7
s_add_u32 s54, s54, s56
s_mov_b32 m0, 139264
s_waitcnt lgkmcnt(0)
global_load_dword v6, v7, s[48:49]
buffer_load_dword v30, off, s[4:7], 0 offset:0 sc1
s_barrier
L_wmloop:
buffer_load_dwordx4 v8, s[24:27], s54 offen lds
s_add_u32 s54, s54, 49152
s_add_u32 m0, m0, 1024
s_cmp_lt_u32 m0, 155648
s_cbranch_scc1 L_wmloop
L_common:
s_load_dwordx2 s[12:13], s[0:1], 64
s_load_dwordx2 s[16:17], s[0:1], 72
s_load_dwordx2 s[20:21], s[0:1], 80
s_load_dwordx2 s[28:29], s[0:1], 104
s_mov_b32 s14, 1409024
s_mov_b32 s15, 0x20000
s_mov_b32 s18, 1409024
s_mov_b32 s19, 0x20000
s_mov_b32 s22, 1409024
s_mov_b32 s23, 0x20000
s_mov_b32 s30, 2097152
s_mov_b32 s31, 0x20000
v_and_b32 v3, 15, v1
v_lshrrev_b32 v4, 4, v1
s_lshr_b32 s87, s51, 2
s_lshl_b32 s87, s87, 3
s_lshr_b32 s35, s52, 2
s_add_u32 s35, s35, s87
s_and_b32 s87, s51, 3
s_lshl_b32 s87, s87, 2
s_and_b32 s50, s52, 3
s_add_u32 s50, s50, s87
s_lshr_b32 s3, s50, 3
s_lshl_b32 s3, s3, 1
s_lshr_b32 s87, s33, 1
s_add_u32 s3, s3, s87
s_and_b32 s71, s50, 7
s_lshl_b32 s62, s71, 1
s_and_b32 s87, s33, 1
s_add_u32 s62, s62, s87
s_lshl_b32 s99, s33, 7
s_add_u32 s98, s99, 48
v_add_u32 v244, 1, v3
v_and_b32 v245, 3, v244
v_mul_u32_u24 v248, 4160, v245
v_and_b32_e64 v244, 28, v244
v_lshl_add_u32 v248, v244, 1, v248
v_lshlrev_b32 v244, 4, v4
v_sub_u32 v248, v248, v244
v_add_u32_e64 v248, s98, v248
s_sub_u32 s98, 33696, s99
v_lshl_add_u32 v249, v3, 5, v244
v_add_u32 v249, s98, v249
s_lshl_b32 s98, s33, 13
s_add_u32 s98, s98, 42624
v_add_u32 v224, s98, v2
v_lshlrev_b32 v227, 4, v0
v_and_b32 v225, 0xf00, v227
v_add_u32_e64 v225, v225, v227
v_add_u32 v225, 42624, v225
v_and_b32 v226, 0xe00, v227
v_lshl_add_u32 v226, v3, 5, v226
v_and_b32 v244, 16, v0
v_add_u32 v226, v226, v244
v_add_u32 v226, 126720, v226
v_mov_b32 v228, 131072
s_lshl_b32 s96, s52, 3
s_add_u32 s96, s96, s51
s_lshl_b32 s96, s96, 12
s_add_u32 s96, s96, 3145728
v_mov_b32 v245, 1073741824
v_lshlrev_b32 v229, 7, v1
v_lshlrev_b32 v230, 11, v1
s_cmp_ge_u32 s33, 2
s_cselect_b32 s98, 4, 0
v_cmp_gt_u32 vcc, s98, v1
s_cmp_eq_u32 s33, 3
s_cselect_b32 s99, 16, 0
s_cselect_b32 s98, 16, 0
s_cselect_b32 s78, 1073741824, 0
v_cndmask_b32 v231, v245, v229, vcc
v_cmp_gt_u32 vcc, s99, v1
s_and_b32 s92, s100, 15
s_lshl_b32 s101, s92, 7
v_cndmask_b32 v229, v245, v229, vcc
v_cmp_gt_u32 vcc, s98, v1
s_nop 1
v_cndmask_b32 v230, v245, v230, vcc
v_cmp_eq_u32 vcc, 0, v1
s_add_u32 s101, s101, 655360
s_lshr_b32 s79, s2, 4
v_cndmask_b32 v232, v245, 0, vcc
v_cndmask_b32 v236, 0, 32, vcc
s_lshl_b32 s79, s79, 11
s_add_u32 s79, s79, 655360
s_and_b32 s97, s100, 15
s_lshl_b32 s97, s97, 9
s_add_u32 s97, s97, 655360
s_lshl_b32 s95, s50, 2
s_add_u32 s95, s95, s33
s_lshl_b32 s95, s95, 7
s_add_u32 s95, s95, 655360
v_and_b32 v237, 9, v3
v_and_b32_e64 v244, 2, v3
v_lshl_add_u32 v237, v244, 1, v237
v_bfe_u32 v244, v3, 2, 1
v_lshl_add_u32 v237, v244, 1, v237
v_lshl_add_u32 v237, v4, 4, v237
v_lshlrev_b32 v237, 4, v237
s_mul_i32 s99, s50, 11
s_mul_i32 s98, s33, 3
s_add_u32 s99, s99, s98
s_lshl_b32 s99, s99, 14
s_add_u32 s99, s99, 5242880
v_add_u32 v237, s99, v237
v_add_u32 v238, 0x4000, v237
s_add_u32 s98, s78, 0x8000
v_add_u32 v239, s98, v237
s_mov_b32 s81, 0
v_mov_b32 v233, 1
v_mov_b32 v234, 0
v_mov_b32_e64 v235, 0
s_sub_u32 s60, s2, 80
s_cmp_ge_u32 s2, 80
s_cselect_b32 s61, 0, 1073741824
s_cselect_b32 s60, s60, 0
v_lshrrev_b32_e64 v242, 2, v3
v_lshl_add_u32 v242, v4, 3, v242
v_and_b32 v243, 3, v1
v_lshlrev_b32_e64 v243, 4, v243
v_lshl_add_u32 v242, v242, 6, v243
s_lshl_b32 s98, s33, 11
s_add_u32 s98, s98, 155648
v_add_u32 v242, s98, v242
v_add_u32 v243, s61, v2
s_and_b32 s98, s60, 3
s_lshl_b32 s98, s98, 2
s_add_u32 s98, s98, s33
s_lshr_b32 s98, s98, 1
s_lshl_b32 s98, s98, 2
s_bfe_u32 s99, s60, 0x20002
s_add_u32 s98, s98, s99
s_mul_i32 s98, s98, 11
s_lshr_b32 s60, s60, 4
s_add_u32 s60, s60, s98
s_lshl_b32 s60, s60, 1
s_xor_b32 s99, s99, s33
s_and_b32 s99, s99, 1
s_add_u32 s60, s60, s99
s_lshl_b32 s60, s60, 11
s_add_u32 s60, s60, 8388608
s_waitcnt lgkmcnt(0)
s_cmp_eq_u32 s33, 1
s_cbranch_scc1 L_w1b
s_cmp_ge_u32 s33, 2
s_cbranch_scc1 L_kgenb
s_mov_b32 s57, 0x05040100
s_mov_b32 s58, 0x07060302
s_lshr_b32 s53, s100, 1
s_lshl_b32 s53, s53, 14
s_and_b32 s54, s100, 1
s_lshl_b32 s54, s54, 6
s_add_u32 s53, s53, s54
s_add_u32 s53, s53, 1048576
s_mov_b32 s54, 0x3f803f80
v_and_b32 v16, 0x3c0, v2
v_add_u32 v16, v16, v2
s_lshl_b32 s55, s2, 7
s_add_u32 s55, s55, 655360
v_lshlrev_b32 v17, 6, v1
v_lshlrev_b32 v18, 11, v1
v_lshlrev_b32 v19, 7, v1
s_lshl_b32 s56, s100, 6
s_add_u32 s56, s56, 16384
s_mov_b32 s82, 16
v_mov_b32 v10, 1
v_mov_b32 v11, 0
v_mov_b32 v122, 0
v_mov_b32 v123, 0
v_lshrrev_b32 v124, 1, v1
v_lshlrev_b32 v124, 15, v124
v_and_b32 v125, 16, v2
v_add_u32 v124, v124, v125
v_mov_b32 v28, 131072
s_waitcnt vmcnt(8)
v_readfirstlane_b32 s32, v30
s_nop 0
s_mul_i32 s32, s32, 0x9E3779B1
s_add_u32 s32, s32, 0x7F4A7C15
v_mov_b32 v13, s32
s_mov_b32 exec_lo, 0x00000003
s_mov_b32 exec_hi, 0x00000000
buffer_store_dwordx4 v[12:15], v124, s[4:7], s55 offen sc1
s_mov_b64 exec, -1
s_mov_b32 s83, s32
v_lshrrev_b32 v21, 1, v0
v_lshrrev_b32 v8, 2, v0
v_lshlrev_b32 v8, 14, v8
v_and_b32 v31, 2, v0
v_lshl_add_u32 v8, v31, 5, v8
v_and_b32 v31, 1, v0
v_lshl_add_u32 v8, v31, 4, v8
v_mul_u32_u24 v6, 4672, v31
v_lshl_add_u32 v6, v21, 4, v6
v_add_u32 v6, 33792, v6
v_mul_u32_u24 v20, 8384, v31
v_lshl_add_u32 v20, v21, 4, v20
v_add_u32 v20, 126720, v20
v_lshlrev_b32 v21, 6, v21
s_lshl_b32 s87, s51, 11
s_lshr_b32 s88, s52, 1
s_lshl_b32 s88, s88, 7
s_add_u32 s87, s87, s88
s_and_b32 s88, s52, 1
s_lshl_b32 s88, s88, 5
s_add_u32 s87, s87, s88
s_add_u32 s87, s87, 1048576
v_and_b32 v7, 3, v1
v_mul_u32_u24 v7, 24576, v7
v_lshrrev_b32 v31, 3, v1
v_min_u32 v31, 2, v31
v_lshl_add_u32 v7, v31, 12, v7
v_and_b32_e64 v31, 4, v1
v_lshl_add_u32 v7, v31, 4, v7
s_lshl_b32 s59, s34, 3
s_add_u32 s59, s59, 65536
v_and_b32 v9, 24, v1
v_and_b32 v31, 31, v1
v_add_u32 v9, v9, v31
v_lshlrev_b32 v9, 3, v9
v_and_b32 v31, 32, v1
v_lshlrev_b32 v31, 7, v31
v_sub_u32_e64 v9, v9, v31
v_add_u32 v9, 4096, v9
s_bfe_u32 s89, s100, 0x30004
s_lshl_b32 s89, s89, 3
s_lshr_b32 s90, s100, 7
s_add_u32 s89, s89, s90
s_lshl_b32 s89, s89, 6
s_add_u32 s89, s89, 77824
s_add_u32 s90, s89, 24576
s_add_u32 s91, s89, 49152
s_add_u32 s92, s89, 73728
v_bfe_u32 v22, v1, 2, 2
v_lshlrev_b32 v22, 3, v22
v_and_b32 v31, 3, v1
v_add_u32_e64 v22, v22, v31
v_bfe_u32 v31, v1, 4, 1
v_lshl_add_u32 v22, v31, 2, v22
v_lshlrev_b32 v23, 2, v22
v_add_u32 v23, 131584, v23
v_lshlrev_b32 v22, 1, v22
v_add_u32 v22, 131712, v22
v_and_b32 v31, 1, v1
v_lshlrev_b32 v31, 4, v31
v_xor_b32 v31, 16, v31
s_waitcnt vmcnt(1)
v_perm_b32 v64, v56, v60, s57
v_perm_b32 v65, v48, v52, s57
v_perm_b32 v66, v40, v44, s57
v_perm_b32 v67, v32, v36, s57
buffer_store_dwordx4 v[64:67], v16, s[4:7], s53 offen offset:0 sc1
v_perm_b32 v68, v56, v60, s58
v_perm_b32 v69, v48, v52, s58
v_perm_b32 v70, v40, v44, s58
v_perm_b32 v71, v32, v36, s58
buffer_store_dwordx4 v[68:71], v16, s[4:7], s53 offen offset:2048 sc1
s_add_u32 s53, s53, 4096
v_perm_b32 v72, v57, v61, s57
v_perm_b32 v73, v49, v53, s57
v_perm_b32 v74, v41, v45, s57
v_perm_b32 v75, v33, v37, s57
buffer_store_dwordx4 v[72:75], v16, s[4:7], s53 offen offset:0 sc1
v_perm_b32 v76, v57, v61, s58
v_perm_b32 v77, v49, v53, s58
v_perm_b32 v78, v41, v45, s58
v_perm_b32 v79, v33, v37, s58
buffer_store_dwordx4 v[76:79], v16, s[4:7], s53 offen offset:2048 sc1
s_add_u32 s53, s53, 4096
v_perm_b32 v80, v58, v62, s57
v_perm_b32 v81, v50, v54, s57
v_perm_b32 v82, v42, v46, s57
v_perm_b32 v83, v34, v38, s57
buffer_store_dwordx4 v[80:83], v16, s[4:7], s53 offen offset:0 sc1
v_perm_b32 v84, v58, v62, s58
v_perm_b32 v85, v50, v54, s58
v_perm_b32 v86, v42, v46, s58
v_perm_b32 v87, v34, v38, s58
buffer_store_dwordx4 v[84:87], v16, s[4:7], s53 offen offset:2048 sc1
s_add_u32 s53, s53, 4096
v_perm_b32 v88, v59, v63, s57
v_perm_b32 v89, v51, v55, s57
v_perm_b32 v90, v43, v47, s57
v_perm_b32 v91, v35, v39, s57
buffer_store_dwordx4 v[88:91], v16, s[4:7], s53 offen offset:0 sc1
v_perm_b32 v92, v59, v63, s58
v_perm_b32 v93, v51, v55, s58
v_perm_b32 v94, v43, v47, s58
v_perm_b32 v95, v35, v39, s58
buffer_store_dwordx4 v[92:95], v16, s[4:7], s53 offen offset:2048 sc1
s_add_u32 s53, s53, 4096
ds_write_b32 v28, v10 offset:12
v_dot2_f32_bf16 v96, v60, s54, 0
v_dot2_f32_bf16 v100, v56, s54, 0
v_dot2_f32_bf16 v104, v60, v60, 0
v_dot2_f32_bf16 v108, v56, v56, 0
v_dot2_f32_bf16 v97, v52, s54, 0
v_dot2_f32_bf16 v101, v48, s54, 0
v_dot2_f32_bf16 v105, v52, v52, 0
v_dot2_f32_bf16 v109, v48, v48, 0
v_dot2_f32_bf16 v98, v44, s54, 0
v_dot2_f32_bf16 v102, v40, s54, 0
v_dot2_f32_bf16 v106, v44, v44, 0
v_dot2_f32_bf16 v110, v40, v40, 0
v_dot2_f32_bf16 v99, v36, s54, 0
v_dot2_f32_bf16 v103, v32, s54, 0
v_dot2_f32_bf16 v107, v36, v36, 0
v_dot2_f32_bf16 v111, v32, v32, 0
v_dot2_f32_bf16 v96, v61, s54, v96
v_dot2_f32_bf16 v100, v57, s54, v100
v_dot2_f32_bf16 v104, v61, v61, v104
v_dot2_f32_bf16 v108, v57, v57, v108
v_dot2_f32_bf16 v97, v53, s54, v97
v_dot2_f32_bf16 v101, v49, s54, v101
v_dot2_f32_bf16 v105, v53, v53, v105
v_dot2_f32_bf16 v109, v49, v49, v109
v_dot2_f32_bf16 v98, v45, s54, v98
v_dot2_f32_bf16 v102, v41, s54, v102
v_dot2_f32_bf16 v106, v45, v45, v106
v_dot2_f32_bf16 v110, v41, v41, v110
v_dot2_f32_bf16 v99, v37, s54, v99
v_dot2_f32_bf16 v103, v33, s54, v103
v_dot2_f32_bf16 v107, v37, v37, v107
v_dot2_f32_bf16 v111, v33, v33, v111
v_dot2_f32_bf16 v96, v62, s54, v96
v_dot2_f32_bf16 v100, v58, s54, v100
v_dot2_f32_bf16 v104, v62, v62, v104
v_dot2_f32_bf16 v108, v58, v58, v108
v_dot2_f32_bf16 v97, v54, s54, v97
v_dot2_f32_bf16 v101, v50, s54, v101
v_dot2_f32_bf16 v105, v54, v54, v105
v_dot2_f32_bf16 v109, v50, v50, v109
v_dot2_f32_bf16 v98, v46, s54, v98
v_dot2_f32_bf16 v102, v42, s54, v102
v_dot2_f32_bf16 v106, v46, v46, v106
v_dot2_f32_bf16 v110, v42, v42, v110
v_dot2_f32_bf16 v99, v38, s54, v99
v_dot2_f32_bf16 v103, v34, s54, v103
v_dot2_f32_bf16 v107, v38, v38, v107
v_dot2_f32_bf16 v111, v34, v34, v111
v_dot2_f32_bf16 v96, v63, s54, v96
v_dot2_f32_bf16 v100, v59, s54, v100
v_dot2_f32_bf16 v104, v63, v63, v104
v_dot2_f32_bf16 v108, v59, v59, v108
v_dot2_f32_bf16 v97, v55, s54, v97
v_dot2_f32_bf16 v101, v51, s54, v101
v_dot2_f32_bf16 v105, v55, v55, v105
v_dot2_f32_bf16 v109, v51, v51, v109
v_dot2_f32_bf16 v98, v47, s54, v98
v_dot2_f32_bf16 v102, v43, s54, v102
v_dot2_f32_bf16 v106, v47, v47, v106
v_dot2_f32_bf16 v110, v43, v43, v110
v_dot2_f32_bf16 v99, v39, s54, v99
v_dot2_f32_bf16 v103, v35, s54, v103
v_dot2_f32_bf16 v107, v39, v39, v107
v_dot2_f32_bf16 v111, v35, v35, v111
v_permlane32_swap_b32 v96, v98
v_permlane32_swap_b32 v97, v99
v_permlane32_swap_b32 v100, v102
v_permlane32_swap_b32 v101, v103
v_permlane32_swap_b32 v104, v106
v_permlane32_swap_b32 v105, v107
v_permlane32_swap_b32 v108, v110
v_permlane32_swap_b32 v109, v111
v_add_f32 v96, v96, v98
v_add_f32 v97, v97, v99
v_add_f32 v100, v100, v102
v_add_f32 v101, v101, v103
v_add_f32 v104, v104, v106
v_add_f32 v105, v105, v107
v_add_f32 v108, v108, v110
v_add_f32 v109, v109, v111
v_permlane16_swap_b32 v96, v97
v_permlane16_swap_b32 v100, v101
v_permlane16_swap_b32 v104, v105
v_permlane16_swap_b32 v108, v109
v_add_f32 v96, v96, v97
v_add_f32 v100, v100, v101
v_add_f32 v104, v104, v105
v_add_f32 v108, v108, v109
v_add_f32_dpp v96, v96, v96 row_ror:8 row_mask:0xf bank_mask:0xf
v_add_f32_dpp v100, v100, v100 row_ror:8 row_mask:0xf bank_mask:0xf
v_add_f32_dpp v104, v104, v104 row_ror:8 row_mask:0xf bank_mask:0xf
v_add_f32_dpp v108, v108, v108 row_ror:8 row_mask:0xf bank_mask:0xf
v_add_f32_dpp v96, v96, v96 row_ror:4 row_mask:0xf bank_mask:0xf
v_add_f32_dpp v100, v100, v100 row_ror:4 row_mask:0xf bank_mask:0xf
v_add_f32_dpp v104, v104, v104 row_ror:4 row_mask:0xf bank_mask:0xf
v_add_f32_dpp v108, v108, v108 row_ror:4 row_mask:0xf bank_mask:0xf
v_add_f32_dpp v96, v96, v96 row_ror:2 row_mask:0xf bank_mask:0xf
v_add_f32_dpp v100, v100, v100 row_ror:2 row_mask:0xf bank_mask:0xf
v_add_f32_dpp v104, v104, v104 row_ror:2 row_mask:0xf bank_mask:0xf
v_add_f32_dpp v108, v108, v108 row_ror:2 row_mask:0xf bank_mask:0xf
v_add_f32_dpp v96, v96, v96 row_ror:1 row_mask:0xf bank_mask:0xf
v_add_f32_dpp v100, v100, v100 row_ror:1 row_mask:0xf bank_mask:0xf
v_add_f32_dpp v104, v104, v104 row_ror:1 row_mask:0xf bank_mask:0xf
v_add_f32_dpp v108, v108, v108 row_ror:1 row_mask:0xf bank_mask:0xf
v_mul_f32 v96, 0x3b000000, v96
v_mul_f32 v104, 0x3b000000, v104
v_fma_f32 v104, -v96, v96, v104
v_max_f32_e64 v104, 0, v104
v_add_f32 v104, 0x3727c5ac, v104
v_rsq_f32_e64 v112, v104
v_mul_f32 v100, 0x3b000000, v100
v_mul_f32 v108, 0x3b000000, v108
v_fma_f32 v108, -v100, v100, v108
v_max_f32 v108, 0, v108
v_add_f32 v108, 0x3727c5ac, v108
v_rsq_f32 v113, v108
v_cvt_pk_bf16_f32 v114, v96, v100
v_mov_b32 v119, s32
ds_bpermute_b32 v116, v17, v112
ds_bpermute_b32 v117, v17, v113
ds_bpermute_b32 v118, v17, v114
s_mov_b32 exec_lo, 0x0000000f
s_mov_b32 exec_hi, 0x00000000
s_waitcnt lgkmcnt(0)
buffer_store_dwordx4 v[116:119], v2, s[4:7], s56 offen sc1
L_pad_h_0:
s_cbranch_execz L_pad_h_1
s_mov_b32 exec_lo, 0x0000ffff
s_mov_b32 exec_hi, 0x00000000
s_waitcnt vmcnt(1)
buffer_atomic_add_x2 v[10:11], v18, s[4:7], s101 offen sc0 sc1
buffer_atomic_add_x2 v[122:123], v19, s[4:7], s79 offen sc0 sc1
s_mov_b64 exec, 0
s_branch L_pad_b_0
L_ret_b:
s_mov_b64 exec, -1
s_mov_b64 exec, 0
s_branch L_pad_c_0
L_ret_c:
s_mov_b64 exec, -1
s_mov_b32 exec_lo, 0x0000ffff
s_mov_b32 exec_hi, 0x00000000
s_waitcnt vmcnt(1)
v_cmp_ne_u32 vcc, s32, v11
s_nop 4
s_cbranch_vccz L_sp_a1_ok
s_mov_b32 s70, 0
L_sp_a1:
s_mov_b64 exec, vcc
v_mov_b32 v10, 1
v_mov_b32 v11, 0
buffer_atomic_add_x2 v[10:11], v18, s[4:7], s101 offen sc0 sc1
s_waitcnt vmcnt(0)
v_cmp_ne_u32 vcc, s32, v11
s_nop 4
s_cbranch_vccz L_sp_a1_ok
s_add_u32 s70, s70, 1
s_cmp_lt_u32 s70, 2097152
s_cbranch_scc1 L_sp_a1
L_pad_h_1:
s_cbranch_execz L_pad_h_2
L_sp_a1_ok:
s_mov_b32 exec_lo, 0x0000ffff
s_mov_b32 exec_hi, 0x00000000
s_waitcnt vmcnt(0)
s_mov_b32 s70, 0
L_sp_p1:
v_cmp_ne_u64_e64 vcc, s[82:83], v[122:123]
s_nop 4
s_cbranch_vccz L_sp_p1_ok
v_mov_b32_e64 v122, 0
v_mov_b32_e64 v123, 0
buffer_atomic_add_x2 v[122:123], v19, s[4:7], s79 offen sc0 sc1
s_waitcnt vmcnt(0)
s_add_u32 s70, s70, 1
s_cmp_lt_u32 s70, 2097152
s_cbranch_scc1 L_sp_p1
L_sp_p1_ok:
s_mov_b64 exec, -1
v_mov_b32 v28, 131072
v_mov_b32_e64 v29, 1
ds_write_b32 v28, v29 offset:0
L_hprepa:
v_mov_b32_e64 v25, s32
s_mov_b32 exec_lo, 0x00ffffff
s_mov_b32 exec_hi, 0x00000000
buffer_load_dwordx2 v[24:25], v7, s[4:7], s59 offen sc1
s_mov_b64 exec, -1
buffer_load_dwordx2 v[96:97], v9, s[4:7], s89 offen sc1
buffer_load_dwordx2 v[98:99], v9, s[4:7], s90 offen sc1
buffer_load_dwordx2 v[100:101], v9, s[4:7], s91 offen sc1
buffer_load_dwordx2 v[102:103], v9, s[4:7], s92 offen sc1
buffer_load_dwordx4 v[64:67], v8, s[4:7], s87 offen
s_mov_b32 s53, 16384
s_add_u32 s87, s87, 524288
buffer_load_dwordx4 v[128:131], v21, s[4:7], s53 offen offset:0
buffer_load_dwordx4 v[132:135], v21, s[4:7], s53 offen offset:16
buffer_load_dwordx4 v[136:139], v21, s[4:7], s53 offen offset:32
buffer_load_dwordx4 v[140:143], v21, s[4:7], s53 offen offset:48
buffer_load_dwordx4 v[68:71], v8, s[4:7], s87 offen
s_mov_b32 s53, 20480
s_add_u32 s87, s87, 524288
buffer_load_dwordx4 v[144:147], v21, s[4:7], s53 offen offset:0
buffer_load_dwordx4 v[148:151], v21, s[4:7], s53 offen offset:16
buffer_load_dwordx4 v[152:155], v21, s[4:7], s53 offen offset:32
buffer_load_dwordx4 v[156:159], v21, s[4:7], s53 offen offset:48
buffer_load_dwordx4 v[72:75], v8, s[4:7], s87 offen
s_mov_b32 s53, 24576
s_add_u32 s87, s87, 524288
buffer_load_dwordx4 v[160:163], v21, s[4:7], s53 offen offset:0
buffer_load_dwordx4 v[164:167], v21, s[4:7], s53 offen offset:16
buffer_load_dwordx4 v[168:171], v21, s[4:7], s53 offen offset:32
buffer_load_dwordx4 v[172:175], v21, s[4:7], s53 offen offset:48
buffer_load_dwordx4 v[76:79], v8, s[4:7], s87 offen
s_mov_b32 s53, 28672
buffer_load_dwordx4 v[176:179], v21, s[4:7], s53 offen offset:0
buffer_load_dwordx4 v[180:183], v21, s[4:7], s53 offen offset:16
buffer_load_dwordx4 v[184:187], v21, s[4:7], s53 offen offset:32
buffer_load_dwordx4 v[188:191], v21, s[4:7], s53 offen offset:48
v_mov_b32 v28, 131072
s_mov_b32 s54, 0x05040100
s_mov_b32 s55, 0x07060302
s_mov_b32 s56, 0xbf803f80
s_waitcnt vmcnt(20)
s_mov_b32 s70, 0
L_sp_sta:
v_xor_b32_e64 v11, s32, v25
v_bitop3_b32 v11, v97, s32, v11 bitop3:0xbe
v_bitop3_b32 v11, v99, s32, v11 bitop3:0xbe
v_bitop3_b32 v11, v101, s32, v11 bitop3:0xbe
v_bitop3_b32 v11, v103, s32, v11 bitop3:0xbe
v_cmp_ne_u32_e64 vcc, 0, v11
s_nop 4
s_cbranch_vccz L_sp_sta_ok
s_mov_b32 exec_lo, 0x00ffffff
s_mov_b32 exec_hi, 0x00000000
buffer_load_dwordx2 v[24:25], v7, s[4:7], s59 offen sc1
s_mov_b64 exec, -1
buffer_load_dwordx2 v[96:97], v9, s[4:7], s89 offen sc1
buffer_load_dwordx2 v[98:99], v9, s[4:7], s90 offen sc1
buffer_load_dwordx2 v[100:101], v9, s[4:7], s91 offen sc1
buffer_load_dwordx2 v[102:103], v9, s[4:7], s92 offen sc1
s_waitcnt vmcnt(0)
s_add_u32 s70, s70, 1
s_cmp_lt_u32 s70, 2097152
s_cbranch_scc1 L_sp_sta
L_sp_sta_ok:
v_add_f32 v96, v96, v98
v_add_f32_e64 v100, v100, v102
v_add_f32_e64 v96, v96, v100
v_cvt_pk_bf16_f32 v96, v96, v96
v_and_b32 v96, 0xffff0000, v96
v_add_f32_e64 v97, 1.0, v96
v_cvt_pk_bf16_f32 v97, v97, v97
v_and_b32 v97, 0xffff0000, v97
v_lshrrev_b32_e64 v97, v31, v97
v_mov_b32_e64 v29, 1
s_mov_b32 exec_lo, 0xffffffff
s_mov_b32 exec_hi, 0x00000000
ds_write_b32 v23, v97
s_mov_b32 exec_lo, 0x00000000
s_mov_b32 exec_hi, 0xffffffff
ds_write_b16_d16_hi v22, v96
s_mov_b64 exec, -1
ds_write_b32 v28, v29 offset:4
v_add_f32_dpp v24, v24, v24 quad_perm:[1,0,3,2] row_mask:0xf bank_mask:0xf
s_nop 1
v_add_f32_dpp v24, v24, v24 quad_perm:[2,3,0,1] row_mask:0xf bank_mask:0xf
v_cvt_pk_bf16_f32 v24, v24, v24
v_and_b32 v24, 0xffff0000, v24
v_add_f32_e64 v25, 1.0, v24
v_cvt_pk_bf16_f32 v25, v25, v25
v_and_b32 v25, 0xffff0000, v25
v_readlane_b32 s64, v24, 0
v_readlane_b32 s65, v24, 4
v_readlane_b32 s66, v25, 8
v_readlane_b32 s67, v25, 12
v_readlane_b32 s68, v24, 16
v_readlane_b32 s69, v24, 20
v_mov_b32 v12, s66
v_mov_b32 v13, s64
s_mov_b32 exec_lo, 0xaaaaaaaa
s_mov_b32 exec_hi, 0xaaaaaaaa
v_mov_b32 v12, s67
v_mov_b32 v13, s65
s_mov_b64 exec, -1
s_waitcnt vmcnt(15)
L_sta0:
v_xor_b32_e64 v14, s32, v131
v_bitop3_b32 v14, v135, s32, v14 bitop3:0xbe
v_bitop3_b32 v14, v139, s32, v14 bitop3:0xbe
v_bitop3_b32 v14, v143, s32, v14 bitop3:0xbe
v_cmp_ne_u32_e64 vcc, 0, v14
v_perm_b32 v104, v130, v64, s54
v_perm_b32 v105, v130, v64, s55
v_perm_b32 v106, v134, v65, s54
v_perm_b32 v107, v134, v65, s55
v_perm_b32 v108, v138, v66, s54
v_perm_b32 v109, v138, v66, s55
v_perm_b32 v110, v142, v67, s54
v_perm_b32 v111, v142, v67, s55
s_cbranch_vccnz L_sta0_again
v_dot2_f32_bf16 v104, v104, s56, 0
s_nop 0
v_dot2_f32_bf16 v105, v105, s56, 0
v_dot2_f32_bf16 v106, v106, s56, 0
v_dot2_f32_bf16 v107, v107, s56, 0
v_dot2_f32_bf16 v108, v108, s56, 0
v_dot2_f32_bf16 v109, v109, s56, 0
v_dot2_f32_bf16 v110, v110, s56, 0
v_dot2_f32_bf16 v111, v111, s56, 0
v_pk_mul_f32 v[128:129], v[128:129], v[12:13] op_sel_hi:[1,0]
v_pk_mul_f32 v[132:133], v[132:133], v[12:13] op_sel_hi:[1,0]
v_pk_mul_f32 v[136:137], v[136:137], v[12:13] op_sel_hi:[1,0]
v_pk_mul_f32 v[140:141], v[140:141], v[12:13] op_sel_hi:[1,0]
v_pk_fma_f32 v[104:105], v[104:105], v[128:129], v[12:13] op_sel:[0,0,1] op_sel_hi:[1,1,1]
v_pk_fma_f32 v[106:107], v[106:107], v[132:133], v[12:13] op_sel:[0,0,1] op_sel_hi:[1,1,1]
v_pk_fma_f32 v[108:109], v[108:109], v[136:137], v[12:13] op_sel:[0,0,1] op_sel_hi:[1,1,1]
v_pk_fma_f32 v[110:111], v[110:111], v[140:141], v[12:13] op_sel:[0,0,1] op_sel_hi:[1,1,1]
v_cvt_pk_bf16_f32 v80, v104, v105
v_cvt_pk_bf16_f32 v81, v106, v107
v_cvt_pk_bf16_f32 v82, v108, v109
v_cvt_pk_bf16_f32 v83, v110, v111
ds_write_b128 v6, v[80:83] offset:0
ds_write_b128 v20, v[64:67] offset:0
s_waitcnt vmcnt(10)
L_sta1:
v_xor_b32 v14, s32, v147
v_bitop3_b32 v14, v151, s32, v14 bitop3:0xbe
v_bitop3_b32 v14, v155, s32, v14 bitop3:0xbe
v_bitop3_b32 v14, v159, s32, v14 bitop3:0xbe
v_cmp_ne_u32_e64 vcc, 0, v14
v_perm_b32 v112, v146, v68, s54
v_perm_b32 v113, v146, v68, s55
v_perm_b32 v114, v150, v69, s54
v_perm_b32 v115, v150, v69, s55
v_perm_b32 v116, v154, v70, s54
v_perm_b32 v117, v154, v70, s55
v_perm_b32 v118, v158, v71, s54
v_perm_b32 v119, v158, v71, s55
s_cbranch_vccnz L_sta1_again
v_dot2_f32_bf16 v112, v112, s56, 0
s_nop 0
v_dot2_f32_bf16 v113, v113, s56, 0
v_dot2_f32_bf16 v114, v114, s56, 0
v_dot2_f32_bf16 v115, v115, s56, 0
v_dot2_f32_bf16 v116, v116, s56, 0
v_dot2_f32_bf16 v117, v117, s56, 0
v_dot2_f32_bf16 v118, v118, s56, 0
v_dot2_f32_bf16 v119, v119, s56, 0
v_pk_mul_f32 v[144:145], v[144:145], v[12:13] op_sel_hi:[1,0]
v_pk_mul_f32 v[148:149], v[148:149], v[12:13] op_sel_hi:[1,0]
v_pk_mul_f32 v[152:153], v[152:153], v[12:13] op_sel_hi:[1,0]
v_pk_mul_f32 v[156:157], v[156:157], v[12:13] op_sel_hi:[1,0]
v_pk_fma_f32 v[112:113], v[112:113], v[144:145], v[12:13] op_sel:[0,0,1] op_sel_hi:[1,1,1]
v_pk_fma_f32 v[114:115], v[114:115], v[148:149], v[12:13] op_sel:[0,0,1] op_sel_hi:[1,1,1]
v_pk_fma_f32 v[116:117], v[116:117], v[152:153], v[12:13] op_sel:[0,0,1] op_sel_hi:[1,1,1]
v_pk_fma_f32 v[118:119], v[118:119], v[156:157], v[12:13] op_sel:[0,0,1] op_sel_hi:[1,1,1]
v_cvt_pk_bf16_f32 v84, v112, v113
v_cvt_pk_bf16_f32 v85, v114, v115
v_cvt_pk_bf16_f32 v86, v116, v117
v_cvt_pk_bf16_f32 v87, v118, v119
ds_write_b128 v6, v[84:87] offset:1024
ds_write_b128 v20, v[68:71] offset:1024
s_waitcnt vmcnt(5)
L_sta2:
v_xor_b32 v14, s32, v163
v_bitop3_b32 v14, v167, s32, v14 bitop3:0xbe
v_bitop3_b32 v14, v171, s32, v14 bitop3:0xbe
v_bitop3_b32 v14, v175, s32, v14 bitop3:0xbe
v_cmp_ne_u32_e64 vcc, 0, v14
v_perm_b32 v104, v162, v72, s54
v_perm_b32 v105, v162, v72, s55
v_perm_b32 v106, v166, v73, s54
v_perm_b32 v107, v166, v73, s55
v_perm_b32 v108, v170, v74, s54
v_perm_b32 v109, v170, v74, s55
v_perm_b32 v110, v174, v75, s54
v_perm_b32 v111, v174, v75, s55
s_cbranch_vccnz L_sta2_again
v_dot2_f32_bf16 v104, v104, s56, 0
s_nop 0
v_dot2_f32_bf16 v105, v105, s56, 0
v_dot2_f32_bf16 v106, v106, s56, 0
v_dot2_f32_bf16 v107, v107, s56, 0
v_dot2_f32_bf16 v108, v108, s56, 0
v_dot2_f32_bf16 v109, v109, s56, 0
v_dot2_f32_bf16 v110, v110, s56, 0
v_dot2_f32_bf16 v111, v111, s56, 0
v_pk_mul_f32 v[160:161], v[160:161], v[12:13] op_sel_hi:[1,0]
v_pk_mul_f32 v[164:165], v[164:165], v[12:13] op_sel_hi:[1,0]
v_pk_mul_f32 v[168:169], v[168:169], v[12:13] op_sel_hi:[1,0]
v_pk_mul_f32 v[172:173], v[172:173], v[12:13] op_sel_hi:[1,0]
v_pk_fma_f32 v[104:105], v[104:105], v[160:161], v[12:13] op_sel:[0,0,1] op_sel_hi:[1,1,1]
v_pk_fma_f32 v[106:107], v[106:107], v[164:165], v[12:13] op_sel:[0,0,1] op_sel_hi:[1,1,1]
v_pk_fma_f32 v[108:109], v[108:109], v[168:169], v[12:13] op_sel:[0,0,1] op_sel_hi:[1,1,1]
v_pk_fma_f32 v[110:111], v[110:111], v[172:173], v[12:13] op_sel:[0,0,1] op_sel_hi:[1,1,1]
v_cvt_pk_bf16_f32 v88, v104, v105
v_cvt_pk_bf16_f32 v89, v106, v107
v_cvt_pk_bf16_f32 v90, v108, v109
v_cvt_pk_bf16_f32 v91, v110, v111
ds_write_b128 v6, v[88:91] offset:2048
ds_write_b128 v20, v[72:75] offset:2048
s_waitcnt vmcnt(0)
L_sta3:
v_xor_b32 v14, s32, v179
v_bitop3_b32 v14, v183, s32, v14 bitop3:0xbe
v_bitop3_b32 v14, v187, s32, v14 bitop3:0xbe
v_bitop3_b32 v14, v191, s32, v14 bitop3:0xbe
v_cmp_ne_u32_e64 vcc, 0, v14
v_perm_b32 v112, v178, v76, s54
v_perm_b32 v113, v178, v76, s55
v_perm_b32 v114, v182, v77, s54
v_perm_b32 v115, v182, v77, s55
v_perm_b32 v116, v186, v78, s54
v_perm_b32 v117, v186, v78, s55
v_perm_b32 v118, v190, v79, s54
v_perm_b32 v119, v190, v79, s55
s_cbranch_vccnz L_sta3_again
v_dot2_f32_bf16 v112, v112, s56, 0
s_nop 0
v_dot2_f32_bf16 v113, v113, s56, 0
v_dot2_f32_bf16 v114, v114, s56, 0
v_dot2_f32_bf16 v115, v115, s56, 0
v_dot2_f32_bf16 v116, v116, s56, 0
v_dot2_f32_bf16 v117, v117, s56, 0
v_dot2_f32_bf16 v118, v118, s56, 0
v_dot2_f32_bf16 v119, v119, s56, 0
v_pk_mul_f32 v[176:177], v[176:177], v[12:13] op_sel_hi:[1,0]
v_pk_mul_f32 v[180:181], v[180:181], v[12:13] op_sel_hi:[1,0]
v_pk_mul_f32 v[184:185], v[184:185], v[12:13] op_sel_hi:[1,0]
v_pk_mul_f32 v[188:189], v[188:189], v[12:13] op_sel_hi:[1,0]
v_pk_fma_f32 v[112:113], v[112:113], v[176:177], v[12:13] op_sel:[0,0,1] op_sel_hi:[1,1,1]
v_pk_fma_f32 v[114:115], v[114:115], v[180:181], v[12:13] op_sel:[0,0,1] op_sel_hi:[1,1,1]
v_pk_fma_f32 v[116:117], v[116:117], v[184:185], v[12:13] op_sel:[0,0,1] op_sel_hi:[1,1,1]
v_pk_fma_f32 v[118:119], v[118:119], v[188:189], v[12:13] op_sel:[0,0,1] op_sel_hi:[1,1,1]
v_cvt_pk_bf16_f32 v92, v112, v113
v_cvt_pk_bf16_f32 v93, v114, v115
v_cvt_pk_bf16_f32 v94, v116, v117
v_cvt_pk_bf16_f32 v95, v118, v119
ds_write_b128 v6, v[92:95] offset:3072
ds_write_b128 v20, v[76:79] offset:3072
v_mov_b32_e64 v10, s68
v_mov_b32_e64 v11, s69
ds_write_b64 v28, v[10:11] offset:16
s_branch L_join1
s_nop 0
L_sta0_again:
s_mov_b32 s53, 16384
buffer_load_dwordx4 v[128:131], v21, s[4:7], s53 offen offset:0 sc1
buffer_load_dwordx4 v[132:135], v21, s[4:7], s53 offen offset:16 sc1
buffer_load_dwordx4 v[136:139], v21, s[4:7], s53 offen offset:32 sc1
buffer_load_dwordx4 v[140:143], v21, s[4:7], s53 offen offset:48 sc1
s_add_u32 s70, s70, 1
s_cmp_lt_u32 s70, 2097152
s_waitcnt vmcnt(0)
s_cbranch_scc1 L_sta0
s_branch L_join1
L_sta1_again:
s_mov_b32 s53, 20480
buffer_load_dwordx4 v[144:147], v21, s[4:7], s53 offen offset:0 sc1
buffer_load_dwordx4 v[148:151], v21, s[4:7], s53 offen offset:16 sc1
buffer_load_dwordx4 v[152:155], v21, s[4:7], s53 offen offset:32 sc1
buffer_load_dwordx4 v[156:159], v21, s[4:7], s53 offen offset:48 sc1
s_add_u32 s70, s70, 1
s_cmp_lt_u32 s70, 2097152
s_waitcnt vmcnt(0)
s_cbranch_scc1 L_sta1
s_branch L_join1
L_sta2_again:
s_mov_b32 s53, 24576
buffer_load_dwordx4 v[160:163], v21, s[4:7], s53 offen offset:0 sc1
buffer_load_dwordx4 v[164:167], v21, s[4:7], s53 offen offset:16 sc1
buffer_load_dwordx4 v[168:171], v21, s[4:7], s53 offen offset:32 sc1
buffer_load_dwordx4 v[172:175], v21, s[4:7], s53 offen offset:48 sc1
s_add_u32 s70, s70, 1
s_cmp_lt_u32 s70, 2097152
s_waitcnt vmcnt(0)
s_cbranch_scc1 L_sta2
s_branch L_join1
L_sta3_again:
s_mov_b32 s53, 28672
buffer_load_dwordx4 v[176:179], v21, s[4:7], s53 offen offset:0 sc1
buffer_load_dwordx4 v[180:183], v21, s[4:7], s53 offen offset:16 sc1
buffer_load_dwordx4 v[184:187], v21, s[4:7], s53 offen offset:32 sc1
buffer_load_dwordx4 v[188:191], v21, s[4:7], s53 offen offset:48 sc1
s_add_u32 s70, s70, 1
s_cmp_lt_u32 s70, 2097152
s_waitcnt vmcnt(0)
s_cbranch_scc1 L_sta3
s_branch L_join1
L_w1b:
v_mul_u32_u24 v251, 2736, v4
v_lshl_add_u32 v251, v3, 4, v251
s_bfe_u32 s93, s100, 0x30004
s_lshl_b32 s93, s93, 3
s_lshr_b32 s87, s100, 7
s_add_u32 s93, s93, s87
s_mul_i32 s93, s93, 22016
s_mov_b32 s94, 11008
s_and_b32 s87, s100, 15
s_mul_i32 s87, s87, 172
s_add_u32 s93, s93, s87
s_mov_b32 m0, 109184
s_sub_u32 s87, s2, 80
s_max_i32 s87, s87, 0
s_and_b32 s98, s87, 3
s_lshl_b32 s98, s98, 8
s_add_u32 s98, s98, s61
v_and_b32 v250, 3, v1
v_lshl_add_u32 v250, v250, 4, s98
s_and_b32 s87, s87, 0xfc
s_lshr_b32 s88, s87, 6
s_and_b32 s87, s87, 63
s_movk_i32 s89, 16384
s_cmp_eq_u32 s88, 2
s_cselect_b32 s89, 21846, s89
s_cselect_b32 s90, 3, 4
s_lshl_b32 s88, s88, 3
v_bfe_u32 v240, v1, 2, 3
v_add_u32 v240, s88, v240
v_lshrrev_b32 v244, 5, v1
v_add_u32 v244, s87, v244
v_mov_b32 v241, 1073741824
v_mul_u32_u24 v246, s89, v244
v_lshrrev_b32 v246, 16, v246
v_mul_u32_u24 v245, s90, v246
v_sub_u32 v245, v244, v245
v_mad_u32_u24 v245, v245, 24, v240
v_cmp_gt_u32 vcc, 86, v245
v_mul_u32_u24 v246, 86, v246
v_add_u32_e64 v246, v246, v245
v_lshl_add_u32 v246, v246, 10, v250
v_cndmask_b32 v246, v241, v246, vcc
v_add_u32 v244, 2, v244
v_mul_u32_u24 v247, s89, v244
v_lshrrev_b32 v247, 16, v247
v_mul_u32_u24 v245, s90, v247
v_sub_u32 v245, v244, v245
v_mad_u32_u24 v245, v245, 24, v240
v_cmp_gt_u32 vcc, 86, v245
v_mul_u32_u24 v247, 86, v247
v_add_u32_e64 v247, v247, v245
v_lshl_add_u32 v247, v247, 10, v250
v_cndmask_b32 v247, v241, v247, vcc
s_waitcnt vmcnt(16)
v_readfirstlane_b32 s32, v30
s_nop 0
s_mul_i32 s32, s32, 0x9E3779B1
s_add_u32 s32, s32, 0x7F4A7C15
v_lshlrev_b32 v12, 16, v6
v_and_b32 v13, 0xffff0000, v6
v_mul_f32 v14, 0xbfb8aa3b, v12
v_exp_f32 v14, v14
v_mul_f32 v16, 0xbfb8aa3b, v13
v_exp_f32 v16, v16
v_add_f32 v14, 1.0, v14
v_min_f32 v14, 0x7e800000, v14
v_rcp_f32 v17, v14
v_add_f32 v16, 1.0, v16
v_min_f32 v16, 0x7e800000, v16
v_rcp_f32 v18, v16
v_mul_f32 v19, v12, v17
v_fma_f32 v12, -v19, v14, v12
v_fma_f32 v12, v12, v17, v19
v_mul_f32 v20, v13, v18
v_fma_f32 v13, -v20, v16, v13
v_fma_f32 v13, v13, v18, v20
v_cvt_pk_bf16_f32 v12, v12, v13
v_lshlrev_b32 v13, 2, v1
v_add_u32 v13, 131328, v13
ds_write_b32 v13, v12
v_lshlrev_b32_e64 v13, 4, v4
v_add_u32 v13, 131328, v13
ds_read_b128 v[32:35], v13 offset:0
ds_read_b128 v[36:39], v13 offset:64
ds_read_b128 v[40:43], v13 offset:128
ds_read_b128 v[44:47], v13 offset:192
v_lshrrev_b32 v14, 2, v3
v_lshl_add_u32 v14, v4, 3, v14
v_and_b32 v16, 3, v1
v_lshlrev_b32_e64 v17, 7, v14
v_lshl_add_u32 v17, v16, 3, v17
v_add_u32 v17, 139264, v17
s_waitcnt lgkmcnt(0)
v_mov_b32 v28, 131072
s_mov_b32 s70, 0
L_sp_f3:
ds_read_b32 v29, v28 offset:12
s_waitcnt lgkmcnt(0)
v_cmp_ne_u32 vcc, 1, v29
s_nop 4
s_cbranch_vccz L_sp_f3_ok
s_add_u32 s70, s70, 1
s_cmp_lt_u32 s70, 67108864
s_cbranch_scc1 L_sp_f3
L_sp_f3_ok:
s_mov_b32 exec_lo, 0x0ffe07ff
s_mov_b32 exec_hi, 0x3ff81ffc
L_slab:
buffer_load_dwordx4 v251, s[12:15], s93 offen lds
s_add_u32 m0, m0, 8832
s_nop 0
buffer_load_dwordx4 v251, s[16:19], s93 offen lds
s_add_u32 s93, s93, s94
s_xor_b32 s94, s94, 43520
s_sub_u32 m0, m0, 7744
s_cmp_lt_u32 m0, 117888
s_cbranch_scc1 L_slab
s_mov_b64 exec, -1
s_waitcnt vmcnt(16)
s_nop 0
ds_read_b64_tr_b16 v[64:65], v17 offset:0
ds_read_b64_tr_b16 v[66:67], v17 offset:512
ds_read_b64_tr_b16 v[68:69], v17 offset:32
ds_read_b64_tr_b16 v[70:71], v17 offset:544
ds_read_b64_tr_b16 v[72:73], v17 offset:64
ds_read_b64_tr_b16 v[74:75], v17 offset:576
ds_read_b64_tr_b16 v[76:77], v17 offset:96
ds_read_b64_tr_b16 v[78:79], v17 offset:608
ds_read_b64_tr_b16 v[80:81], v17 offset:4096
ds_read_b64_tr_b16 v[82:83], v17 offset:4608
s_waitcnt lgkmcnt(8)
v_mfma_f32_16x16x32_bf16 v[48:51], v[32:35], v[64:67], 0
ds_read_b64_tr_b16 v[84:85], v17 offset:4128
ds_read_b64_tr_b16 v[86:87], v17 offset:4640
s_waitcnt lgkmcnt(8)
v_mfma_f32_16x16x32_bf16 v[52:55], v[32:35], v[68:71], 0
ds_read_b64_tr_b16 v[88:89], v17 offset:4160
ds_read_b64_tr_b16 v[90:91], v17 offset:4672
s_waitcnt lgkmcnt(8)
v_mfma_f32_16x16x32_bf16 v[56:59], v[32:35], v[72:75], 0
ds_read_b64_tr_b16 v[92:93], v17 offset:4192
ds_read_b64_tr_b16 v[94:95], v17 offset:4704
s_waitcnt lgkmcnt(8)
v_mfma_f32_16x16x32_bf16 v[60:63], v[32:35], v[76:79], 0
ds_read_b64_tr_b16 v[96:97], v17 offset:8192
ds_read_b64_tr_b16 v[98:99], v17 offset:8704
s_waitcnt lgkmcnt(8)
v_mfma_f32_16x16x32_bf16 v[48:51], v[36:39], v[80:83], v[48:51]
ds_read_b64_tr_b16 v[100:101], v17 offset:8224
ds_read_b64_tr_b16 v[102:103], v17 offset:8736
s_waitcnt lgkmcnt(8)
v_mfma_f32_16x16x32_bf16 v[52:55], v[36:39], v[84:87], v[52:55]
ds_read_b64_tr_b16 v[104:105], v17 offset:8256
ds_read_b64_tr_b16 v[106:107], v17 offset:8768
s_waitcnt lgkmcnt(8)
v_mfma_f32_16x16x32_bf16 v[56:59], v[36:39], v[88:91], v[56:59]
ds_read_b64_tr_b16 v[108:109], v17 offset:8288
ds_read_b64_tr_b16 v[110:111], v17 offset:8800
s_waitcnt lgkmcnt(8)
v_mfma_f32_16x16x32_bf16 v[60:63], v[36:39], v[92:95], v[60:63]
ds_read_b64_tr_b16 v[112:113], v17 offset:12288
ds_read_b64_tr_b16 v[114:115], v17 offset:12800
s_waitcnt lgkmcnt(8)
v_mfma_f32_16x16x32_bf16 v[48:51], v[40:43], v[96:99], v[48:51]
ds_read_b64_tr_b16 v[116:117], v17 offset:12320
ds_read_b64_tr_b16 v[118:119], v17 offset:12832
s_waitcnt lgkmcnt(8)
v_mfma_f32_16x16x32_bf16 v[52:55], v[40:43], v[100:103], v[52:55]
ds_read_b64_tr_b16 v[120:121], v17 offset:12352
ds_read_b64_tr_b16 v[122:123], v17 offset:12864
s_waitcnt lgkmcnt(8)
v_mfma_f32_16x16x32_bf16 v[56:59], v[40:43], v[104:107], v[56:59]
ds_read_b64_tr_b16 v[124:125], v17 offset:12384
ds_read_b64_tr_b16 v[126:127], v17 offset:12896
s_waitcnt lgkmcnt(8)
v_mfma_f32_16x16x32_bf16 v[60:63], v[40:43], v[108:111], v[60:63]
s_waitcnt lgkmcnt(6)
v_mfma_f32_16x16x32_bf16 v[48:51], v[44:47], v[112:115], v[48:51]
s_waitcnt lgkmcnt(4)
v_mfma_f32_16x16x32_bf16 v[52:55], v[44:47], v[116:119], v[52:55]
s_waitcnt lgkmcnt(2)
v_mfma_f32_16x16x32_bf16 v[56:59], v[44:47], v[120:123], v[56:59]
s_waitcnt lgkmcnt(0)
v_mfma_f32_16x16x32_bf16 v[60:63], v[44:47], v[124:127], v[60:63]
s_mul_i32 s54, s53, 24576
s_lshl_b32 s55, s55, 9
s_add_u32 s54, s54, s55
s_add_u32 s54, s54, 65536
v_lshl_add_u32 v12, v1, 3, s59
v_mov_b32 v21, s32
v_mov_b32 v20, v48
s_mov_b32 exec_lo, 0xffff0000
s_mov_b32 exec_hi, 0x00000000
v_mov_b32 v20, v52
s_mov_b32 exec_lo, 0x00000000
s_mov_b32 exec_hi, 0x0000ffff
v_mov_b32 v20, v56
s_mov_b32 exec_lo, 0x00000000
s_mov_b32 exec_hi, 0xffff0000
v_mov_b32_e64 v20, v60
s_mov_b64 exec, -1
buffer_store_dwordx2 v[20:21], v12, s[4:7], s54 offen sc1
s_mov_b32 m0, 155648
s_mov_b32 s93, 0
L_wdslab:
buffer_load_dwordx4 v246, s[20:23], s93 offen lds
s_add_u32 m0, m0, 1024
s_nop 0
buffer_load_dwordx4 v247, s[20:23], s93 offen lds
s_add_u32 m0, m0, 1024
s_add_u32 s93, s93, 64
s_cmp_lt_u32 s93, 256
s_cbranch_scc1 L_wdslab
v_lshrrev_b32 v21, 1, v0
v_lshrrev_b32 v8, 2, v0
v_lshlrev_b32 v8, 14, v8
v_and_b32 v31, 2, v0
v_lshl_add_u32 v8, v31, 5, v8
v_and_b32_e64 v31, 1, v0
v_lshl_add_u32 v8, v31, 4, v8
v_mul_u32_u24 v6, 4672, v31
v_lshl_add_u32 v6, v21, 4, v6
v_add_u32 v6, 33792, v6
v_mul_u32_u24 v20, 8384, v31
v_lshl_add_u32 v20, v21, 4, v20
v_add_u32 v20, 126720, v20
v_lshlrev_b32 v21, 6, v21
s_lshl_b32 s87, s51, 11
s_lshr_b32 s88, s52, 1
s_lshl_b32 s88, s88, 7
s_add_u32 s87, s87, s88
s_and_b32 s88, s52, 1
s_lshl_b32 s88, s88, 5
s_add_u32 s87, s87, s88
s_add_u32 s87, s87, 1048576
v_and_b32 v7, 3, v1
v_mul_u32_u24 v7, 24576, v7
v_lshrrev_b32 v31, 3, v1
v_min_u32 v31, 2, v31
v_lshl_add_u32 v7, v31, 12, v7
v_and_b32 v31, 4, v1
v_lshl_add_u32 v7, v31, 4, v7
s_lshl_b32 s59, s34, 3
s_add_u32 s59, s59, 65536
v_and_b32 v9, 24, v1
v_and_b32 v31, 31, v1
v_add_u32 v9, v9, v31
v_lshlrev_b32 v9, 3, v9
v_and_b32 v31, 32, v1
v_lshlrev_b32 v31, 7, v31
v_sub_u32 v9, v9, v31
v_add_u32 v9, 4096, v9
s_bfe_u32 s89, s100, 0x30004
s_lshl_b32 s89, s89, 3
s_lshr_b32 s90, s100, 7
s_add_u32 s89, s89, s90
s_lshl_b32 s89, s89, 6
s_add_u32 s89, s89, 77824
s_add_u32 s90, s89, 24576
s_add_u32 s91, s89, 49152
s_add_u32 s92, s89, 73728
v_bfe_u32 v22, v1, 2, 2
v_lshlrev_b32 v22, 3, v22
v_and_b32 v31, 3, v1
v_add_u32 v22, v22, v31
v_bfe_u32 v31, v1, 4, 1
v_lshl_add_u32 v22, v31, 2, v22
v_lshlrev_b32 v23, 2, v22
v_add_u32 v23, 131584, v23
v_lshlrev_b32 v22, 1, v22
v_add_u32 v22, 131712, v22
v_and_b32 v31, 1, v1
v_lshlrev_b32 v31, 4, v31
v_xor_b32 v31, 16, v31
s_mov_b64 exec, 0
s_branch L_pad_h_0
s_nop 0
L_ret_h:
s_mov_b64 exec, -1
s_mov_b64 exec, 0
s_branch L_pad_a_0
s_nop 0
L_ret_a:
s_mov_b64 exec, -1
s_mov_b64 exec, 0
s_branch L_pad_d_0
s_nop 0
L_ret_d:
s_mov_b64 exec, -1
s_waitcnt vmcnt(0)
v_mov_b32 v28, 131072
v_mov_b32 v29, 1
ds_write_b32 v28, v29 offset:8
v_mov_b32 v28, 131072
s_mov_b32 s70, 0
L_sp_f0:
ds_read_b32 v29, v28 offset:0
s_waitcnt lgkmcnt(0)
v_cmp_ne_u32 vcc, 1, v29
s_nop 4
s_cbranch_vccz L_sp_f0_ok
s_add_u32 s70, s70, 1
s_cmp_lt_u32 s70, 67108864
s_cbranch_scc1 L_sp_f0
L_sp_f0_ok:
L_hprepb:
v_mov_b32 v25, s32
s_mov_b32 exec_lo, 0x00ffffff
s_mov_b32 exec_hi, 0x00000000
buffer_load_dwordx2 v[24:25], v7, s[4:7], s59 offen sc1
s_mov_b64 exec, -1
buffer_load_dwordx4 v[64:67], v8, s[4:7], s87 offen
s_mov_b32 s53, 16384
L_pad_h_2:
s_cbranch_execz L_ret_h
s_add_u32 s87, s87, 524288
buffer_load_dwordx4 v[128:131], v21, s[4:7], s53 offen offset:0
s_nop 0
buffer_load_dwordx4 v[132:135], v21, s[4:7], s53 offen offset:16
buffer_load_dwordx4 v[136:139], v21, s[4:7], s53 offen offset:32
buffer_load_dwordx4 v[140:143], v21, s[4:7], s53 offen offset:48
buffer_load_dwordx4 v[68:71], v8, s[4:7], s87 offen
s_mov_b32 s53, 20480
s_add_u32 s87, s87, 524288
buffer_load_dwordx4 v[144:147], v21, s[4:7], s53 offen offset:0
buffer_load_dwordx4 v[148:151], v21, s[4:7], s53 offen offset:16
buffer_load_dwordx4 v[152:155], v21, s[4:7], s53 offen offset:32
buffer_load_dwordx4 v[156:159], v21, s[4:7], s53 offen offset:48
buffer_load_dwordx4 v[72:75], v8, s[4:7], s87 offen
s_mov_b32 s53, 24576
s_add_u32 s87, s87, 524288
buffer_load_dwordx4 v[160:163], v21, s[4:7], s53 offen offset:0
buffer_load_dwordx4 v[164:167], v21, s[4:7], s53 offen offset:16
buffer_load_dwordx4 v[168:171], v21, s[4:7], s53 offen offset:32
buffer_load_dwordx4 v[172:175], v21, s[4:7], s53 offen offset:48
buffer_load_dwordx4 v[76:79], v8, s[4:7], s87 offen
s_mov_b32 s53, 28672
buffer_load_dwordx4 v[176:179], v21, s[4:7], s53 offen offset:0
buffer_load_dwordx4 v[180:183], v21, s[4:7], s53 offen offset:16
buffer_load_dwordx4 v[184:187], v21, s[4:7], s53 offen offset:32
buffer_load_dwordx4 v[188:191], v21, s[4:7], s53 offen offset:48
v_mov_b32 v28, 131072
s_mov_b32 s54, 0x05040100
s_mov_b32 s55, 0x07060302
s_mov_b32 s56, 0xbf803f80
s_waitcnt vmcnt(20)
s_mov_b32 s70, 0
L_sp_stb:
v_cmp_ne_u32_e64 vcc, s32, v25
s_nop 4
s_cbranch_vccz L_sp_stb_ok
s_mov_b32 exec_lo, 0x00ffffff
s_mov_b32 exec_hi, 0x00000000
buffer_load_dwordx2 v[24:25], v7, s[4:7], s59 offen sc1
s_mov_b64 exec, -1
s_waitcnt vmcnt(0)
s_add_u32 s70, s70, 1
s_cmp_lt_u32 s70, 2097152
s_cbranch_scc1 L_sp_stb
L_sp_stb_ok:
v_add_f32_dpp v24, v24, v24 quad_perm:[1,0,3,2] row_mask:0xf bank_mask:0xf
s_nop 1
v_add_f32_dpp v24, v24, v24 quad_perm:[2,3,0,1] row_mask:0xf bank_mask:0xf
v_cvt_pk_bf16_f32 v24, v24, v24
v_and_b32 v24, 0xffff0000, v24
v_add_f32_e64 v25, 1.0, v24
v_cvt_pk_bf16_f32 v25, v25, v25
v_and_b32 v25, 0xffff0000, v25
v_readlane_b32 s64, v24, 0
v_readlane_b32 s65, v24, 4
v_readlane_b32 s66, v25, 8
v_readlane_b32 s67, v25, 12
s_nop 0
v_mov_b32 v12, s66
v_mov_b32_e64 v13, s64
s_mov_b32 exec_lo, 0xaaaaaaaa
s_mov_b32 exec_hi, 0xaaaaaaaa
v_mov_b32 v12, s67
v_mov_b32 v13, s65
s_mov_b64 exec, -1
s_waitcnt vmcnt(15)
L_stb0:
v_xor_b32 v14, s32, v131
v_bitop3_b32 v14, v135, s32, v14 bitop3:0xbe
v_bitop3_b32 v14, v139, s32, v14 bitop3:0xbe
v_bitop3_b32 v14, v143, s32, v14 bitop3:0xbe
v_cmp_ne_u32 vcc, 0, v14
v_perm_b32 v104, v130, v64, s54
v_perm_b32 v105, v130, v64, s55
v_perm_b32 v106, v134, v65, s54
v_perm_b32 v107, v134, v65, s55
v_perm_b32 v108, v138, v66, s54
v_perm_b32 v109, v138, v66, s55
v_perm_b32 v110, v142, v67, s54
v_perm_b32 v111, v142, v67, s55
s_cbranch_vccnz L_stb0_again
v_dot2_f32_bf16 v104, v104, s56, 0
v_dot2_f32_bf16 v105, v105, s56, 0
s_nop 0
v_dot2_f32_bf16 v106, v106, s56, 0
v_dot2_f32_bf16 v107, v107, s56, 0
v_dot2_f32_bf16 v108, v108, s56, 0
v_dot2_f32_bf16 v109, v109, s56, 0
v_dot2_f32_bf16 v110, v110, s56, 0
v_dot2_f32_bf16 v111, v111, s56, 0
v_pk_mul_f32 v[128:129], v[128:129], v[12:13] op_sel_hi:[1,0]
v_pk_mul_f32 v[132:133], v[132:133], v[12:13] op_sel_hi:[1,0]
v_pk_mul_f32 v[136:137], v[136:137], v[12:13] op_sel_hi:[1,0]
v_pk_mul_f32 v[140:141], v[140:141], v[12:13] op_sel_hi:[1,0]
v_pk_fma_f32 v[104:105], v[104:105], v[128:129], v[12:13] op_sel:[0,0,1] op_sel_hi:[1,1,1]
v_pk_fma_f32 v[106:107], v[106:107], v[132:133], v[12:13] op_sel:[0,0,1] op_sel_hi:[1,1,1]
v_pk_fma_f32 v[108:109], v[108:109], v[136:137], v[12:13] op_sel:[0,0,1] op_sel_hi:[1,1,1]
v_pk_fma_f32 v[110:111], v[110:111], v[140:141], v[12:13] op_sel:[0,0,1] op_sel_hi:[1,1,1]
v_cvt_pk_bf16_f32 v80, v104, v105
v_cvt_pk_bf16_f32 v81, v106, v107
v_cvt_pk_bf16_f32 v82, v108, v109
v_cvt_pk_bf16_f32 v83, v110, v111
ds_write_b128 v6, v[80:83] offset:0
ds_write_b128 v20, v[64:67] offset:0
s_waitcnt vmcnt(10)
L_stb1:
v_xor_b32 v14, s32, v147
v_bitop3_b32 v14, v151, s32, v14 bitop3:0xbe
v_bitop3_b32 v14, v155, s32, v14 bitop3:0xbe
v_bitop3_b32 v14, v159, s32, v14 bitop3:0xbe
v_cmp_ne_u32_e64 vcc, 0, v14
v_perm_b32 v112, v146, v68, s54
v_perm_b32 v113, v146, v68, s55
v_perm_b32 v114, v150, v69, s54
v_perm_b32 v115, v150, v69, s55
v_perm_b32 v116, v154, v70, s54
v_perm_b32 v117, v154, v70, s55
v_perm_b32 v118, v158, v71, s54
v_perm_b32 v119, v158, v71, s55
s_cbranch_vccnz L_stb1_again
v_dot2_f32_bf16 v112, v112, s56, 0
v_dot2_f32_bf16 v113, v113, s56, 0
s_nop 0
v_dot2_f32_bf16 v114, v114, s56, 0
v_dot2_f32_bf16 v115, v115, s56, 0
v_dot2_f32_bf16 v116, v116, s56, 0
v_dot2_f32_bf16 v117, v117, s56, 0
v_dot2_f32_bf16 v118, v118, s56, 0
v_dot2_f32_bf16 v119, v119, s56, 0
v_pk_mul_f32 v[144:145], v[144:145], v[12:13] op_sel_hi:[1,0]
v_pk_mul_f32 v[148:149], v[148:149], v[12:13] op_sel_hi:[1,0]
v_pk_mul_f32 v[152:153], v[152:153], v[12:13] op_sel_hi:[1,0]
v_pk_mul_f32 v[156:157], v[156:157], v[12:13] op_sel_hi:[1,0]
v_pk_fma_f32 v[112:113], v[112:113], v[144:145], v[12:13] op_sel:[0,0,1] op_sel_hi:[1,1,1]
v_pk_fma_f32 v[114:115], v[114:115], v[148:149], v[12:13] op_sel:[0,0,1] op_sel_hi:[1,1,1]
v_pk_fma_f32 v[116:117], v[116:117], v[152:153], v[12:13] op_sel:[0,0,1] op_sel_hi:[1,1,1]
v_pk_fma_f32 v[118:119], v[118:119], v[156:157], v[12:13] op_sel:[0,0,1] op_sel_hi:[1,1,1]
v_cvt_pk_bf16_f32 v84, v112, v113
v_cvt_pk_bf16_f32 v85, v114, v115
v_cvt_pk_bf16_f32 v86, v116, v117
v_cvt_pk_bf16_f32 v87, v118, v119
ds_write_b128 v6, v[84:87] offset:1024
ds_write_b128 v20, v[68:71] offset:1024
s_waitcnt vmcnt(5)
L_stb2:
v_xor_b32 v14, s32, v163
v_bitop3_b32 v14, v167, s32, v14 bitop3:0xbe
v_bitop3_b32 v14, v171, s32, v14 bitop3:0xbe
v_bitop3_b32 v14, v175, s32, v14 bitop3:0xbe
v_cmp_ne_u32_e64 vcc, 0, v14
v_perm_b32 v104, v162, v72, s54
v_perm_b32 v105, v162, v72, s55
v_perm_b32 v106, v166, v73, s54
v_perm_b32 v107, v166, v73, s55
v_perm_b32 v108, v170, v74, s54
v_perm_b32 v109, v170, v74, s55
v_perm_b32 v110, v174, v75, s54
v_perm_b32 v111, v174, v75, s55
s_cbranch_vccnz L_stb2_again
v_dot2_f32_bf16 v104, v104, s56, 0
v_dot2_f32_bf16 v105, v105, s56, 0
s_nop 0
v_dot2_f32_bf16 v106, v106, s56, 0
v_dot2_f32_bf16 v107, v107, s56, 0
v_dot2_f32_bf16 v108, v108, s56, 0
v_dot2_f32_bf16 v109, v109, s56, 0
v_dot2_f32_bf16 v110, v110, s56, 0
v_dot2_f32_bf16 v111, v111, s56, 0
v_pk_mul_f32 v[160:161], v[160:161], v[12:13] op_sel_hi:[1,0]
v_pk_mul_f32 v[164:165], v[164:165], v[12:13] op_sel_hi:[1,0]
v_pk_mul_f32 v[168:169], v[168:169], v[12:13] op_sel_hi:[1,0]
v_pk_mul_f32 v[172:173], v[172:173], v[12:13] op_sel_hi:[1,0]
v_pk_fma_f32 v[104:105], v[104:105], v[160:161], v[12:13] op_sel:[0,0,1] op_sel_hi:[1,1,1]
v_pk_fma_f32 v[106:107], v[106:107], v[164:165], v[12:13] op_sel:[0,0,1] op_sel_hi:[1,1,1]
v_pk_fma_f32 v[108:109], v[108:109], v[168:169], v[12:13] op_sel:[0,0,1] op_sel_hi:[1,1,1]
v_pk_fma_f32 v[110:111], v[110:111], v[172:173], v[12:13] op_sel:[0,0,1] op_sel_hi:[1,1,1]
v_cvt_pk_bf16_f32 v88, v104, v105
v_cvt_pk_bf16_f32 v89, v106, v107
v_cvt_pk_bf16_f32 v90, v108, v109
v_cvt_pk_bf16_f32 v91, v110, v111
ds_write_b128 v6, v[88:91] offset:2048
ds_write_b128 v20, v[72:75] offset:2048
s_waitcnt vmcnt(0)
L_stb3:
v_xor_b32 v14, s32, v179
v_bitop3_b32 v14, v183, s32, v14 bitop3:0xbe
v_bitop3_b32 v14, v187, s32, v14 bitop3:0xbe
v_bitop3_b32 v14, v191, s32, v14 bitop3:0xbe
v_cmp_ne_u32_e64 vcc, 0, v14
v_perm_b32 v112, v178, v76, s54
v_perm_b32 v113, v178, v76, s55
v_perm_b32 v114, v182, v77, s54
v_perm_b32 v115, v182, v77, s55
v_perm_b32 v116, v186, v78, s54
v_perm_b32 v117, v186, v78, s55
v_perm_b32 v118, v190, v79, s54
v_perm_b32 v119, v190, v79, s55
s_cbranch_vccnz L_stb3_again
v_dot2_f32_bf16 v112, v112, s56, 0
v_dot2_f32_bf16 v113, v113, s56, 0
s_nop 0
v_dot2_f32_bf16 v114, v114, s56, 0
v_dot2_f32_bf16 v115, v115, s56, 0
v_dot2_f32_bf16 v116, v116, s56, 0
v_dot2_f32_bf16 v117, v117, s56, 0
v_dot2_f32_bf16 v118, v118, s56, 0
v_dot2_f32_bf16 v119, v119, s56, 0
v_pk_mul_f32 v[176:177], v[176:177], v[12:13] op_sel_hi:[1,0]
v_pk_mul_f32 v[180:181], v[180:181], v[12:13] op_sel_hi:[1,0]
v_pk_mul_f32 v[184:185], v[184:185], v[12:13] op_sel_hi:[1,0]
v_pk_mul_f32 v[188:189], v[188:189], v[12:13] op_sel_hi:[1,0]
v_pk_fma_f32 v[112:113], v[112:113], v[176:177], v[12:13] op_sel:[0,0,1] op_sel_hi:[1,1,1]
v_pk_fma_f32 v[114:115], v[114:115], v[180:181], v[12:13] op_sel:[0,0,1] op_sel_hi:[1,1,1]
v_pk_fma_f32 v[116:117], v[116:117], v[184:185], v[12:13] op_sel:[0,0,1] op_sel_hi:[1,1,1]
v_pk_fma_f32 v[118:119], v[118:119], v[188:189], v[12:13] op_sel:[0,0,1] op_sel_hi:[1,1,1]
v_cvt_pk_bf16_f32 v92, v112, v113
v_cvt_pk_bf16_f32 v93, v114, v115
v_cvt_pk_bf16_f32 v94, v116, v117
v_cvt_pk_bf16_f32 v95, v118, v119
ds_write_b128 v6, v[92:95] offset:3072
ds_write_b128 v20, v[76:79] offset:3072
s_branch L_join1
s_nop 0
L_stb0_again:
s_mov_b32 s53, 16384
buffer_load_dwordx4 v[128:131], v21, s[4:7], s53 offen offset:0 sc1
buffer_load_dwordx4 v[132:135], v21, s[4:7], s53 offen offset:16 sc1
buffer_load_dwordx4 v[136:139], v21, s[4:7], s53 offen offset:32 sc1
buffer_load_dwordx4 v[140:143], v21, s[4:7], s53 offen offset:48 sc1
s_add_u32 s70, s70, 1
s_cmp_lt_u32 s70, 2097152
s_waitcnt vmcnt(0)
s_cbranch_scc1 L_stb0
s_branch L_join1
L_stb1_again:
s_mov_b32 s53, 20480
buffer_load_dwordx4 v[144:147], v21, s[4:7], s53 offen offset:0 sc1
buffer_load_dwordx4 v[148:151], v21, s[4:7], s53 offen offset:16 sc1
buffer_load_dwordx4 v[152:155], v21, s[4:7], s53 offen offset:32 sc1
buffer_load_dwordx4 v[156:159], v21, s[4:7], s53 offen offset:48 sc1
s_add_u32 s70, s70, 1
s_cmp_lt_u32 s70, 2097152
s_waitcnt vmcnt(0)
s_cbranch_scc1 L_stb1
s_branch L_join1
L_stb2_again:
s_mov_b32 s53, 24576
buffer_load_dwordx4 v[160:163], v21, s[4:7], s53 offen offset:0 sc1
buffer_load_dwordx4 v[164:167], v21, s[4:7], s53 offen offset:16 sc1
buffer_load_dwordx4 v[168:171], v21, s[4:7], s53 offen offset:32 sc1
buffer_load_dwordx4 v[172:175], v21, s[4:7], s53 offen offset:48 sc1
s_add_u32 s70, s70, 1
s_cmp_lt_u32 s70, 2097152
s_waitcnt vmcnt(0)
s_cbranch_scc1 L_stb2
s_branch L_join1
L_stb3_again:
s_mov_b32 s53, 28672
buffer_load_dwordx4 v[176:179], v21, s[4:7], s53 offen offset:0 sc1
buffer_load_dwordx4 v[180:183], v21, s[4:7], s53 offen offset:16 sc1
buffer_load_dwordx4 v[184:187], v21, s[4:7], s53 offen offset:32 sc1
buffer_load_dwordx4 v[188:191], v21, s[4:7], s53 offen offset:48 sc1
s_add_u32 s70, s70, 1
s_cmp_lt_u32 s70, 2097152
s_waitcnt vmcnt(0)
s_cbranch_scc1 L_stb3
s_branch L_join1

.p2align 12
L_kgenb:
s_mul_i32 s55, s53, 16640
s_mul_i32 s56, s53, 4672
s_add_u32 s56, s56, 33280
s_mul_i32 s57, s53, 33280
s_add_u32 s57, s57, 42624
v_mov_b32 v14, 0
v_mov_b32 v15, 0
v_lshl_add_u32 v16, v1, 3, s56
ds_write_b64 v16, v[14:15]
v_bfe_u32 v16, v1, 3, 2
v_mul_u32_u24 v16, 4160, v16
v_and_b32 v17, 7, v1
v_lshl_add_u32 v16, v17, 2, v16
v_add_u32 v16, s55, v16
ds_write_b32 v16, v14
v_add_u32 v18, s57, v2
v_and_b32 v16, 31, v1
v_mul_u32_u24 v19, 1040, v16
v_lshrrev_b32_e64 v16, 5, v1
v_lshl_add_u32 v19, v16, 5, v19
v_add_u32 v19, s57, v19
v_add_u32 v20, s55, v2
v_add_u32 v192, 8348, v20
v_add_u32 v196, 12508, v20
v_add_u32 v193, 9372, v20
v_add_u32 v197, 13532, v20
v_add_u32 v194, 10396, v20
v_add_u32 v198, 14556, v20
v_add_u32 v195, 11420, v20
v_add_u32 v199, 15580, v20
v_mul_u32_u24 v200, 1088, v4
v_lshrrev_b32_e64 v16, 2, v3
v_mul_u32_u24 v16, 272, v16
v_add_u32 v200, v200, v16
v_and_b32 v16, 1, v1
v_mul_u32_u24 v16, 8832, v16
v_add_u32 v200, v200, v16
v_and_b32 v16, 2, v1
v_lshl_add_u32 v200, v16, 2, v200
s_mul_i32 s87, s53, 80
s_add_u32 s87, s87, 109184
v_add_u32_e64 v200, s87, v200
s_and_b32 s88, s100, 15
s_lshr_b32 s89, s100, 4
s_mul_i32 s87, s53, 5
s_mul_i32 s88, s88, 11
s_add_u32 s88, s88, s87
s_lshl_b32 s88, s88, 4
s_add_u32 s88, s88, s89
s_lshl_b32 s87, s88, 10
s_add_u32 s87, s87, 5242880
s_lshl_b32 s88, s88, 7
s_add_u32 s88, s88, 262144
v_cmp_eq_u32 vcc, 0, v3
v_mov_b32 v208, 0x3f803f80
v_and_b32 v201, 9, v3
v_cndmask_b32 v204, 0, v208, vcc
v_cndmask_b32 v205, 0, v208, vcc
v_cndmask_b32 v206, 0, v208, vcc
v_cndmask_b32 v207, 0, v208, vcc
v_and_b32 v16, 2, v3
v_lshl_add_u32 v201, v16, 1, v201
v_bfe_u32 v16, v3, 2, 1
v_lshl_add_u32 v201, v16, 1, v201
v_lshlrev_b32 v201, 3, v201
s_cmp_eq_u32 s53, 1
s_cselect_b32 s72, 0xcc00cc00, 0
s_cselect_b32 s74, 0x04000400, 0
s_mov_b32 s73, s72
s_mov_b32 s75, s74
s_mov_b32 s90, 0x00020002
s_mov_b32 s91, 0x00020002
v_lshlrev_b32 v202, 5, v4
v_add_u32 v202, 131584, v202
v_lshlrev_b32 v203, 4, v4
v_add_u32 v203, 131712, v203
v_mov_b32 v209, 131072
s_mov_b64 exec, 0
s_branch L_pad_k_0
s_nop 0
L_ret_k:
s_mov_b64 exec, -1
L_pad_k_0:
s_cbranch_execz L_pad_k_1
s_waitcnt vmcnt(0)
v_lshlrev_b32 v12, 16, v12
v_lshlrev_b32 v32, 16, v8
v_and_b32 v33, 0xffff0000, v8
v_lshlrev_b32 v36, 16, v10
v_and_b32 v38, 0xffff0000, v10
v_lshlrev_b32 v37, 16, v11
v_and_b32 v39, 0xffff0000, v11
v_max_f32 v21, |v36|, |v38|
v_max3_f32 v21, |v37|, |v39|, v21
v_mul_f32 v22, 0x3fb8aa00, v12
v_mul_f32 v23, 0x3fb8aa00, v32
v_mul_f32 v24, 0x3fb8aa00, v33
v_max_f32_dpp v21, v21, v21 row_ror:8 row_mask:0xf bank_mask:0xf
v_exp_f32 v22, v22
v_exp_f32 v23, v23
v_exp_f32_e64 v24, v24
v_max_f32_dpp v21, v21, v21 row_ror:4 row_mask:0xf bank_mask:0xf
v_mul_f32 v25, 0x36a407db, v12
v_mul_f32 v26, 0x36a407db, v32
v_mul_f32 v27, 0x36a407db, v33
v_max_f32_dpp v21, v21, v21 row_ror:2 row_mask:0xf bank_mask:0xf
v_fma_f32 v22, v22, v25, v22
v_fma_f32 v23, v23, v26, v23
v_fma_f32 v24, v24, v27, v24
v_max_f32_dpp v21, v21, v21 row_ror:1 row_mask:0xf bank_mask:0xf
v_cvt_pk_bf16_f32 v22, v22, v22
v_and_b32 v22, 0xffff0000, v22
v_cvt_pk_bf16_f32 v23, v23, v23
v_and_b32 v23, 0xffff0000, v23
v_cvt_pk_bf16_f32 v24, v24, v24
v_and_b32 v24, 0xffff0000, v24
v_mov_b32 v28, v21
v_lshlrev_b32 v34, 16, v9
v_and_b32 v35, 0xffff0000, v9
v_permlane32_swap_b32 v21, v28
v_mul_f32 v32, v23, v22
v_mul_f32 v34, v34, v22
v_mul_f32 v33, v24, v22
v_mul_f32 v35, v35, v22
v_max_f32 v21, v21, v28
v_mov_b32 v28, v21
v_mul_f32 v32, 0xbfb8aa3b, v32
v_mul_f32 v34, 0x3e22f983, v34
v_mul_f32 v33, 0xbfb8aa3b, v33
v_mul_f32 v35, 0x3e22f983, v35
v_permlane16_swap_b32 v21, v28
v_max_f32 v21, v21, v28
v_frexp_exp_i32_f32 v21, v21
v_sub_u32_e64 v28, 14, v21
v_ldexp_f32 v36, v36, v28
v_ldexp_f32 v37, -v37, v28
v_ldexp_f32 v38, v38, v28
v_ldexp_f32 v39, -v39, v28
v_subrev_u32_e64 v21, 27, v21
v_ldexp_f32 v29, v22, v21
v_mul_f32 v52, 0x41000000, v32
v_mul_f32 v54, 0x41000000, v34
v_exp_f32 v52, v52
v_fract_f32 v54, v54
v_cos_f32 v40, v54
v_sin_f32 v41, v54
v_mul_f32 v53, 0x41000000, v33
v_mul_f32 v55, 0x41000000, v35
v_exp_f32 v53, v53
v_fract_f32 v55, v55
v_cos_f32 v42, v55
v_sin_f32 v43, v55
v_mul_f32 v40, v40, v52
v_mul_f32 v41, v41, v52
v_mul_f32 v42, v42, v53
v_mul_f32 v43, v43, v53
v_exp_f32 v52, v32
v_fract_f32 v54, v34
v_cos_f32 v44, v54
v_sin_f32 v45, v54
v_exp_f32 v53, v33
v_fract_f32 v55, v35
v_cos_f32 v46, v55
v_sin_f32 v47, v55
v_mul_f32 v44, v44, v52
v_mul_f32 v45, v45, v52
v_mul_f32 v46, v46, v53
v_mul_f32 v47, v47, v53
v_mul_f32 v52, 0x43800000, v32
v_mul_f32 v54, 0x43800000, v34
v_exp_f32 v52, v52
v_fract_f32 v54, v54
v_cos_f32 v48, v54
v_sin_f32 v49, v54
v_mul_f32 v53, 0x43800000, v33
v_mul_f32 v55, 0x43800000, v35
v_exp_f32 v53, v53
v_fract_f32 v55, v55
v_cos_f32 v50, v55
v_sin_f32 v51, v55
v_mul_f32 v48, v48, v52
v_mul_f32 v49, v49, v52
v_mul_f32_e64 v50, v50, v53
v_mul_f32_e64 v51, v51, v53
v_mov_b32 v172, 0x46800000
v_mov_b32_e64 v173, 0
v_mov_b32 v174, 0x46800000
v_mov_b32_e64 v175, 0
v_cvt_pk_f16_f32 v58, v172, v173
v_cvt_pk_f16_f32 v59, v174, v175
v_cvt_pk_f16_f32 v56, v36, v37
v_cvt_pk_f16_f32 v57, v38, v39
ds_write_b128 v18, v[56:59] offset:0
v_pk_mul_f32 v[176:177], v[172:173], v[40:41] op_sel:[0,0] op_sel_hi:[1,0]
v_pk_mul_f32 v[178:179], v[174:175], v[42:43] op_sel:[0,0] op_sel_hi:[1,0]
v_pk_mul_f32 v[180:181], v[36:37], v[44:45] op_sel:[0,0] op_sel_hi:[1,0]
v_pk_mul_f32 v[182:183], v[38:39], v[46:47] op_sel:[0,0] op_sel_hi:[1,0]
v_pk_fma_f32 v[172:173], v[172:173], v[40:41], v[176:177] op_sel:[1,1,0] op_sel_hi:[0,1,1] neg_lo:[1,0,0]
v_pk_fma_f32 v[174:175], v[174:175], v[42:43], v[178:179] op_sel:[1,1,0] op_sel_hi:[0,1,1] neg_lo:[1,0,0]
v_pk_fma_f32 v[64:65], v[36:37], v[44:45], v[180:181] op_sel:[1,1,0] op_sel_hi:[0,1,1] neg_hi:[1,0,0]
v_pk_fma_f32 v[66:67], v[38:39], v[46:47], v[182:183] op_sel:[1,1,0] op_sel_hi:[0,1,1] neg_hi:[1,0,0]
v_cvt_pk_f16_f32 v62, v172, v173
v_cvt_pk_f16_f32 v63, v174, v175
v_cvt_pk_f16_f32 v60, v64, v65
v_cvt_pk_f16_f32 v61, v66, v67
ds_write_b128 v18, v[60:63] offset:1040
v_pk_mul_f32 v[176:177], v[172:173], v[40:41] op_sel:[0,0] op_sel_hi:[1,0]
v_pk_mul_f32 v[178:179], v[174:175], v[42:43] op_sel:[0,0] op_sel_hi:[1,0]
v_pk_mul_f32 v[180:181], v[64:65], v[44:45] op_sel:[0,0] op_sel_hi:[1,0]
v_pk_mul_f32 v[182:183], v[66:67], v[46:47] op_sel:[0,0] op_sel_hi:[1,0]
v_pk_fma_f32 v[172:173], v[172:173], v[40:41], v[176:177] op_sel:[1,1,0] op_sel_hi:[0,1,1] neg_lo:[1,0,0]
v_pk_fma_f32 v[174:175], v[174:175], v[42:43], v[178:179] op_sel:[1,1,0] op_sel_hi:[0,1,1] neg_lo:[1,0,0]
v_pk_fma_f32 v[68:69], v[64:65], v[44:45], v[180:181] op_sel:[1,1,0] op_sel_hi:[0,1,1] neg_hi:[1,0,0]
v_pk_fma_f32 v[70:71], v[66:67], v[46:47], v[182:183] op_sel:[1,1,0] op_sel_hi:[0,1,1] neg_hi:[1,0,0]
v_cvt_pk_f16_f32 v186, v172, v173
v_cvt_pk_f16_f32 v187, v174, v175
v_cvt_pk_f16_f32 v184, v68, v69
v_cvt_pk_f16_f32 v185, v70, v71
ds_write_b128 v18, v[184:187] offset:2080
v_pk_mul_f32 v[176:177], v[172:173], v[40:41] op_sel:[0,0] op_sel_hi:[1,0]
v_pk_mul_f32 v[178:179], v[174:175], v[42:43] op_sel:[0,0] op_sel_hi:[1,0]
v_pk_mul_f32 v[180:181], v[68:69], v[44:45] op_sel:[0,0] op_sel_hi:[1,0]
v_pk_mul_f32 v[182:183], v[70:71], v[46:47] op_sel:[0,0] op_sel_hi:[1,0]
v_pk_fma_f32 v[172:173], v[172:173], v[40:41], v[176:177] op_sel:[1,1,0] op_sel_hi:[0,1,1] neg_lo:[1,0,0]
v_pk_fma_f32 v[174:175], v[174:175], v[42:43], v[178:179] op_sel:[1,1,0] op_sel_hi:[0,1,1] neg_lo:[1,0,0]
v_pk_fma_f32 v[72:73], v[68:69], v[44:45], v[180:181] op_sel:[1,1,0] op_sel_hi:[0,1,1] neg_hi:[1,0,0]
v_pk_fma_f32 v[74:75], v[70:71], v[46:47], v[182:183] op_sel:[1,1,0] op_sel_hi:[0,1,1] neg_hi:[1,0,0]
v_cvt_pk_f16_f32 v190, v172, v173
v_cvt_pk_f16_f32 v191, v174, v175
v_cvt_pk_f16_f32 v188, v72, v73
v_cvt_pk_f16_f32 v189, v74, v75
ds_write_b128 v18, v[188:191] offset:3120
v_pk_mul_f32 v[176:177], v[172:173], v[40:41] op_sel:[0,0] op_sel_hi:[1,0]
v_pk_mul_f32 v[178:179], v[174:175], v[42:43] op_sel:[0,0] op_sel_hi:[1,0]
v_pk_mul_f32 v[180:181], v[36:37], v[48:49] op_sel:[0,0] op_sel_hi:[1,0]
v_pk_mul_f32 v[182:183], v[38:39], v[50:51] op_sel:[0,0] op_sel_hi:[1,0]
v_pk_fma_f32 v[172:173], v[172:173], v[40:41], v[176:177] op_sel:[1,1,0] op_sel_hi:[0,1,1] neg_lo:[1,0,0]
v_pk_fma_f32 v[174:175], v[174:175], v[42:43], v[178:179] op_sel:[1,1,0] op_sel_hi:[0,1,1] neg_lo:[1,0,0]
v_pk_fma_f32 v[76:77], v[36:37], v[48:49], v[180:181] op_sel:[1,1,0] op_sel_hi:[0,1,1] neg_hi:[1,0,0]
v_pk_fma_f32 v[78:79], v[38:39], v[50:51], v[182:183] op_sel:[1,1,0] op_sel_hi:[0,1,1] neg_hi:[1,0,0]
v_cvt_pk_f16_f32 v58, v172, v173
v_cvt_pk_f16_f32 v59, v174, v175
v_cvt_pk_f16_f32 v56, v76, v77
v_cvt_pk_f16_f32 v57, v78, v79
ds_write_b128 v18, v[56:59] offset:4160
v_pk_mul_f32 v[176:177], v[172:173], v[40:41] op_sel:[0,0] op_sel_hi:[1,0]
v_pk_mul_f32 v[178:179], v[174:175], v[42:43] op_sel:[0,0] op_sel_hi:[1,0]
v_pk_mul_f32 v[180:181], v[72:73], v[44:45] op_sel:[0,0] op_sel_hi:[1,0]
v_pk_mul_f32 v[182:183], v[74:75], v[46:47] op_sel:[0,0] op_sel_hi:[1,0]
v_pk_fma_f32 v[172:173], v[172:173], v[40:41], v[176:177] op_sel:[1,1,0] op_sel_hi:[0,1,1] neg_lo:[1,0,0]
v_pk_fma_f32 v[174:175], v[174:175], v[42:43], v[178:179] op_sel:[1,1,0] op_sel_hi:[0,1,1] neg_lo:[1,0,0]
v_pk_fma_f32 v[80:81], v[72:73], v[44:45], v[180:181] op_sel:[1,1,0] op_sel_hi:[0,1,1] neg_hi:[1,0,0]
v_pk_fma_f32 v[82:83], v[74:75], v[46:47], v[182:183] op_sel:[1,1,0] op_sel_hi:[0,1,1] neg_hi:[1,0,0]
v_cvt_pk_f16_f32 v62, v172, v173
v_cvt_pk_f16_f32 v63, v174, v175
v_cvt_pk_f16_f32 v60, v76, v77
v_cvt_pk_f16_f32 v61, v78, v79
ds_write_b128 v18, v[60:63] offset:5200
v_pk_mul_f32 v[176:177], v[172:173], v[40:41] op_sel:[0,0] op_sel_hi:[1,0]
v_pk_mul_f32 v[178:179], v[174:175], v[42:43] op_sel:[0,0] op_sel_hi:[1,0]
v_pk_mul_f32 v[180:181], v[68:69], v[48:49] op_sel:[0,0] op_sel_hi:[1,0]
v_pk_mul_f32 v[182:183], v[70:71], v[50:51] op_sel:[0,0] op_sel_hi:[1,0]
v_pk_fma_f32 v[172:173], v[172:173], v[40:41], v[176:177] op_sel:[1,1,0] op_sel_hi:[0,1,1] neg_lo:[1,0,0]
v_pk_fma_f32 v[174:175], v[174:175], v[42:43], v[178:179] op_sel:[1,1,0] op_sel_hi:[0,1,1] neg_lo:[1,0,0]
v_pk_fma_f32 v[84:85], v[68:69], v[48:49], v[180:181] op_sel:[1,1,0] op_sel_hi:[0,1,1] neg_hi:[1,0,0]
v_pk_fma_f32 v[86:87], v[70:71], v[50:51], v[182:183] op_sel:[1,1,0] op_sel_hi:[0,1,1] neg_hi:[1,0,0]
v_cvt_pk_f16_f32 v186, v172, v173
v_cvt_pk_f16_f32 v187, v174, v175
v_cvt_pk_f16_f32 v184, v84, v85
v_cvt_pk_f16_f32 v185, v86, v87
ds_write_b128 v18, v[184:187] offset:6240
v_pk_mul_f32 v[176:177], v[172:173], v[40:41] op_sel:[0,0] op_sel_hi:[1,0]
v_pk_mul_f32 v[178:179], v[174:175], v[42:43] op_sel:[0,0] op_sel_hi:[1,0]
v_pk_mul_f32 v[180:181], v[80:81], v[48:49] op_sel:[0,0] op_sel_hi:[1,0]
v_pk_mul_f32 v[182:183], v[82:83], v[50:51] op_sel:[0,0] op_sel_hi:[1,0]
v_pk_fma_f32 v[172:173], v[172:173], v[40:41], v[176:177] op_sel:[1,1,0] op_sel_hi:[0,1,1] neg_lo:[1,0,0]
v_pk_fma_f32 v[174:175], v[174:175], v[42:43], v[178:179] op_sel:[1,1,0] op_sel_hi:[0,1,1] neg_lo:[1,0,0]
v_pk_fma_f32 v[88:89], v[80:81], v[48:49], v[180:181] op_sel:[1,1,0] op_sel_hi:[0,1,1] neg_hi:[1,0,0]
v_pk_fma_f32 v[90:91], v[82:83], v[50:51], v[182:183] op_sel:[1,1,0] op_sel_hi:[0,1,1] neg_hi:[1,0,0]
v_cvt_pk_f16_f32 v190, v172, v173
v_cvt_pk_f16_f32 v191, v174, v175
v_cvt_pk_f16_f32 v188, v88, v89
v_cvt_pk_f16_f32 v189, v90, v91
ds_write_b128 v18, v[188:191] offset:7280
v_pk_mul_f32 v[176:177], v[172:173], v[40:41] op_sel:[0,0] op_sel_hi:[1,0]
v_pk_mul_f32 v[178:179], v[174:175], v[42:43] op_sel:[0,0] op_sel_hi:[1,0]
v_pk_mul_f32 v[180:181], v[80:81], v[44:45] op_sel:[0,0] op_sel_hi:[1,0]
v_pk_mul_f32 v[182:183], v[82:83], v[46:47] op_sel:[0,0] op_sel_hi:[1,0]
v_pk_fma_f32 v[172:173], v[172:173], v[40:41], v[176:177] op_sel:[1,1,0] op_sel_hi:[0,1,1] neg_lo:[1,0,0]
v_pk_fma_f32 v[174:175], v[174:175], v[42:43], v[178:179] op_sel:[1,1,0] op_sel_hi:[0,1,1] neg_lo:[1,0,0]
v_pk_fma_f32 v[92:93], v[80:81], v[44:45], v[180:181] op_sel:[1,1,0] op_sel_hi:[0,1,1] neg_hi:[1,0,0]
v_pk_fma_f32 v[94:95], v[82:83], v[46:47], v[182:183] op_sel:[1,1,0] op_sel_hi:[0,1,1] neg_hi:[1,0,0]
v_cvt_pk_f16_f32 v58, v172, v173
v_cvt_pk_f16_f32 v59, v174, v175
v_cvt_pk_f16_f32 v56, v80, v81
v_cvt_pk_f16_f32 v57, v82, v83
ds_write_b128 v18, v[56:59] offset:8320
v_pk_mul_f32 v[176:177], v[172:173], v[40:41] op_sel:[0,0] op_sel_hi:[1,0]
v_pk_mul_f32 v[178:179], v[174:175], v[42:43] op_sel:[0,0] op_sel_hi:[1,0]
v_pk_mul_f32 v[180:181], v[92:93], v[44:45] op_sel:[0,0] op_sel_hi:[1,0]
v_pk_mul_f32 v[182:183], v[94:95], v[46:47] op_sel:[0,0] op_sel_hi:[1,0]
v_pk_fma_f32 v[172:173], v[172:173], v[40:41], v[176:177] op_sel:[1,1,0] op_sel_hi:[0,1,1] neg_lo:[1,0,0]
v_pk_fma_f32 v[174:175], v[174:175], v[42:43], v[178:179] op_sel:[1,1,0] op_sel_hi:[0,1,1] neg_lo:[1,0,0]
v_pk_fma_f32 v[96:97], v[92:93], v[44:45], v[180:181] op_sel:[1,1,0] op_sel_hi:[0,1,1] neg_hi:[1,0,0]
v_pk_fma_f32 v[98:99], v[94:95], v[46:47], v[182:183] op_sel:[1,1,0] op_sel_hi:[0,1,1] neg_hi:[1,0,0]
v_cvt_pk_f16_f32 v62, v172, v173
v_cvt_pk_f16_f32 v63, v174, v175
v_cvt_pk_f16_f32 v60, v92, v93
v_cvt_pk_f16_f32 v61, v94, v95
ds_write_b128 v18, v[60:63] offset:9360
v_pk_mul_f32 v[176:177], v[172:173], v[40:41] op_sel:[0,0] op_sel_hi:[1,0]
v_pk_mul_f32 v[178:179], v[174:175], v[42:43] op_sel:[0,0] op_sel_hi:[1,0]
v_pk_mul_f32 v[180:181], v[96:97], v[44:45] op_sel:[0,0] op_sel_hi:[1,0]
v_pk_mul_f32 v[182:183], v[98:99], v[46:47] op_sel:[0,0] op_sel_hi:[1,0]
v_pk_fma_f32 v[172:173], v[172:173], v[40:41], v[176:177] op_sel:[1,1,0] op_sel_hi:[0,1,1] neg_lo:[1,0,0]
v_pk_fma_f32 v[174:175], v[174:175], v[42:43], v[178:179] op_sel:[1,1,0] op_sel_hi:[0,1,1] neg_lo:[1,0,0]
v_pk_fma_f32 v[100:101], v[96:97], v[44:45], v[180:181] op_sel:[1,1,0] op_sel_hi:[0,1,1] neg_hi:[1,0,0]
v_pk_fma_f32 v[102:103], v[98:99], v[46:47], v[182:183] op_sel:[1,1,0] op_sel_hi:[0,1,1] neg_hi:[1,0,0]
v_cvt_pk_f16_f32 v186, v172, v173
v_cvt_pk_f16_f32 v187, v174, v175
v_cvt_pk_f16_f32 v184, v96, v97
v_cvt_pk_f16_f32 v185, v98, v99
ds_write_b128 v18, v[184:187] offset:10400
v_pk_mul_f32 v[176:177], v[172:173], v[40:41] op_sel:[0,0] op_sel_hi:[1,0]
v_pk_mul_f32 v[178:179], v[174:175], v[42:43] op_sel:[0,0] op_sel_hi:[1,0]
v_pk_mul_f32 v[180:181], v[100:101], v[44:45] op_sel:[0,0] op_sel_hi:[1,0]
v_pk_mul_f32 v[182:183], v[102:103], v[46:47] op_sel:[0,0] op_sel_hi:[1,0]
v_pk_fma_f32 v[172:173], v[172:173], v[40:41], v[176:177] op_sel:[1,1,0] op_sel_hi:[0,1,1] neg_lo:[1,0,0]
v_pk_fma_f32 v[174:175], v[174:175], v[42:43], v[178:179] op_sel:[1,1,0] op_sel_hi:[0,1,1] neg_lo:[1,0,0]
v_pk_fma_f32 v[104:105], v[100:101], v[44:45], v[180:181] op_sel:[1,1,0] op_sel_hi:[0,1,1] neg_hi:[1,0,0]
v_pk_fma_f32 v[106:107], v[102:103], v[46:47], v[182:183] op_sel:[1,1,0] op_sel_hi:[0,1,1] neg_hi:[1,0,0]
v_cvt_pk_f16_f32 v190, v172, v173
v_cvt_pk_f16_f32 v191, v174, v175
v_cvt_pk_f16_f32 v188, v100, v101
v_cvt_pk_f16_f32 v189, v102, v103
ds_write_b128 v18, v[188:191] offset:11440
v_pk_mul_f32 v[176:177], v[172:173], v[40:41] op_sel:[0,0] op_sel_hi:[1,0]
v_pk_mul_f32 v[178:179], v[174:175], v[42:43] op_sel:[0,0] op_sel_hi:[1,0]
v_pk_mul_f32 v[180:181], v[96:97], v[48:49] op_sel:[0,0] op_sel_hi:[1,0]
v_pk_mul_f32 v[182:183], v[98:99], v[50:51] op_sel:[0,0] op_sel_hi:[1,0]
v_pk_fma_f32 v[172:173], v[172:173], v[40:41], v[176:177] op_sel:[1,1,0] op_sel_hi:[0,1,1] neg_lo:[1,0,0]
v_pk_fma_f32 v[174:175], v[174:175], v[42:43], v[178:179] op_sel:[1,1,0] op_sel_hi:[0,1,1] neg_lo:[1,0,0]
v_pk_fma_f32 v[108:109], v[96:97], v[48:49], v[180:181] op_sel:[1,1,0] op_sel_hi:[0,1,1] neg_hi:[1,0,0]
v_pk_fma_f32 v[110:111], v[98:99], v[50:51], v[182:183] op_sel:[1,1,0] op_sel_hi:[0,1,1] neg_hi:[1,0,0]
v_cvt_pk_f16_f32 v58, v172, v173
v_cvt_pk_f16_f32 v59, v174, v175
v_cvt_pk_f16_f32 v56, v88, v89
v_cvt_pk_f16_f32 v57, v90, v91
ds_write_b128 v18, v[56:59] offset:12480
v_pk_mul_f32 v[176:177], v[172:173], v[40:41] op_sel:[0,0] op_sel_hi:[1,0]
v_pk_mul_f32 v[178:179], v[174:175], v[42:43] op_sel:[0,0] op_sel_hi:[1,0]
v_pk_mul_f32 v[180:181], v[104:105], v[48:49] op_sel:[0,0] op_sel_hi:[1,0]
v_pk_mul_f32 v[182:183], v[106:107], v[50:51] op_sel:[0,0] op_sel_hi:[1,0]
v_pk_fma_f32 v[172:173], v[172:173], v[40:41], v[176:177] op_sel:[1,1,0] op_sel_hi:[0,1,1] neg_lo:[1,0,0]
v_pk_fma_f32 v[174:175], v[174:175], v[42:43], v[178:179] op_sel:[1,1,0] op_sel_hi:[0,1,1] neg_lo:[1,0,0]
v_pk_fma_f32 v[112:113], v[104:105], v[48:49], v[180:181] op_sel:[1,1,0] op_sel_hi:[0,1,1] neg_hi:[1,0,0]
v_pk_fma_f32 v[114:115], v[106:107], v[50:51], v[182:183] op_sel:[1,1,0] op_sel_hi:[0,1,1] neg_hi:[1,0,0]
v_cvt_pk_f16_f32 v62, v172, v173
v_cvt_pk_f16_f32 v63, v174, v175
v_cvt_pk_f16_f32 v60, v88, v89
v_cvt_pk_f16_f32 v61, v90, v91
ds_write_b128 v18, v[60:63] offset:13520
v_pk_mul_f32 v[176:177], v[172:173], v[40:41] op_sel:[0,0] op_sel_hi:[1,0]
v_pk_mul_f32 v[178:179], v[174:175], v[42:43] op_sel:[0,0] op_sel_hi:[1,0]
v_pk_mul_f32 v[180:181], v[76:77], v[48:49] op_sel:[0,0] op_sel_hi:[1,0]
v_pk_mul_f32 v[182:183], v[78:79], v[50:51] op_sel:[0,0] op_sel_hi:[1,0]
v_pk_fma_f32 v[172:173], v[172:173], v[40:41], v[176:177] op_sel:[1,1,0] op_sel_hi:[0,1,1] neg_lo:[1,0,0]
v_pk_fma_f32 v[174:175], v[174:175], v[42:43], v[178:179] op_sel:[1,1,0] op_sel_hi:[0,1,1] neg_lo:[1,0,0]
v_pk_fma_f32 v[116:117], v[76:77], v[48:49], v[180:181] op_sel:[1,1,0] op_sel_hi:[0,1,1] neg_hi:[1,0,0]
v_pk_fma_f32 v[118:119], v[78:79], v[50:51], v[182:183] op_sel:[1,1,0] op_sel_hi:[0,1,1] neg_hi:[1,0,0]
v_cvt_pk_f16_f32 v186, v172, v173
v_cvt_pk_f16_f32 v187, v174, v175
v_cvt_pk_f16_f32 v184, v108, v109
v_cvt_pk_f16_f32 v185, v110, v111
ds_write_b128 v18, v[184:187] offset:14560
v_pk_mul_f32 v[176:177], v[172:173], v[40:41] op_sel:[0,0] op_sel_hi:[1,0]
v_pk_mul_f32 v[178:179], v[174:175], v[42:43] op_sel:[0,0] op_sel_hi:[1,0]
v_pk_mul_f32 v[180:181], v[88:89], v[48:49] op_sel:[0,0] op_sel_hi:[1,0]
v_pk_mul_f32 v[182:183], v[90:91], v[50:51] op_sel:[0,0] op_sel_hi:[1,0]
v_pk_fma_f32 v[172:173], v[172:173], v[40:41], v[176:177] op_sel:[1,1,0] op_sel_hi:[0,1,1] neg_lo:[1,0,0]
v_pk_fma_f32 v[174:175], v[174:175], v[42:43], v[178:179] op_sel:[1,1,0] op_sel_hi:[0,1,1] neg_lo:[1,0,0]
v_pk_fma_f32 v[120:121], v[88:89], v[48:49], v[180:181] op_sel:[1,1,0] op_sel_hi:[0,1,1] neg_hi:[1,0,0]
v_pk_fma_f32 v[122:123], v[90:91], v[50:51], v[182:183] op_sel:[1,1,0] op_sel_hi:[0,1,1] neg_hi:[1,0,0]
v_cvt_pk_f16_f32 v190, v172, v173
v_cvt_pk_f16_f32 v191, v174, v175
v_cvt_pk_f16_f32 v188, v112, v113
v_cvt_pk_f16_f32 v189, v114, v115
ds_write_b128 v18, v[188:191] offset:15600
v_pk_mul_f32 v[176:177], v[172:173], v[40:41] op_sel:[0,0] op_sel_hi:[1,0]
v_pk_mul_f32 v[178:179], v[174:175], v[42:43] op_sel:[0,0] op_sel_hi:[1,0]
v_pk_mul_f32 v[180:181], v[112:113], v[48:49] op_sel:[0,0] op_sel_hi:[1,0]
v_pk_mul_f32 v[182:183], v[114:115], v[50:51] op_sel:[0,0] op_sel_hi:[1,0]
v_pk_fma_f32 v[172:173], v[172:173], v[40:41], v[176:177] op_sel:[1,1,0] op_sel_hi:[0,1,1] neg_lo:[1,0,0]
v_pk_fma_f32 v[174:175], v[174:175], v[42:43], v[178:179] op_sel:[1,1,0] op_sel_hi:[0,1,1] neg_lo:[1,0,0]
v_pk_fma_f32 v[124:125], v[112:113], v[48:49], v[180:181] op_sel:[1,1,0] op_sel_hi:[0,1,1] neg_hi:[1,0,0]
v_pk_fma_f32 v[126:127], v[114:115], v[50:51], v[182:183] op_sel:[1,1,0] op_sel_hi:[0,1,1] neg_hi:[1,0,0]
v_cvt_pk_f16_f32 v58, v172, v173
v_cvt_pk_f16_f32 v59, v174, v175
v_cvt_pk_f16_f32 v56, v104, v105
v_cvt_pk_f16_f32 v57, v106, v107
ds_write_b128 v18, v[56:59] offset:16640
v_pk_mul_f32 v[176:177], v[172:173], v[40:41] op_sel:[0,0] op_sel_hi:[1,0]
v_pk_mul_f32 v[178:179], v[174:175], v[42:43] op_sel:[0,0] op_sel_hi:[1,0]
v_pk_mul_f32 v[180:181], v[116:117], v[48:49] op_sel:[0,0] op_sel_hi:[1,0]
v_pk_mul_f32 v[182:183], v[118:119], v[50:51] op_sel:[0,0] op_sel_hi:[1,0]
v_pk_fma_f32 v[172:173], v[172:173], v[40:41], v[176:177] op_sel:[1,1,0] op_sel_hi:[0,1,1] neg_lo:[1,0,0]
v_pk_fma_f32 v[174:175], v[174:175], v[42:43], v[178:179] op_sel:[1,1,0] op_sel_hi:[0,1,1] neg_lo:[1,0,0]
v_pk_fma_f32 v[128:129], v[116:117], v[48:49], v[180:181] op_sel:[1,1,0] op_sel_hi:[0,1,1] neg_hi:[1,0,0]
v_pk_fma_f32 v[130:131], v[118:119], v[50:51], v[182:183] op_sel:[1,1,0] op_sel_hi:[0,1,1] neg_hi:[1,0,0]
v_cvt_pk_f16_f32 v62, v172, v173
v_cvt_pk_f16_f32 v63, v174, v175
v_cvt_pk_f16_f32 v60, v116, v117
v_cvt_pk_f16_f32 v61, v118, v119
ds_write_b128 v18, v[60:63] offset:17680
v_pk_mul_f32 v[176:177], v[172:173], v[40:41] op_sel:[0,0] op_sel_hi:[1,0]
v_pk_mul_f32 v[178:179], v[174:175], v[42:43] op_sel:[0,0] op_sel_hi:[1,0]
v_pk_mul_f32 v[180:181], v[120:121], v[48:49] op_sel:[0,0] op_sel_hi:[1,0]
v_pk_mul_f32 v[182:183], v[122:123], v[50:51] op_sel:[0,0] op_sel_hi:[1,0]
v_pk_fma_f32 v[172:173], v[172:173], v[40:41], v[176:177] op_sel:[1,1,0] op_sel_hi:[0,1,1] neg_lo:[1,0,0]
v_pk_fma_f32 v[174:175], v[174:175], v[42:43], v[178:179] op_sel:[1,1,0] op_sel_hi:[0,1,1] neg_lo:[1,0,0]
v_pk_fma_f32 v[132:133], v[120:121], v[48:49], v[180:181] op_sel:[1,1,0] op_sel_hi:[0,1,1] neg_hi:[1,0,0]
v_pk_fma_f32 v[134:135], v[122:123], v[50:51], v[182:183] op_sel:[1,1,0] op_sel_hi:[0,1,1] neg_hi:[1,0,0]
v_cvt_pk_f16_f32 v186, v172, v173
v_cvt_pk_f16_f32 v187, v174, v175
v_cvt_pk_f16_f32 v184, v120, v121
v_cvt_pk_f16_f32 v185, v122, v123
ds_write_b128 v18, v[184:187] offset:18720
v_pk_mul_f32 v[176:177], v[172:173], v[40:41] op_sel:[0,0] op_sel_hi:[1,0]
v_pk_mul_f32 v[178:179], v[174:175], v[42:43] op_sel:[0,0] op_sel_hi:[1,0]
v_pk_mul_f32 v[180:181], v[124:125], v[48:49] op_sel:[0,0] op_sel_hi:[1,0]
v_pk_mul_f32 v[182:183], v[126:127], v[50:51] op_sel:[0,0] op_sel_hi:[1,0]
v_pk_fma_f32 v[172:173], v[172:173], v[40:41], v[176:177] op_sel:[1,1,0] op_sel_hi:[0,1,1] neg_lo:[1,0,0]
v_pk_fma_f32 v[174:175], v[174:175], v[42:43], v[178:179] op_sel:[1,1,0] op_sel_hi:[0,1,1] neg_lo:[1,0,0]
v_pk_fma_f32 v[136:137], v[124:125], v[48:49], v[180:181] op_sel:[1,1,0] op_sel_hi:[0,1,1] neg_hi:[1,0,0]
v_pk_fma_f32 v[138:139], v[126:127], v[50:51], v[182:183] op_sel:[1,1,0] op_sel_hi:[0,1,1] neg_hi:[1,0,0]
v_cvt_pk_f16_f32 v190, v172, v173
v_cvt_pk_f16_f32 v191, v174, v175
v_cvt_pk_f16_f32 v188, v124, v125
v_cvt_pk_f16_f32 v189, v126, v127
ds_write_b128 v18, v[188:191] offset:19760
v_pk_mul_f32 v[176:177], v[172:173], v[40:41] op_sel:[0,0] op_sel_hi:[1,0]
v_pk_mul_f32 v[178:179], v[174:175], v[42:43] op_sel:[0,0] op_sel_hi:[1,0]
v_pk_mul_f32 v[180:181], v[128:129], v[48:49] op_sel:[0,0] op_sel_hi:[1,0]
v_pk_mul_f32 v[182:183], v[130:131], v[50:51] op_sel:[0,0] op_sel_hi:[1,0]
v_pk_fma_f32 v[172:173], v[172:173], v[40:41], v[176:177] op_sel:[1,1,0] op_sel_hi:[0,1,1] neg_lo:[1,0,0]
v_pk_fma_f32 v[174:175], v[174:175], v[42:43], v[178:179] op_sel:[1,1,0] op_sel_hi:[0,1,1] neg_lo:[1,0,0]
v_pk_fma_f32 v[140:141], v[128:129], v[48:49], v[180:181] op_sel:[1,1,0] op_sel_hi:[0,1,1] neg_hi:[1,0,0]
v_pk_fma_f32 v[142:143], v[130:131], v[50:51], v[182:183] op_sel:[1,1,0] op_sel_hi:[0,1,1] neg_hi:[1,0,0]
v_cvt_pk_f16_f32 v58, v172, v173
v_cvt_pk_f16_f32 v59, v174, v175
v_cvt_pk_f16_f32 v56, v112, v113
v_cvt_pk_f16_f32 v57, v114, v115
ds_write_b128 v18, v[56:59] offset:20800
v_pk_mul_f32 v[176:177], v[172:173], v[40:41] op_sel:[0,0] op_sel_hi:[1,0]
v_pk_mul_f32 v[178:179], v[174:175], v[42:43] op_sel:[0,0] op_sel_hi:[1,0]
v_pk_mul_f32 v[180:181], v[136:137], v[48:49] op_sel:[0,0] op_sel_hi:[1,0]
v_pk_mul_f32 v[182:183], v[138:139], v[50:51] op_sel:[0,0] op_sel_hi:[1,0]
v_pk_fma_f32 v[172:173], v[172:173], v[40:41], v[176:177] op_sel:[1,1,0] op_sel_hi:[0,1,1] neg_lo:[1,0,0]
v_pk_fma_f32 v[174:175], v[174:175], v[42:43], v[178:179] op_sel:[1,1,0] op_sel_hi:[0,1,1] neg_lo:[1,0,0]
v_pk_fma_f32 v[144:145], v[136:137], v[48:49], v[180:181] op_sel:[1,1,0] op_sel_hi:[0,1,1] neg_hi:[1,0,0]
v_pk_fma_f32 v[146:147], v[138:139], v[50:51], v[182:183] op_sel:[1,1,0] op_sel_hi:[0,1,1] neg_hi:[1,0,0]
v_cvt_pk_f16_f32 v62, v172, v173
v_cvt_pk_f16_f32 v63, v174, v175
v_cvt_pk_f16_f32 v60, v128, v129
v_cvt_pk_f16_f32 v61, v130, v131
ds_write_b128 v18, v[60:63] offset:21840
v_pk_mul_f32 v[176:177], v[172:173], v[40:41] op_sel:[0,0] op_sel_hi:[1,0]
v_pk_mul_f32 v[178:179], v[174:175], v[42:43] op_sel:[0,0] op_sel_hi:[1,0]
v_pk_mul_f32 v[180:181], v[140:141], v[48:49] op_sel:[0,0] op_sel_hi:[1,0]
v_pk_mul_f32 v[182:183], v[142:143], v[50:51] op_sel:[0,0] op_sel_hi:[1,0]
v_pk_fma_f32 v[172:173], v[172:173], v[40:41], v[176:177] op_sel:[1,1,0] op_sel_hi:[0,1,1] neg_lo:[1,0,0]
v_pk_fma_f32 v[174:175], v[174:175], v[42:43], v[178:179] op_sel:[1,1,0] op_sel_hi:[0,1,1] neg_lo:[1,0,0]
v_pk_fma_f32 v[148:149], v[140:141], v[48:49], v[180:181] op_sel:[1,1,0] op_sel_hi:[0,1,1] neg_hi:[1,0,0]
v_pk_fma_f32 v[150:151], v[142:143], v[50:51], v[182:183] op_sel:[1,1,0] op_sel_hi:[0,1,1] neg_hi:[1,0,0]
v_cvt_pk_f16_f32 v186, v172, v173
v_cvt_pk_f16_f32 v187, v174, v175
v_cvt_pk_f16_f32 v184, v132, v133
v_cvt_pk_f16_f32 v185, v134, v135
ds_write_b128 v18, v[184:187] offset:22880
v_pk_mul_f32 v[176:177], v[172:173], v[40:41] op_sel:[0,0] op_sel_hi:[1,0]
v_pk_mul_f32 v[178:179], v[174:175], v[42:43] op_sel:[0,0] op_sel_hi:[1,0]
v_pk_mul_f32 v[180:181], v[144:145], v[48:49] op_sel:[0,0] op_sel_hi:[1,0]
v_pk_mul_f32 v[182:183], v[146:147], v[50:51] op_sel:[0,0] op_sel_hi:[1,0]
v_pk_fma_f32 v[172:173], v[172:173], v[40:41], v[176:177] op_sel:[1,1,0] op_sel_hi:[0,1,1] neg_lo:[1,0,0]
v_pk_fma_f32 v[174:175], v[174:175], v[42:43], v[178:179] op_sel:[1,1,0] op_sel_hi:[0,1,1] neg_lo:[1,0,0]
v_pk_fma_f32 v[152:153], v[144:145], v[48:49], v[180:181] op_sel:[1,1,0] op_sel_hi:[0,1,1] neg_hi:[1,0,0]
v_pk_fma_f32 v[154:155], v[146:147], v[50:51], v[182:183] op_sel:[1,1,0] op_sel_hi:[0,1,1] neg_hi:[1,0,0]
v_cvt_pk_f16_f32 v190, v172, v173
v_cvt_pk_f16_f32 v191, v174, v175
v_cvt_pk_f16_f32 v188, v136, v137
v_cvt_pk_f16_f32 v189, v138, v139
ds_write_b128 v18, v[188:191] offset:23920
v_pk_mul_f32 v[176:177], v[172:173], v[40:41] op_sel:[0,0] op_sel_hi:[1,0]
v_pk_mul_f32 v[178:179], v[174:175], v[42:43] op_sel:[0,0] op_sel_hi:[1,0]
v_pk_mul_f32 v[180:181], v[148:149], v[48:49] op_sel:[0,0] op_sel_hi:[1,0]
v_pk_mul_f32 v[182:183], v[150:151], v[50:51] op_sel:[0,0] op_sel_hi:[1,0]
v_pk_fma_f32 v[172:173], v[172:173], v[40:41], v[176:177] op_sel:[1,1,0] op_sel_hi:[0,1,1] neg_lo:[1,0,0]
v_pk_fma_f32 v[174:175], v[174:175], v[42:43], v[178:179] op_sel:[1,1,0] op_sel_hi:[0,1,1] neg_lo:[1,0,0]
v_pk_fma_f32 v[156:157], v[148:149], v[48:49], v[180:181] op_sel:[1,1,0] op_sel_hi:[0,1,1] neg_hi:[1,0,0]
v_pk_fma_f32 v[158:159], v[150:151], v[50:51], v[182:183] op_sel:[1,1,0] op_sel_hi:[0,1,1] neg_hi:[1,0,0]
v_cvt_pk_f16_f32 v58, v172, v173
v_cvt_pk_f16_f32 v59, v174, v175
v_cvt_pk_f16_f32 v56, v140, v141
v_cvt_pk_f16_f32 v57, v142, v143
ds_write_b128 v18, v[56:59] offset:24960
v_pk_mul_f32 v[176:177], v[172:173], v[40:41] op_sel:[0,0] op_sel_hi:[1,0]
v_pk_mul_f32 v[178:179], v[174:175], v[42:43] op_sel:[0,0] op_sel_hi:[1,0]
v_pk_mul_f32 v[180:181], v[152:153], v[48:49] op_sel:[0,0] op_sel_hi:[1,0]
v_pk_mul_f32 v[182:183], v[154:155], v[50:51] op_sel:[0,0] op_sel_hi:[1,0]
v_pk_fma_f32 v[172:173], v[172:173], v[40:41], v[176:177] op_sel:[1,1,0] op_sel_hi:[0,1,1] neg_lo:[1,0,0]
v_pk_fma_f32 v[174:175], v[174:175], v[42:43], v[178:179] op_sel:[1,1,0] op_sel_hi:[0,1,1] neg_lo:[1,0,0]
v_pk_fma_f32 v[160:161], v[152:153], v[48:49], v[180:181] op_sel:[1,1,0] op_sel_hi:[0,1,1] neg_hi:[1,0,0]
v_pk_fma_f32 v[162:163], v[154:155], v[50:51], v[182:183] op_sel:[1,1,0] op_sel_hi:[0,1,1] neg_hi:[1,0,0]
v_cvt_pk_f16_f32 v62, v172, v173
v_cvt_pk_f16_f32 v63, v174, v175
v_cvt_pk_f16_f32 v60, v144, v145
v_cvt_pk_f16_f32 v61, v146, v147
ds_write_b128 v18, v[60:63] offset:26000
v_pk_mul_f32 v[176:177], v[172:173], v[40:41] op_sel:[0,0] op_sel_hi:[1,0]
v_pk_mul_f32 v[178:179], v[174:175], v[42:43] op_sel:[0,0] op_sel_hi:[1,0]
v_pk_mul_f32 v[180:181], v[156:157], v[48:49] op_sel:[0,0] op_sel_hi:[1,0]
v_pk_mul_f32 v[182:183], v[158:159], v[50:51] op_sel:[0,0] op_sel_hi:[1,0]
v_pk_fma_f32 v[172:173], v[172:173], v[40:41], v[176:177] op_sel:[1,1,0] op_sel_hi:[0,1,1] neg_lo:[1,0,0]
v_pk_fma_f32 v[174:175], v[174:175], v[42:43], v[178:179] op_sel:[1,1,0] op_sel_hi:[0,1,1] neg_lo:[1,0,0]
v_pk_fma_f32 v[164:165], v[156:157], v[48:49], v[180:181] op_sel:[1,1,0] op_sel_hi:[0,1,1] neg_hi:[1,0,0]
v_pk_fma_f32 v[166:167], v[158:159], v[50:51], v[182:183] op_sel:[1,1,0] op_sel_hi:[0,1,1] neg_hi:[1,0,0]
v_cvt_pk_f16_f32 v186, v172, v173
v_cvt_pk_f16_f32 v187, v174, v175
v_cvt_pk_f16_f32 v184, v156, v157
v_cvt_pk_f16_f32 v185, v158, v159
ds_write_b128 v18, v[184:187] offset:27040
v_pk_mul_f32 v[176:177], v[172:173], v[40:41] op_sel:[0,0] op_sel_hi:[1,0]
v_pk_mul_f32 v[178:179], v[174:175], v[42:43] op_sel:[0,0] op_sel_hi:[1,0]
v_pk_mul_f32 v[180:181], v[160:161], v[48:49] op_sel:[0,0] op_sel_hi:[1,0]
v_pk_mul_f32 v[182:183], v[162:163], v[50:51] op_sel:[0,0] op_sel_hi:[1,0]
v_pk_fma_f32 v[172:173], v[172:173], v[40:41], v[176:177] op_sel:[1,1,0] op_sel_hi:[0,1,1] neg_lo:[1,0,0]
v_pk_fma_f32 v[174:175], v[174:175], v[42:43], v[178:179] op_sel:[1,1,0] op_sel_hi:[0,1,1] neg_lo:[1,0,0]
v_pk_fma_f32 v[168:169], v[160:161], v[48:49], v[180:181] op_sel:[1,1,0] op_sel_hi:[0,1,1] neg_hi:[1,0,0]
v_pk_fma_f32 v[170:171], v[162:163], v[50:51], v[182:183] op_sel:[1,1,0] op_sel_hi:[0,1,1] neg_hi:[1,0,0]
v_cvt_pk_f16_f32 v190, v172, v173
v_cvt_pk_f16_f32 v191, v174, v175
v_cvt_pk_f16_f32 v188, v160, v161
v_cvt_pk_f16_f32 v189, v162, v163
ds_write_b128 v18, v[188:191] offset:28080
v_pk_mul_f32 v[176:177], v[172:173], v[40:41] op_sel:[0,0] op_sel_hi:[1,0]
v_pk_mul_f32 v[178:179], v[174:175], v[42:43] op_sel:[0,0] op_sel_hi:[1,0]
v_pk_fma_f32 v[172:173], v[172:173], v[40:41], v[176:177] op_sel:[1,1,0] op_sel_hi:[0,1,1] neg_lo:[1,0,0]
v_pk_fma_f32 v[174:175], v[174:175], v[42:43], v[178:179] op_sel:[1,1,0] op_sel_hi:[0,1,1] neg_lo:[1,0,0]
v_cvt_pk_f16_f32 v58, v172, v173
v_cvt_pk_f16_f32 v59, v174, v175
v_cvt_pk_f16_f32 v56, v148, v149
v_cvt_pk_f16_f32 v57, v150, v151
ds_write_b128 v18, v[56:59] offset:29120
v_pk_mul_f32 v[176:177], v[172:173], v[40:41] op_sel:[0,0] op_sel_hi:[1,0]
v_pk_mul_f32 v[178:179], v[174:175], v[42:43] op_sel:[0,0] op_sel_hi:[1,0]
v_pk_fma_f32 v[172:173], v[172:173], v[40:41], v[176:177] op_sel:[1,1,0] op_sel_hi:[0,1,1] neg_lo:[1,0,0]
v_pk_fma_f32 v[174:175], v[174:175], v[42:43], v[178:179] op_sel:[1,1,0] op_sel_hi:[0,1,1] neg_lo:[1,0,0]
v_cvt_pk_f16_f32 v62, v172, v173
v_cvt_pk_f16_f32 v63, v174, v175
v_cvt_pk_f16_f32 v60, v152, v153
v_cvt_pk_f16_f32 v61, v154, v155
L_pad_k_1:
s_cbranch_execz L_ret_k
ds_write_b128 v18, v[60:63] offset:30160
v_pk_mul_f32 v[176:177], v[172:173], v[40:41] op_sel:[0,0] op_sel_hi:[1,0]
s_nop 0
v_pk_mul_f32 v[178:179], v[174:175], v[42:43] op_sel:[0,0] op_sel_hi:[1,0]
v_pk_fma_f32 v[172:173], v[172:173], v[40:41], v[176:177] op_sel:[1,1,0] op_sel_hi:[0,1,1] neg_lo:[1,0,0]
v_pk_fma_f32 v[174:175], v[174:175], v[42:43], v[178:179] op_sel:[1,1,0] op_sel_hi:[0,1,1] neg_lo:[1,0,0]
v_cvt_pk_f16_f32 v186, v172, v173
v_cvt_pk_f16_f32 v187, v174, v175
v_cvt_pk_f16_f32 v184, v164, v165
v_cvt_pk_f16_f32 v185, v166, v167
ds_write_b128 v18, v[184:187] offset:31200
v_pk_mul_f32 v[176:177], v[172:173], v[40:41] op_sel:[0,0] op_sel_hi:[1,0]
v_pk_mul_f32 v[178:179], v[174:175], v[42:43] op_sel:[0,0] op_sel_hi:[1,0]
v_pk_fma_f32 v[172:173], v[172:173], v[40:41], v[176:177] op_sel:[1,1,0] op_sel_hi:[0,1,1] neg_lo:[1,0,0]
v_pk_fma_f32 v[174:175], v[174:175], v[42:43], v[178:179] op_sel:[1,1,0] op_sel_hi:[0,1,1] neg_lo:[1,0,0]
v_cvt_pk_f16_f32 v190, v172, v173
v_cvt_pk_f16_f32 v191, v174, v175
v_cvt_pk_f16_f32 v188, v168, v169
v_cvt_pk_f16_f32 v189, v170, v171
ds_write_b128 v18, v[188:191] offset:32240
ds_read_b64 v[64:65], v19 offset:0
ds_read_b64 v[128:129], v19 offset:8
ds_read_b64 v[66:67], v19 offset:16
ds_read_b64 v[130:131], v19 offset:24
ds_read_b64 v[68:69], v19 offset:64
ds_read_b64 v[132:133], v19 offset:72
ds_read_b64 v[70:71], v19 offset:80
ds_read_b64 v[134:135], v19 offset:88
ds_read_b64 v[72:73], v19 offset:128
ds_read_b64 v[136:137], v19 offset:136
ds_read_b64 v[74:75], v19 offset:144
ds_read_b64 v[138:139], v19 offset:152
s_waitcnt lgkmcnt(8)
v_mfma_f32_32x32x16_f16 v[32:47], v[64:67], v[128:131], 0
ds_read_b64 v[76:77], v19 offset:192
ds_read_b64 v[140:141], v19 offset:200
ds_read_b64 v[78:79], v19 offset:208
ds_read_b64 v[142:143], v19 offset:216
s_waitcnt lgkmcnt(8)
v_mfma_f32_32x32x16_f16 v[32:47], v[68:71], v[132:135], v[32:47]
ds_read_b64 v[80:81], v19 offset:256
ds_read_b64 v[144:145], v19 offset:264
ds_read_b64 v[82:83], v19 offset:272
ds_read_b64 v[146:147], v19 offset:280
s_waitcnt lgkmcnt(8)
v_mfma_f32_32x32x16_f16 v[32:47], v[72:75], v[136:139], v[32:47]
ds_read_b64 v[84:85], v19 offset:320
ds_read_b64 v[148:149], v19 offset:328
ds_read_b64 v[86:87], v19 offset:336
ds_read_b64 v[150:151], v19 offset:344
s_waitcnt lgkmcnt(8)
v_mfma_f32_32x32x16_f16 v[32:47], v[76:79], v[140:143], v[32:47]
ds_read_b64 v[88:89], v19 offset:384
ds_read_b64 v[152:153], v19 offset:392
ds_read_b64 v[90:91], v19 offset:400
ds_read_b64 v[154:155], v19 offset:408
s_waitcnt lgkmcnt(8)
v_mfma_f32_32x32x16_f16 v[32:47], v[80:83], v[144:147], v[32:47]
ds_read_b64 v[92:93], v19 offset:448
ds_read_b64 v[156:157], v19 offset:456
ds_read_b64 v[94:95], v19 offset:464
ds_read_b64 v[158:159], v19 offset:472
s_waitcnt lgkmcnt(8)
v_mfma_f32_32x32x16_f16 v[32:47], v[84:87], v[148:151], v[32:47]
ds_read_b64 v[96:97], v19 offset:512
ds_read_b64 v[160:161], v19 offset:520
ds_read_b64 v[98:99], v19 offset:528
ds_read_b64 v[162:163], v19 offset:536
s_waitcnt lgkmcnt(8)
v_mfma_f32_32x32x16_f16 v[32:47], v[88:91], v[152:155], v[32:47]
ds_read_b64 v[100:101], v19 offset:576
ds_read_b64 v[164:165], v19 offset:584
ds_read_b64 v[102:103], v19 offset:592
ds_read_b64 v[166:167], v19 offset:600
s_waitcnt lgkmcnt(8)
v_mfma_f32_32x32x16_f16 v[32:47], v[92:95], v[156:159], v[32:47]
ds_read_b64 v[104:105], v19 offset:640
ds_read_b64 v[168:169], v19 offset:648
ds_read_b64 v[106:107], v19 offset:656
ds_read_b64 v[170:171], v19 offset:664
s_waitcnt lgkmcnt(8)
v_mfma_f32_32x32x16_f16 v[32:47], v[96:99], v[160:163], v[32:47]
ds_read_b64 v[108:109], v19 offset:704
ds_read_b64 v[172:173], v19 offset:712
ds_read_b64 v[110:111], v19 offset:720
ds_read_b64 v[174:175], v19 offset:728
s_waitcnt lgkmcnt(8)
v_mfma_f32_32x32x16_f16 v[32:47], v[100:103], v[164:167], v[32:47]
ds_read_b64 v[112:113], v19 offset:768
ds_read_b64 v[176:177], v19 offset:776
ds_read_b64 v[114:115], v19 offset:784
ds_read_b64 v[178:179], v19 offset:792
s_waitcnt lgkmcnt(8)
v_mfma_f32_32x32x16_f16 v[32:47], v[104:107], v[168:171], v[32:47]
ds_read_b64 v[116:117], v19 offset:832
ds_read_b64 v[180:181], v19 offset:840
ds_read_b64 v[118:119], v19 offset:848
ds_read_b64 v[182:183], v19 offset:856
s_waitcnt lgkmcnt(8)
v_mfma_f32_32x32x16_f16 v[32:47], v[108:111], v[172:175], v[32:47]
ds_read_b64 v[120:121], v19 offset:896
ds_read_b64 v[184:185], v19 offset:904
ds_read_b64 v[122:123], v19 offset:912
ds_read_b64 v[186:187], v19 offset:920
s_waitcnt lgkmcnt(8)
v_mfma_f32_32x32x16_f16 v[32:47], v[112:115], v[176:179], v[32:47]
ds_read_b64 v[124:125], v19 offset:960
ds_read_b64 v[188:189], v19 offset:968
ds_read_b64 v[126:127], v19 offset:976
ds_read_b64 v[190:191], v19 offset:984
s_waitcnt lgkmcnt(8)
v_mfma_f32_32x32x16_f16 v[32:47], v[116:119], v[180:183], v[32:47]
s_waitcnt lgkmcnt(4)
v_mfma_f32_32x32x16_f16 v[32:47], v[120:123], v[184:187], v[32:47]
s_waitcnt lgkmcnt(0)
v_mfma_f32_32x32x16_f16 v[32:47], v[124:127], v[188:191], v[32:47]
v_lshlrev_b32 v13, 16, v13
v_cmp_eq_u32 vcc, 0, v1
s_nop 1
v_cndmask_b32 v13, 0, v13, vcc
v_and_b32 v16, 1, v1
v_cmp_eq_u32_e64 vcc, 0, v16
s_nop 4
v_fma_f32 v32, v32, v29, v13
v_mul_f32 v33, v33, v29
v_mul_f32 v34, v34, v29
v_mul_f32 v35, v35, v29
v_mul_f32 v36, v36, v29
v_mul_f32 v37, v37, v29
v_mul_f32 v38, v38, v29
v_mul_f32 v39, v39, v29
v_mul_f32 v40, v40, v29
v_mul_f32 v41, v41, v29
v_mul_f32 v42, v42, v29
v_mul_f32 v43, v43, v29
v_mul_f32 v44, v44, v29
v_mul_f32_e64 v45, v45, v29
v_mul_f32_e64 v46, v46, v29
v_mul_f32_e64 v47, v47, v29
v_cndmask_b32_e64 v48, v45, v44, vcc
v_cndmask_b32_e64 v49, v47, v46, vcc
v_cvt_pk_bf16_f32 v64, v32, v33
v_cvt_pk_bf16_f32 v65, v34, v35
v_cvt_pk_bf16_f32 v66, v36, v37
v_cvt_pk_bf16_f32 v67, v38, v39
ds_write_b128 v20, v[64:67] offset:32
ds_write2_b32 v192, v64, v65 offset0:0 offset1:1
ds_write2_b32 v192, v66, v67 offset0:2 offset1:3
v_cvt_pk_bf16_f32 v68, v33, v34
v_cvt_pk_bf16_f32 v69, v35, v36
v_cvt_pk_bf16_f32 v70, v37, v38
v_cvt_pk_bf16_f32 v71, v39, v40
ds_write_b128 v20, v[68:71] offset:4192
ds_write2_b32 v196, v68, v69 offset0:0 offset1:1
ds_write2_b32 v196, v70, v71 offset0:2 offset1:3
v_cvt_pk_bf16_f32 v72, v41, v41
v_cvt_pk_bf16_f32 v73, v41, v42
v_cvt_pk_bf16_f32 v74, v42, v42
v_cvt_pk_bf16_f32 v75, v43, v43
ds_write_b128 v20, v[72:75] offset:1056
ds_write2_b32 v193, v72, v73 offset0:0 offset1:1
ds_write2_b32 v193, v74, v75 offset0:2 offset1:3
v_cvt_pk_bf16_f32 v76, v41, v41
v_cvt_pk_bf16_f32 v77, v42, v42
v_cvt_pk_bf16_f32 v78, v42, v43
v_cvt_pk_bf16_f32 v79, v43, v43
ds_write_b128 v20, v[76:79] offset:5216
ds_write2_b32 v197, v76, v77 offset0:0 offset1:1
ds_write2_b32 v197, v78, v79 offset0:2 offset1:3
v_cvt_pk_bf16_f32 v80, v44, v44
v_cvt_pk_bf16_f32 v81, v44, v44
v_cvt_pk_bf16_f32 v82, v48, v45
v_cvt_pk_bf16_f32 v83, v45, v45
ds_write_b128 v20, v[80:83] offset:2080
ds_write2_b32 v194, v80, v81 offset0:0 offset1:1
ds_write2_b32 v194, v82, v83 offset0:2 offset1:3
v_cvt_pk_bf16_f32 v84, v44, v44
v_cvt_pk_bf16_f32 v85, v44, v48
v_cvt_pk_bf16_f32 v86, v45, v45
v_cvt_pk_bf16_f32 v87, v45, v45
ds_write_b128 v20, v[84:87] offset:6240
ds_write2_b32 v198, v84, v85 offset0:0 offset1:1
ds_write2_b32 v198, v86, v87 offset0:2 offset1:3
v_cvt_pk_bf16_f32 v88, v46, v46
v_cvt_pk_bf16_f32 v89, v46, v46
v_cvt_pk_bf16_f32 v90, v49, v47
v_cvt_pk_bf16_f32 v91, v47, v47
ds_write_b128 v20, v[88:91] offset:3104
ds_write2_b32 v195, v88, v89 offset0:0 offset1:1
ds_write2_b32 v195, v90, v91 offset0:2 offset1:3
v_cvt_pk_bf16_f32 v92, v46, v46
v_cvt_pk_bf16_f32 v93, v46, v49
v_cvt_pk_bf16_f32 v94, v47, v47
v_cvt_pk_bf16_f32 v95, v47, v47
ds_write_b128 v20, v[92:95] offset:7264
ds_write2_b32 v199, v92, v93 offset0:0 offset1:1
ds_write2_b32 v199, v94, v95 offset0:2 offset1:3
v_lshlrev_b32_e64 v16, 16, v64
s_mov_b32 exec_lo, 0x00000001
s_mov_b32 exec_hi, 0x00000000
ds_write_b32 v20, v16 offset:4188
ds_write_b32 v20, v16 offset:12504
s_mov_b64 exec, -1
s_mov_b32 s70, 0
L_sp_f12:
ds_read2_b32 v[26:27], v209 offset0:1 offset1:2
ds_read_b128 v[112:115], v203
ds_read_b64_tr_b16 v[128:129], v200 offset:0
ds_read_b64_tr_b16 v[130:131], v200 offset:4352
ds_read_b64_tr_b16 v[132:133], v200 offset:16
ds_read_b64_tr_b16 v[134:135], v200 offset:4368
ds_read_b64_tr_b16 v[136:137], v200 offset:32
ds_read_b64_tr_b16 v[138:139], v200 offset:4384
ds_read_b64_tr_b16 v[140:141], v200 offset:48
ds_read_b64_tr_b16 v[142:143], v200 offset:4400
ds_read_b64_tr_b16 v[144:145], v200 offset:64
ds_read_b64_tr_b16 v[146:147], v200 offset:4416
ds_read_b64_tr_b16 v[148:149], v200 offset:80
ds_read_b64_tr_b16 v[150:151], v200 offset:4432
ds_read_b128 v[104:107], v202
ds_read_b128 v[108:111], v202 offset:16
s_waitcnt lgkmcnt(14)
v_and_b32 v26, v26, v27
v_cmp_ne_u32_e64 vcc, 1, v26
v_cndmask_b32 v112, 0, v112, s[90:91]
v_cndmask_b32 v113, 0, v113, s[90:91]
v_cndmask_b32 v114, 0, v114, s[90:91]
v_cndmask_b32 v115, 0, v115, s[90:91]
s_waitcnt lgkmcnt(0)
s_cbranch_vccz L_sp_f12_ok
s_add_u32 s70, s70, 1
s_cmp_lt_u32 s70, 67108864
s_cbranch_scc1 L_sp_f12
L_sp_f12_ok:
v_cndmask_b32 v148, v148, 0, s[72:73]
v_cndmask_b32 v149, v149, 0, s[72:73]
v_cndmask_b32 v150, v150, 0, s[72:73]
v_cndmask_b32 v151, v151, 0, s[72:73]
v_mfma_f32_16x16x32_bf16 v[160:163], v[112:115], v[128:131], 0
v_mfma_f32_16x16x32_bf16 v[164:167], v[112:115], v[132:135], 0
v_mfma_f32_16x16x32_bf16 v[168:171], v[112:115], v[136:139], 0
v_mfma_f32_16x16x32_bf16 v[172:175], v[112:115], v[140:143], 0
v_mfma_f32_16x16x32_bf16 v[176:179], v[112:115], v[144:147], 0
v_mfma_f32_16x16x32_bf16 v[180:183], v[112:115], v[148:151], 0
v_dot2_f32_bf16 v16, v128, v104, 0
v_dot2_f32_bf16 v17, v128, v105, 0
v_dot2_f32_bf16 v18, v129, v106, 0
v_dot2_f32_bf16 v19, v129, v107, 0
v_dot2_f32_bf16 v20, v130, v108, 0
v_dot2_f32_bf16 v21, v130, v109, 0
v_dot2_f32_bf16 v22, v131, v110, 0
v_dot2_f32_bf16 v23, v131, v111, 0
v_cvt_pk_bf16_f32 v128, v16, v17
v_cvt_pk_bf16_f32 v129, v18, v19
v_cvt_pk_bf16_f32 v130, v20, v21
v_cvt_pk_bf16_f32 v131, v22, v23
buffer_store_dwordx4 v[128:131], v2, s[4:7], s87 offen sc1
s_add_u32 s87, s87, 16384
v_dot2_f32_bf16 v16, v132, v104, 0
v_dot2_f32_bf16 v17, v132, v105, 0
v_dot2_f32_bf16 v18, v133, v106, 0
v_dot2_f32_bf16 v19, v133, v107, 0
v_dot2_f32_bf16 v20, v134, v108, 0
v_dot2_f32_bf16 v21, v134, v109, 0
v_dot2_f32_bf16 v22, v135, v110, 0
v_dot2_f32_bf16 v23, v135, v111, 0
v_cvt_pk_bf16_f32 v132, v16, v17
v_cvt_pk_bf16_f32 v133, v18, v19
v_cvt_pk_bf16_f32 v134, v20, v21
v_cvt_pk_bf16_f32 v135, v22, v23
buffer_store_dwordx4 v[132:135], v2, s[4:7], s87 offen sc1
s_add_u32 s87, s87, 16384
v_dot2_f32_bf16 v16, v136, v104, 0
v_dot2_f32_bf16 v17, v136, v105, 0
v_dot2_f32_bf16 v18, v137, v106, 0
v_dot2_f32_bf16 v19, v137, v107, 0
v_dot2_f32_bf16 v20, v138, v108, 0
v_dot2_f32_bf16 v21, v138, v109, 0
v_dot2_f32_bf16 v22, v139, v110, 0
v_dot2_f32_bf16 v23, v139, v111, 0
v_cvt_pk_bf16_f32 v136, v16, v17
v_cvt_pk_bf16_f32 v137, v18, v19
v_cvt_pk_bf16_f32 v138, v20, v21
v_cvt_pk_bf16_f32 v139, v22, v23
buffer_store_dwordx4 v[136:139], v2, s[4:7], s87 offen sc1
s_add_u32 s87, s87, 16384
v_dot2_f32_bf16 v16, v140, v104, 0
v_dot2_f32_bf16 v17, v140, v105, 0
v_dot2_f32_bf16 v18, v141, v106, 0
v_dot2_f32_bf16 v19, v141, v107, 0
v_dot2_f32_bf16 v20, v142, v108, 0
v_dot2_f32_bf16 v21, v142, v109, 0
v_dot2_f32_bf16 v22, v143, v110, 0
v_dot2_f32_bf16 v23, v143, v111, 0
v_cvt_pk_bf16_f32 v140, v16, v17
v_cvt_pk_bf16_f32 v141, v18, v19
v_cvt_pk_bf16_f32 v142, v20, v21
v_cvt_pk_bf16_f32 v143, v22, v23
buffer_store_dwordx4 v[140:143], v2, s[4:7], s87 offen sc1
s_add_u32 s87, s87, 16384
v_dot2_f32_bf16 v16, v144, v104, 0
v_dot2_f32_bf16 v17, v144, v105, 0
v_dot2_f32_bf16 v18, v145, v106, 0
v_dot2_f32_bf16 v19, v145, v107, 0
v_dot2_f32_bf16 v20, v146, v108, 0
v_dot2_f32_bf16 v21, v146, v109, 0
v_dot2_f32_bf16 v22, v147, v110, 0
v_dot2_f32_bf16 v23, v147, v111, 0
v_cvt_pk_bf16_f32 v144, v16, v17
v_cvt_pk_bf16_f32 v145, v18, v19
v_cvt_pk_bf16_f32 v146, v20, v21
v_cvt_pk_bf16_f32 v147, v22, v23
buffer_store_dwordx4 v[144:147], v2, s[4:7], s87 offen sc1
s_add_u32 s87, s87, 16384
v_dot2_f32_bf16 v16, v148, v104, 0
v_dot2_f32_bf16 v17, v148, v105, 0
v_dot2_f32_bf16 v18, v149, v106, 0
v_dot2_f32_bf16 v19, v149, v107, 0
v_dot2_f32_bf16 v20, v150, v108, 0
v_dot2_f32_bf16 v21, v150, v109, 0
v_dot2_f32_bf16 v22, v151, v110, 0
v_dot2_f32_bf16 v23, v151, v111, 0
v_cvt_pk_bf16_f32 v148, v16, v17
v_cvt_pk_bf16_f32 v149, v18, v19
v_cvt_pk_bf16_f32 v150, v20, v21
v_cvt_pk_bf16_f32 v151, v22, v23
v_cndmask_b32 v148, v148, v208, s[74:75]
v_cndmask_b32 v149, v149, v208, s[74:75]
v_cndmask_b32 v150, v150, v208, s[74:75]
v_cndmask_b32 v151, v151, v208, s[74:75]
buffer_store_dwordx4 v[148:151], v2, s[4:7], s87 offen sc1
v_mfma_f32_16x16x32_bf16 v[160:163], v[204:207], v[128:131], v[160:163]
v_mfma_f32_16x16x32_bf16 v[164:167], v[204:207], v[132:135], v[164:167]
v_mfma_f32_16x16x32_bf16 v[168:171], v[204:207], v[136:139], v[168:171]
v_mfma_f32_16x16x32_bf16 v[172:175], v[204:207], v[140:143], v[172:175]
v_mfma_f32_16x16x32_bf16 v[176:179], v[204:207], v[144:147], v[176:179]
v_mfma_f32_16x16x32_bf16 v[180:183], v[204:207], v[148:151], v[180:183]
s_mov_b32 exec_lo, 0x0000ffff
s_mov_b32 exec_hi, 0x00000000
s_nop 0
buffer_store_dwordx2 v[160:161], v201, s[4:7], s88 offen offset:0 sc1
buffer_store_dwordx2 v[164:165], v201, s[4:7], s88 offen offset:2048 sc1
s_add_u32 s88, s88, 4096
buffer_store_dwordx2 v[168:169], v201, s[4:7], s88 offen offset:0 sc1
buffer_store_dwordx2 v[172:173], v201, s[4:7], s88 offen offset:2048 sc1
s_add_u32 s88, s88, 4096
buffer_store_dwordx2 v[176:177], v201, s[4:7], s88 offen offset:0 sc1
buffer_store_dwordx2 v[180:181], v201, s[4:7], s88 offen offset:2048 sc1
s_add_u32 s88, s88, 4096
s_mov_b64 exec, -1

L_join1:
L_pad_a_0:
s_cbranch_execz L_pad_a_1
s_waitcnt lgkmcnt(0)
s_barrier
ds_read_b64 v[32:33], v248 offset:0
ds_read_b64 v[34:35], v248 offset:8
ds_read_b128 v[64:67], v249 offset:64
ds_read_b64 v[36:37], v248 offset:512
ds_read_b64 v[38:39], v248 offset:520
ds_read_b128 v[68:71], v249 offset:576
ds_read_b64 v[40:41], v248 offset:1024
ds_read_b64 v[42:43], v248 offset:1032
ds_read_b128 v[72:75], v249 offset:1088
ds_read_b64 v[44:45], v248 offset:1536
ds_read_b64 v[46:47], v248 offset:1544
ds_read_b128 v[76:79], v249 offset:1600
s_waitcnt lgkmcnt(10)
s_waitcnt lgkmcnt(9)
v_mfma_f32_16x16x32_bf16 v[160:163], v[32:35], v[64:67], 0
ds_read_b64 v[48:49], v248 offset:2048
ds_read_b64 v[50:51], v248 offset:2056
s_waitcnt lgkmcnt(8)
v_mfma_f32_16x16x32_bf16 v[164:167], v[32:35], v[68:71], 0
ds_read_b128 v[80:83], v249 offset:2112
ds_read_b64 v[52:53], v248 offset:2560
v_mfma_f32_16x16x32_bf16 v[164:167], v[36:39], v[64:67], v[164:167]
ds_read_b64 v[54:55], v248 offset:2568
ds_read_b128 v[84:87], v249 offset:2624
v_mfma_f32_16x16x32_bf16 v[168:171], v[36:39], v[68:71], 0
ds_read_b64 v[56:57], v248 offset:3072
ds_read_b64 v[58:59], v248 offset:3080
s_waitcnt lgkmcnt(11)
v_mfma_f32_16x16x32_bf16 v[168:171], v[32:35], v[72:75], v[168:171]
ds_read_b128 v[88:91], v249 offset:3136
ds_read_b64 v[60:61], v248 offset:3584
v_mfma_f32_16x16x32_bf16 v[168:171], v[40:43], v[64:67], v[168:171]
ds_read_b64 v[62:63], v248 offset:3592
ds_read_b128 v[92:95], v249 offset:3648
v_mfma_f32_16x16x32_bf16 v[172:175], v[36:39], v[72:75], 0
ds_read_b64 v[96:97], v248 offset:64
ds_read_b64 v[98:99], v248 offset:72
v_mfma_f32_16x16x32_bf16 v[172:175], v[40:43], v[68:71], v[172:175]
ds_read_b128 v[128:131], v249 offset:0
ds_read_b64 v[100:101], v248 offset:576
v_mfma_f32_16x16x32_bf16 v[176:179], v[40:43], v[72:75], 0
ds_read_b64 v[102:103], v248 offset:584
s_waitcnt lgkmcnt(15)
v_mfma_f32_16x16x32_bf16 v[172:175], v[32:35], v[76:79], v[172:175]
ds_read_b128 v[132:135], v249 offset:512
v_and_b32 v11, 7, v3
v_mfma_f32_16x16x32_bf16 v[172:175], v[44:47], v[64:67], v[172:175]
ds_read_b64 v[104:105], v248 offset:1088
v_xor_b32_e64 v11, v11, v4
v_mfma_f32_16x16x32_bf16 v[176:179], v[36:39], v[76:79], v[176:179]
ds_read_b64 v[106:107], v248 offset:1096
v_lshlrev_b32_e64 v11, 4, v11
v_mfma_f32_16x16x32_bf16 v[176:179], v[44:47], v[68:71], v[176:179]
ds_read_b128 v[136:139], v249 offset:1024
v_lshl_add_u32 v9, v4, 12, v11
v_mfma_f32_16x16x32_bf16 v[180:183], v[40:43], v[76:79], 0
ds_read_b64 v[108:109], v248 offset:1600
v_and_b32_e64 v11, 8, v3
v_mfma_f32_16x16x32_bf16 v[180:183], v[44:47], v[72:75], v[180:183]
ds_read_b64 v[110:111], v248 offset:1608
v_lshl_add_u32 v9, v11, 5, v9
v_mfma_f32_16x16x32_bf16 v[184:187], v[44:47], v[76:79], 0
ds_read_b128 v[140:143], v249 offset:1536
s_waitcnt lgkmcnt(15)
v_mfma_f32_16x16x32_bf16 v[176:179], v[32:35], v[80:83], v[176:179]
ds_read_b64 v[112:113], v248 offset:2112
s_lshl_b32 s86, s33, 15
v_mfma_f32_16x16x32_bf16 v[176:179], v[48:51], v[64:67], v[176:179]
ds_read_b64 v[114:115], v248 offset:2120
s_lshr_b32 s54, s35, 1
v_mfma_f32_16x16x32_bf16 v[180:183], v[36:39], v[80:83], v[180:183]
ds_read_b128 v[144:147], v249 offset:2048
s_lshl_b32 s54, s54, 9
v_mfma_f32_16x16x32_bf16 v[180:183], v[48:51], v[68:71], v[180:183]
ds_read_b64 v[116:117], v248 offset:2624
s_add_u32 s86, s86, s54
v_mfma_f32_16x16x32_bf16 v[184:187], v[40:43], v[80:83], v[184:187]
ds_read_b64 v[118:119], v248 offset:2632
s_and_b32 s54, s35, 1
v_mfma_f32_16x16x32_bf16 v[184:187], v[48:51], v[72:75], v[184:187]
ds_read_b128 v[148:151], v249 offset:2560
s_lshl_b32 s54, s54, 7
v_mfma_f32_16x16x32_bf16 v[188:191], v[44:47], v[80:83], 0
ds_read_b64 v[120:121], v248 offset:3136
s_add_u32 s86, s86, s54
v_mfma_f32_16x16x32_bf16 v[188:191], v[48:51], v[76:79], v[188:191]
ds_read_b64 v[122:123], v248 offset:3144
s_add_u32 s86, s86, 3145728
v_mfma_f32_16x16x32_bf16 v[180:183], v[32:35], v[84:87], v[180:183]
s_waitcnt vmcnt(0)
L_warr:
buffer_atomic_add v233, v231, s[4:7], s97 offen offset:12 sc1
v_mfma_f32_16x16x32_bf16 v[180:183], v[52:55], v[64:67], v[180:183]
ds_read_b128 v[152:155], v249 offset:3072
v_add_u32 v9, s86, v9
v_mfma_f32_16x16x32_bf16 v[184:187], v[36:39], v[84:87], v[184:187]
ds_read_b64 v[124:125], v248 offset:3648
v_xor_b32_e64 v10, 64, v9
v_mfma_f32_16x16x32_bf16 v[184:187], v[52:55], v[68:71], v[184:187]
ds_read_b64 v[126:127], v248 offset:3656
v_add_u32 v10, 16384, v10
v_mfma_f32_16x16x32_bf16 v[188:191], v[40:43], v[84:87], v[188:191]
ds_read_b128 v[156:159], v249 offset:3584
s_mov_b32 s86, 0
v_mfma_f32_16x16x32_bf16 v[188:191], v[52:55], v[72:75], v[188:191]
ds_read_b64_tr_b16 v[24:25], v242 offset:0
s_lshl_b32 m0, s33, 11
v_mfma_f32_16x16x32_bf16 v[184:187], v[32:35], v[88:91], v[184:187]
ds_read_b64_tr_b16 v[26:27], v242 offset:256
v_mov_b32 v13, v237
v_mfma_f32_16x16x32_bf16 v[184:187], v[56:59], v[64:67], v[184:187]
ds_read_b64_tr_b16 v[28:29], v242 offset:8
v_mov_b32 v14, v239
v_mfma_f32_16x16x32_bf16 v[188:191], v[36:39], v[88:91], v[188:191]
ds_read_b64_tr_b16 v[30:31], v242 offset:264
s_mul_i32 s87, s50, 11
v_mfma_f32_16x16x32_bf16 v[188:191], v[56:59], v[68:71], v[188:191]
s_mul_i32 s88, s33, 3
s_waitcnt lgkmcnt(15)
v_mfma_f32_16x16x32_bf16 v[188:191], v[32:35], v[92:95], v[188:191]
s_add_u32 s87, s87, s88
s_lshl_b32 s87, s87, 11
v_mfma_f32_16x16x32_bf16 v[188:191], v[60:63], v[64:67], v[188:191]
s_add_u32 s87, s87, 262144
s_add_u32 s88, s87, 4096
v_mfma_f32_16x16x32_bf16 v[160:163], v[96:99], v[128:131], v[160:163]
ds_read_b128 v[244:247], v226
s_lshl_b32 s89, s62, 8
v_mfma_f32_16x16x32_bf16 v[164:167], v[96:99], v[132:135], v[164:167]
ds_read_b64 v[240:241], v228 offset:16
s_add_u32 s89, s89, 86016
v_mfma_f32_16x16x32_bf16 v[164:167], v[100:103], v[128:131], v[164:167]
ds_read_b64 v[32:33], v248 offset:16640
s_add_u32 s90, s89, 24576
v_mfma_f32_16x16x32_bf16 v[168:171], v[96:99], v[136:139], v[168:171]
ds_read_b64 v[34:35], v248 offset:16648
s_lshl_b32 s85, s71, 2
v_mfma_f32_16x16x32_bf16 v[168:171], v[100:103], v[132:135], v[168:171]
ds_write_b128 v224, v[160:163] offset:0
v_mfma_f32_16x16x32_bf16 v[168:171], v[104:107], v[128:131], v[168:171]
ds_read_b128 v[64:67], v249 offset:4736
s_add_u32 s85, s85, s33
v_mfma_f32_16x16x32_bf16 v[172:175], v[96:99], v[140:143], v[172:175]
ds_write_b128 v224, v[164:167] offset:1024
v_mfma_f32_16x16x32_bf16 v[172:175], v[100:103], v[136:139], v[172:175]
ds_read_b64 v[36:37], v248 offset:17152
s_mul_i32 s85, s85, 45056
v_mfma_f32_16x16x32_bf16 v[172:175], v[104:107], v[132:135], v[172:175]
ds_read_b64 v[38:39], v248 offset:17160
s_add_u32 s85, s85, 8388608
v_mfma_f32_16x16x32_bf16 v[172:175], v[108:111], v[128:131], v[172:175]
ds_write_b128 v224, v[168:171] offset:2048
s_waitcnt lgkmcnt(15)
v_mfma_f32_16x16x32_bf16 v[176:179], v[96:99], v[144:147], v[176:179]
ds_read_b128 v[68:71], v249 offset:5248
s_mov_b32 s84, s85
v_mfma_f32_16x16x32_bf16 v[176:179], v[100:103], v[140:143], v[176:179]
ds_read_b64 v[40:41], v248 offset:17664
s_mul_i32 s91, s33, 384
v_mfma_f32_16x16x32_bf16 v[176:179], v[104:107], v[136:139], v[176:179]
ds_read_b64 v[42:43], v248 offset:17672
s_add_u32 s91, s91, 139264
v_mfma_f32_16x16x32_bf16 v[176:179], v[108:111], v[132:135], v[176:179]
ds_write_b128 v224, v[172:175] offset:3072
v_mfma_f32_16x16x32_bf16 v[176:179], v[112:115], v[128:131], v[176:179]
ds_read_b128 v[72:75], v249 offset:5760
v_lshl_add_u32 v12, v4, 4, s91
s_waitcnt lgkmcnt(13)
v_mfma_f32_16x16x32_bf16 v[180:183], v[96:99], v[148:151], v[180:183]
ds_read_b64 v[44:45], v248 offset:18176
v_lshlrev_b32 v23, 16, v244
v_mfma_f32_16x16x32_bf16 v[180:183], v[100:103], v[144:147], v[180:183]
ds_read_b64 v[46:47], v248 offset:18184
v_and_b32 v22, 0xffff0000, v244
v_mfma_f32_16x16x32_bf16 v[180:183], v[104:107], v[140:143], v[180:183]
ds_read_b128 v[76:79], v249 offset:6272
v_lshlrev_b32_e64 v21, 16, v245
v_mfma_f32_16x16x32_bf16 v[180:183], v[108:111], v[136:139], v[180:183]
ds_write_b128 v224, v[176:179] offset:4096
v_mfma_f32_16x16x32_bf16 v[180:183], v[112:115], v[132:135], v[180:183]
ds_read_b64 v[48:49], v248 offset:18688
v_and_b32 v20, 0xffff0000, v245
v_mfma_f32_16x16x32_bf16 v[180:183], v[116:119], v[128:131], v[180:183]
ds_read_b64 v[50:51], v248 offset:18696
v_lshlrev_b32_e64 v19, 16, v246
v_mfma_f32_16x16x32_bf16 v[184:187], v[96:99], v[152:155], v[184:187]
ds_read_b128 v[80:83], v249 offset:6784
v_and_b32 v18, 0xffff0000, v246
v_mfma_f32_16x16x32_bf16 v[184:187], v[100:103], v[148:151], v[184:187]
ds_read_b64 v[52:53], v248 offset:19200
v_lshlrev_b32_e64 v17, 16, v247
v_mfma_f32_16x16x32_bf16 v[184:187], v[104:107], v[144:147], v[184:187]
ds_read_b64 v[54:55], v248 offset:19208
v_and_b32 v16, 0xffff0000, v247
v_mfma_f32_16x16x32_bf16 v[184:187], v[108:111], v[140:143], v[184:187]
ds_write_b128 v224, v[180:183] offset:5120
v_mfma_f32_16x16x32_bf16 v[184:187], v[112:115], v[136:139], v[184:187]
buffer_store_dwordx4 v[24:27], v243, s[4:7], s60 offen offset:0 sc1
v_mfma_f32_16x16x32_bf16 v[184:187], v[116:119], v[132:135], v[184:187]
ds_read_b128 v[84:87], v249 offset:7296
v_lshlrev_b32_e64 v6, 4, v3
v_mfma_f32_16x16x32_bf16 v[184:187], v[120:123], v[128:131], v[184:187]
ds_read_b64 v[56:57], v248 offset:19712
L_pad_a_1:
s_cbranch_execz L_ret_a
v_add_u32 v7, 132864, v6
v_mfma_f32_16x16x32_bf16 v[188:191], v[96:99], v[156:159], v[188:191]
buffer_store_dwordx4 v[28:31], v243, s[4:7], s60 offen offset:1024 sc1
v_mfma_f32_16x16x32_bf16 v[188:191], v[100:103], v[152:155], v[188:191]
ds_read_b64 v[58:59], v248 offset:19720
v_mul_u32_u24 v8, 45056, v4
v_mfma_f32_16x16x32_bf16 v[188:191], v[104:107], v[148:151], v[188:191]
buffer_atomic_add v234, v232, s[4:7], s95 offen offset:12 sc0 sc1
v_mfma_f32_16x16x32_bf16 v[188:191], v[108:111], v[144:147], v[188:191]
ds_write_b128 v224, v[184:187] offset:6144
v_mfma_f32_16x16x32_bf16 v[188:191], v[112:115], v[140:143], v[188:191]
ds_read_b128 v[88:91], v249 offset:7808
v_add_u32 v8, v8, v6
v_mfma_f32_16x16x32_bf16 v[188:191], v[116:119], v[136:139], v[188:191]
ds_read_b64 v[60:61], v248 offset:20224
v_add_u32 v15, 180224, v8
v_mfma_f32_16x16x32_bf16 v[188:191], v[120:123], v[132:135], v[188:191]
ds_read_b64 v[62:63], v248 offset:20232
s_mul_i32 s53, s35, 360448
v_mfma_f32_16x16x32_bf16 v[188:191], v[124:127], v[128:131], v[188:191]
ds_read_b128 v[92:95], v249 offset:8320
s_waitcnt lgkmcnt(15)
v_mfma_f32_16x16x32_bf16 v[192:195], v[32:35], v[64:67], 0
ds_read_b64 v[96:97], v248 offset:16704
s_lshl_b32 s54, s33, 8
v_mfma_f32_16x16x32_bf16 v[196:199], v[32:35], v[68:71], 0
ds_read_b64 v[98:99], v248 offset:16712
s_add_u32 s53, s53, s54
v_mfma_f32_16x16x32_bf16 v[196:199], v[36:39], v[64:67], v[196:199]
ds_read_b128 v[128:131], v249 offset:4672
s_add_u32 s53, s53, 10485760
v_mfma_f32_16x16x32_bf16 v[200:203], v[36:39], v[68:71], 0
ds_write_b128 v224, v[188:191] offset:7168
v_mfma_f32_16x16x32_bf16 v[200:203], v[32:35], v[72:75], v[200:203]
ds_read_b64 v[100:101], v248 offset:17216
s_mul_i32 s54, s50, 768
v_mfma_f32_16x16x32_bf16 v[200:203], v[40:43], v[64:67], v[200:203]
ds_read_b64 v[102:103], v248 offset:17224
s_add_u32 s57, s53, s54
v_mfma_f32_16x16x32_bf16 v[204:207], v[36:39], v[72:75], 0
s_waitcnt lgkmcnt(2)
s_barrier
v_mfma_f32_16x16x32_bf16 v[204:207], v[40:43], v[68:71], v[204:207]
ds_read_b128 v[160:163], v225 offset:0
ds_read_b128 v[164:167], v225 offset:256
v_mfma_f32_16x16x32_bf16 v[208:211], v[40:43], v[72:75], 0
ds_read_b128 v[168:171], v225 offset:8192
ds_read_b128 v[172:175], v225 offset:8448
v_mfma_f32_16x16x32_bf16 v[204:207], v[32:35], v[76:79], v[204:207]
ds_read_b128 v[176:179], v225 offset:16384
ds_read_b128 v[180:183], v225 offset:16640
v_mfma_f32_16x16x32_bf16 v[204:207], v[44:47], v[64:67], v[204:207]
ds_read_b128 v[184:187], v225 offset:24576
ds_read_b128 v[188:191], v225 offset:24832
v_mfma_f32_16x16x32_bf16 v[208:211], v[36:39], v[76:79], v[208:211]
ds_read_b128 v[132:135], v249 offset:5184
s_add_u32 s57, s57, 32768
v_mfma_f32_16x16x32_bf16 v[208:211], v[44:47], v[68:71], v[208:211]
ds_read_b64 v[104:105], v248 offset:17728
s_lshl_b32 s54, s50, 10
v_mfma_f32_16x16x32_bf16 v[212:215], v[40:43], v[76:79], 0
ds_read_b64 v[106:107], v248 offset:17736
s_add_u32 s53, s53, s54
v_mfma_f32_16x16x32_bf16 v[212:215], v[44:47], v[72:75], v[212:215]
ds_read_b128 v[136:139], v249 offset:5696
s_lshl_b32 s55, s35, 9
v_mfma_f32_16x16x32_bf16 v[216:219], v[44:47], v[76:79], 0
ds_read_b64 v[108:109], v248 offset:18240
s_add_u32 s55, s55, 663552
v_mfma_f32_16x16x32_bf16 v[208:211], v[32:35], v[80:83], v[208:211]
s_waitcnt lgkmcnt(9)
v_pk_add_f32 v[160:161], v[160:161], v[168:169]
v_pk_add_f32 v[162:163], v[162:163], v[170:171]
v_pk_add_f32 v[164:165], v[164:165], v[172:173]
v_pk_add_f32 v[166:167], v[166:167], v[174:175]
s_waitcnt lgkmcnt(5)
s_nop 0
v_pk_add_f32 v[176:177], v[176:177], v[184:185]
v_pk_add_f32 v[178:179], v[178:179], v[186:187]
v_pk_add_f32 v[180:181], v[180:181], v[188:189]
v_pk_add_f32 v[182:183], v[182:183], v[190:191]
v_pk_add_f32 v[160:161], v[160:161], v[176:177]
v_pk_add_f32 v[162:163], v[162:163], v[178:179]
v_pk_add_f32 v[164:165], v[164:165], v[180:181]
v_pk_add_f32 v[166:167], v[166:167], v[182:183]
v_pk_fma_f32 v[160:161], v[160:161], v[240:241], v[16:17] op_sel:[0,0,0] op_sel_hi:[1,0,1]
v_pk_fma_f32 v[162:163], v[162:163], v[240:241], v[18:19] op_sel:[0,0,0] op_sel_hi:[1,0,1]
v_pk_fma_f32 v[164:165], v[164:165], v[240:241], v[20:21] op_sel:[0,0,0] op_sel_hi:[1,0,1]
v_pk_fma_f32 v[166:167], v[166:167], v[240:241], v[22:23] op_sel:[0,0,0] op_sel_hi:[1,0,1]
v_cvt_pk_bf16_f32 v252, v160, v161
v_cvt_pk_bf16_f32 v253, v162, v163
v_cvt_pk_bf16_f32 v254, v164, v165
v_cvt_pk_bf16_f32 v255, v166, v167
buffer_store_dwordx4 v[252:255], v227, s[4:7], s96 offen sc1
s_add_u32 s96, s96, 1048576
v_mfma_f32_16x16x32_bf16 v[208:211], v[48:51], v[64:67], v[208:211]
ds_read_b64 v[110:111], v248 offset:18248
s_lshl_b32 s56, s33, 7
v_mfma_f32_16x16x32_bf16 v[212:215], v[36:39], v[80:83], v[212:215]
ds_read_b128 v[140:143], v249 offset:6208
s_add_u32 s56, s56, s55
v_mfma_f32_16x16x32_bf16 v[212:215], v[48:51], v[68:71], v[212:215]
ds_read_b64 v[112:113], v248 offset:18752
s_lshl_b32 s92, s62, 12
v_mfma_f32_16x16x32_bf16 v[216:219], v[40:43], v[80:83], v[216:219]
ds_read_b64 v[114:115], v248 offset:18760
s_add_u32 s93, s53, 16384
v_mfma_f32_16x16x32_bf16 v[216:219], v[48:51], v[72:75], v[216:219]
ds_read_b128 v[144:147], v249 offset:6720
v_mfma_f32_16x16x32_bf16 v[220:223], v[44:47], v[80:83], 0
ds_read_b64 v[116:117], v248 offset:19264
v_mfma_f32_16x16x32_bf16 v[220:223], v[48:51], v[76:79], v[220:223]
ds_read_b64 v[118:119], v248 offset:19272
v_mfma_f32_16x16x32_bf16 v[212:215], v[32:35], v[84:87], v[212:215]
ds_read_b128 v[148:151], v249 offset:7232
v_mfma_f32_16x16x32_bf16 v[212:215], v[52:55], v[64:67], v[212:215]
ds_read_b64 v[120:121], v248 offset:19776
v_mfma_f32_16x16x32_bf16 v[216:219], v[36:39], v[84:87], v[216:219]
s_waitcnt vmcnt(1)
v_cmp_ne_u32_e64 vcc, v236, v234
s_nop 1
s_cbranch_vccnz L_sp_w_slow
L_sp_w_ok:
v_mfma_f32_16x16x32_bf16 v[216:219], v[52:55], v[68:71], v[216:219]
buffer_load_dwordx4 a[0:3], v237, s[4:7], s81 offen
v_mfma_f32_16x16x32_bf16 v[220:223], v[40:43], v[84:87], v[220:223]
ds_read_b64 v[122:123], v248 offset:19784
v_mfma_f32_16x16x32_bf16 v[220:223], v[52:55], v[72:75], v[220:223]
ds_read_b128 v[152:155], v249 offset:7744
v_mfma_f32_16x16x32_bf16 v[216:219], v[32:35], v[88:91], v[216:219]
buffer_load_dwordx4 a[4:7], v238, s[4:7], s81 offen
v_mfma_f32_16x16x32_bf16 v[216:219], v[56:59], v[64:67], v[216:219]
ds_read_b64 v[124:125], v248 offset:20288
v_mfma_f32_16x16x32_bf16 v[220:223], v[36:39], v[88:91], v[220:223]
ds_read_b64 v[126:127], v248 offset:20296
v_mfma_f32_16x16x32_bf16 v[220:223], v[56:59], v[68:71], v[220:223]
buffer_load_dwordx4 a[8:11], v239, s[4:7], s81 offen
s_add_u32 s81, s81, 1024
v_mfma_f32_16x16x32_bf16 v[220:223], v[32:35], v[92:95], v[220:223]
ds_read_b128 v[156:159], v249 offset:8256
v_mfma_f32_16x16x32_bf16 v[220:223], v[60:63], v[64:67], v[220:223]
ds_read_b128 v[244:247], v226 offset:8384
v_mfma_f32_16x16x32_bf16 v[192:195], v[96:99], v[128:131], v[192:195]
buffer_load_dwordx4 a[12:15], v237, s[4:7], s81 offen
s_waitcnt lgkmcnt(15)
v_mfma_f32_16x16x32_bf16 v[196:199], v[96:99], v[132:135], v[196:199]
v_mov_b32 v55, v238
v_and_b32 v48, 1, v1
v_mfma_f32_16x16x32_bf16 v[196:199], v[100:103], v[128:131], v[196:199]
v_lshlrev_b32 v48, 3, v48
v_and_b32_e64 v6, 2, v1
v_mfma_f32_16x16x32_bf16 v[200:203], v[96:99], v[136:139], v[200:203]
buffer_load_dwordx4 a[16:19], v238, s[4:7], s81 offen
v_mfma_f32_16x16x32_bf16 v[200:203], v[100:103], v[132:135], v[200:203]
ds_write_b128 v224, v[192:195] offset:32768
v_mfma_f32_16x16x32_bf16 v[200:203], v[104:107], v[128:131], v[200:203]
v_lshl_add_u32 v48, v6, 6, v48
s_waitcnt lgkmcnt(14)
v_mfma_f32_16x16x32_bf16 v[204:207], v[96:99], v[140:143], v[204:207]
ds_write_b128 v224, v[196:199] offset:33792
v_mfma_f32_16x16x32_bf16 v[204:207], v[100:103], v[136:139], v[204:207]
buffer_load_dwordx4 a[20:23], v239, s[4:7], s81 offen
s_add_u32 s81, s81, 1024
v_mfma_f32_16x16x32_bf16 v[204:207], v[104:107], v[132:135], v[204:207]
v_lshrrev_b32 v6, 2, v1
v_and_b32 v11, 7, v6
v_mfma_f32_16x16x32_bf16 v[204:207], v[108:111], v[128:131], v[204:207]
ds_write_b128 v224, v[200:203] offset:34816
s_waitcnt lgkmcnt(13)
v_mfma_f32_16x16x32_bf16 v[208:211], v[96:99], v[144:147], v[208:211]
buffer_load_dwordx4 a[24:27], v237, s[4:7], s81 offen
v_mfma_f32_16x16x32_bf16 v[208:211], v[100:103], v[140:143], v[208:211]
v_lshl_add_u32 v6, v6, 8, v48
v_lshl_add_u32 v40, v11, 4, v6
v_mfma_f32_16x16x32_bf16 v[208:211], v[104:107], v[136:139], v[208:211]
v_xor_b32 v41, 16, v40
v_xor_b32_e64 v42, 32, v40
s_waitcnt lgkmcnt(3)
v_mfma_f32_16x16x32_bf16 v[208:211], v[108:111], v[132:135], v[208:211]
ds_write_b128 v224, v[204:207] offset:35840
v_mfma_f32_16x16x32_bf16 v[208:211], v[112:115], v[128:131], v[208:211]
s_waitcnt vmcnt(7)
s_barrier
v_mfma_f32_16x16x32_bf16 v[212:215], v[96:99], v[148:151], v[212:215]
buffer_atomic_add v233, v230, s[4:7], s101 offen offset:8 sc1
v_mfma_f32_16x16x32_bf16 v[212:215], v[100:103], v[144:147], v[212:215]
buffer_load_dwordx4 a[28:31], v238, s[4:7], s81 offen
v_mfma_f32_16x16x32_bf16 v[212:215], v[104:107], v[140:143], v[212:215]
v_lshlrev_b32_e64 v23, 16, v244
v_xor_b32_e64 v43, 48, v40
v_mfma_f32_16x16x32_bf16 v[212:215], v[108:111], v[136:139], v[212:215]
ds_write_b128 v224, v[208:211] offset:36864
v_mfma_f32_16x16x32_bf16 v[212:215], v[112:115], v[132:135], v[212:215]
v_mov_b32_e64 v236, 0
buffer_atomic_add v236, v229, s[4:7], s79 offen offset:8 sc0 sc1
v_mfma_f32_16x16x32_bf16 v[212:215], v[116:119], v[128:131], v[212:215]
buffer_load_dwordx4 a[32:35], v239, s[4:7], s81 offen
s_add_u32 s81, s81, 1024
v_mfma_f32_16x16x32_bf16 v[216:219], v[96:99], v[152:155], v[216:219]
v_and_b32 v22, 0xffff0000, v244
v_xor_b32_e64 v44, 64, v40
v_mfma_f32_16x16x32_bf16 v[216:219], v[100:103], v[148:151], v[216:219]
v_lshlrev_b32_e64 v21, 16, v245
v_xor_b32 v45, 80, v40
v_mfma_f32_16x16x32_bf16 v[216:219], v[104:107], v[144:147], v[216:219]
buffer_load_dwordx4 a[36:39], v237, s[4:7], s81 offen
v_mfma_f32_16x16x32_bf16 v[216:219], v[108:111], v[140:143], v[216:219]
ds_write_b128 v224, v[212:215] offset:37888
v_mfma_f32_16x16x32_bf16 v[216:219], v[112:115], v[136:139], v[216:219]
v_and_b32 v20, 0xffff0000, v245
v_xor_b32 v46, 96, v40
v_mfma_f32_16x16x32_bf16 v[216:219], v[116:119], v[132:135], v[216:219]
buffer_load_dwordx4 a[40:43], v238, s[4:7], s81 offen
v_mfma_f32_16x16x32_bf16 v[216:219], v[120:123], v[128:131], v[216:219]
v_lshlrev_b32_e64 v19, 16, v246
v_xor_b32 v47, 112, v40
v_mfma_f32_16x16x32_bf16 v[220:223], v[96:99], v[156:159], v[220:223]
v_and_b32 v18, 0xffff0000, v246
v_mov_b32_e64 v54, v229
v_mfma_f32_16x16x32_bf16 v[220:223], v[100:103], v[152:155], v[220:223]
buffer_load_dwordx4 a[44:47], v239, s[4:7], s81 offen
s_add_u32 s81, s81, 1024
v_mfma_f32_16x16x32_bf16 v[220:223], v[104:107], v[148:151], v[220:223]
v_lshlrev_b32_e64 v17, 16, v247
v_add_u32_e64 v57, s78, v2
v_mfma_f32_16x16x32_bf16 v[220:223], v[108:111], v[144:147], v[220:223]
ds_write_b128 v224, v[216:219] offset:38912
v_mfma_f32_16x16x32_bf16 v[220:223], v[112:115], v[140:143], v[220:223]
buffer_load_dwordx4 a[48:51], v237, s[4:7], s81 offen
v_mfma_f32_16x16x32_bf16 v[220:223], v[116:119], v[136:139], v[220:223]
v_and_b32 v16, 0xffff0000, v247
v_and_b32_e64 v58, 7, v3
v_mfma_f32_16x16x32_bf16 v[220:223], v[120:123], v[132:135], v[220:223]
v_lshl_add_u32 v58, v4, 3, v58
v_lshlrev_b32 v58, 3, v58
v_mfma_f32_16x16x32_bf16 v[220:223], v[124:127], v[128:131], v[220:223]
buffer_load_dwordx4 a[52:55], v238, s[4:7], s81 offen
s_nop 6
ds_write_b128 v224, v[220:223] offset:39936
s_waitcnt lgkmcnt(0)
s_barrier
ds_read_b128 v[160:163], v225 offset:32768
ds_read_b128 v[164:167], v225 offset:33024
ds_read_b128 v[168:171], v225 offset:40960
ds_read_b128 v[172:175], v225 offset:41216
ds_read_b128 v[176:179], v225 offset:49152
ds_read_b128 v[180:183], v225 offset:49408
ds_read_b128 v[184:187], v225 offset:57344
ds_read_b128 v[188:191], v225 offset:57600
buffer_atomic_add v235, v229, s[4:7], s79 offen offset:8 sc0 sc1
s_waitcnt lgkmcnt(4)
v_pk_add_f32 v[160:161], v[160:161], v[168:169]
v_pk_add_f32 v[162:163], v[162:163], v[170:171]
v_pk_add_f32 v[164:165], v[164:165], v[172:173]
v_pk_add_f32 v[166:167], v[166:167], v[174:175]
s_waitcnt lgkmcnt(0)
v_pk_add_f32 v[176:177], v[176:177], v[184:185]
v_pk_add_f32 v[178:179], v[178:179], v[186:187]
v_pk_add_f32 v[180:181], v[180:181], v[188:189]
v_pk_add_f32 v[182:183], v[182:183], v[190:191]
v_pk_add_f32 v[160:161], v[160:161], v[176:177]
v_pk_add_f32 v[162:163], v[162:163], v[178:179]
v_pk_add_f32 v[164:165], v[164:165], v[180:181]
v_pk_add_f32 v[166:167], v[166:167], v[182:183]
v_pk_fma_f32 v[160:161], v[160:161], v[240:241], v[16:17] op_sel:[0,1,0] op_sel_hi:[1,1,1]
v_pk_fma_f32 v[162:163], v[162:163], v[240:241], v[18:19] op_sel:[0,1,0] op_sel_hi:[1,1,1]
v_pk_fma_f32 v[164:165], v[164:165], v[240:241], v[20:21] op_sel:[0,1,0] op_sel_hi:[1,1,1]
v_pk_fma_f32 v[166:167], v[166:167], v[240:241], v[22:23] op_sel:[0,1,0] op_sel_hi:[1,1,1]
v_cvt_pk_bf16_f32 v252, v160, v161
v_cvt_pk_bf16_f32 v253, v162, v163
v_cvt_pk_bf16_f32 v254, v164, v165
v_cvt_pk_bf16_f32 v255, v166, v167
buffer_store_dwordx4 v[252:255], v227, s[4:7], s96 offen sc1
buffer_load_dwordx4 a[56:59], v239, s[4:7], s81 offen
s_add_u32 s81, s81, 1024
buffer_load_dwordx4 a[60:63], v237, s[4:7], s81 offen
buffer_load_dwordx4 a[64:67], v238, s[4:7], s81 offen
buffer_load_dwordx4 a[68:71], v239, s[4:7], s81 offen
s_add_u32 s81, s81, 1024
buffer_load_dwordx4 a[72:75], v237, s[4:7], s81 offen
buffer_load_dwordx4 a[76:79], v238, s[4:7], s81 offen
buffer_load_dwordx4 a[80:83], v239, s[4:7], s81 offen
s_add_u32 s81, s81, 1024
s_cmp_lg_u32 s33, 3
s_cbranch_scc1 L_s2_nopoll
s_mov_b32 exec_lo, 0x0000ffff
s_mov_b32 exec_hi, 0x00000000
s_waitcnt vmcnt(15)
v_cmp_ne_u32_e64 vcc, 16, v236
s_nop 1
s_cbranch_vccz L_sp_s2_ok
s_waitcnt vmcnt(8)
s_mov_b32 s70, 0
L_sp_s2:
v_cmp_ne_u32_e64 vcc, 16, v235
s_nop 4
s_cbranch_vccz L_sp_s2_ok
v_mov_b32_e64 v235, 0
buffer_atomic_add v235, v229, s[4:7], s79 offen offset:8 sc0 sc1
s_waitcnt vmcnt(0)
s_add_u32 s70, s70, 1
s_cmp_lt_u32 s70, 2097152
s_cbranch_scc1 L_sp_s2
L_sp_s2_ok:
s_mov_b64 exec, -1
L_s2_nopoll:
s_barrier
buffer_load_dwordx4 v9, s[4:7], s86 offen lds
s_add_u32 m0, m0, 1024
s_nop 0
buffer_load_dwordx4 v10, s[4:7], s86 offen lds
s_add_u32 m0, m0, 7168
s_add_u32 s86, s86, 131072
buffer_load_dwordx4 v9, s[4:7], s86 offen lds
s_add_u32 m0, m0, 1024
s_nop 0
buffer_load_dwordx4 v10, s[4:7], s86 offen lds
s_add_u32 m0, m0, 7168
s_add_u32 s86, s86, 131072
buffer_load_dwordx4 v9, s[4:7], s86 offen lds
s_add_u32 m0, m0, 1024
s_nop 0
buffer_load_dwordx4 v10, s[4:7], s86 offen lds
s_add_u32 m0, m0, 7168
s_add_u32 s86, s86, 131072
buffer_load_dwordx4 v9, s[4:7], s86 offen lds
s_add_u32 m0, m0, 1024
s_nop 0
buffer_load_dwordx4 v10, s[4:7], s86 offen lds
s_add_u32 m0, m0, 7168
s_add_u32 s86, s86, 131072
buffer_load_dwordx4 v9, s[4:7], s86 offen lds
s_add_u32 m0, m0, 1024
s_nop 0
buffer_load_dwordx4 v10, s[4:7], s86 offen lds
s_add_u32 m0, m0, 7168
s_add_u32 s86, s86, 131072
v_lshrrev_b32 v6, 3, v3
v_mul_u32_u24 v6, 49152, v6
v_add_u32 v58, v58, v6
v_lshrrev_b32 v11, 2, v3
v_lshrrev_b32 v6, 1, v4
v_lshl_add_u32 v6, v6, 3, v11
v_and_b32 v59, 1, v4
v_lshl_add_u32 v6, v59, 8, v6
v_lshl_add_u32 v6, v6, 8, v48
v_add_u32 v6, s92, v6
v_xor_b32 v11, s3, v11
v_lshl_add_u32 v59, v11, 4, v6
v_xor_b32 v60, 64, v59
v_cmp_gt_u32 vcc, 16, v1
v_and_b32 v6, 7, v3
v_lshl_add_u32 v56, v6, 3, s91
v_cndmask_b32 v52, 0, 16, vcc
v_and_b32_e64 v6, 1, v3
v_cmp_eq_u32_e64 vcc, 0, v6
v_and_b32_e64 v6, 1, v4
v_lshl_add_u32 v56, v6, 6, v56
v_mov_b32 v11, 0xbfb8aa3b
v_cndmask_b32_e64 v63, 1.0, v11, vcc
v_and_b32_e64 v6, 2, v4
v_lshl_add_u32 v56, v6, 1, v56
s_add_u32 s58, s2, s33
s_cmp_lg_u32 s58, 0
s_cbranch_scc1 L_noepoch
v_mov_b32_e64 v11, s32
s_mov_b32 exec_lo, 0x00000001
s_mov_b32 exec_hi, 0x00000000
buffer_store_dword v11, off, s[4:7], 0 offset:0 sc1
s_mov_b64 exec, -1
L_noepoch:
s_cmp_eq_u32 s33, 3
s_cbranch_scc1 L_g1_w3

L_pad_b_0:
s_cbranch_execz L_pad_b_1
s_waitcnt vmcnt(8)
s_barrier
ds_read_b64_tr_b16 a[192:193], v40 offset:0
ds_read_b64_tr_b16 a[194:195], v40 offset:4096
ds_read_b64_tr_b16 a[196:197], v41 offset:0
ds_read_b64_tr_b16 a[198:199], v41 offset:4096
ds_read_b64_tr_b16 a[200:201], v42 offset:0
ds_read_b64_tr_b16 a[202:203], v42 offset:4096
ds_read_b64_tr_b16 a[204:205], v43 offset:0
ds_read_b64_tr_b16 a[206:207], v43 offset:4096
ds_read_b64_tr_b16 a[208:209], v44 offset:0
ds_read_b64_tr_b16 a[210:211], v44 offset:4096
s_waitcnt lgkmcnt(8)
v_mfma_f32_16x16x32_bf16 v[64:67], a[0:3], a[192:195], 0
ds_read_b64_tr_b16 a[212:213], v45 offset:0
v_mfma_f32_16x16x32_bf16 v[68:71], a[4:7], a[192:195], 0
ds_read_b64_tr_b16 a[214:215], v45 offset:4096
s_waitcnt lgkmcnt(8)
v_mfma_f32_16x16x32_bf16 v[72:75], a[8:11], a[192:195], 0
v_mfma_f32_16x16x32_bf16 v[76:79], a[0:3], a[196:199], 0
ds_read_b64_tr_b16 a[216:217], v46 offset:0
v_mfma_f32_16x16x32_bf16 v[80:83], a[4:7], a[196:199], 0
ds_read_b64_tr_b16 a[218:219], v46 offset:4096
s_waitcnt lgkmcnt(8)
v_mfma_f32_16x16x32_bf16 v[84:87], a[8:11], a[196:199], 0
buffer_load_dwordx4 v9, s[4:7], s86 offen lds
v_mfma_f32_16x16x32_bf16 v[88:91], a[0:3], a[200:203], 0
ds_read_b64_tr_b16 a[220:221], v47 offset:0
s_add_u32 m0, m0, 1024
v_mfma_f32_16x16x32_bf16 v[92:95], a[4:7], a[200:203], 0
ds_read_b64_tr_b16 a[222:223], v47 offset:4096
s_waitcnt lgkmcnt(8)
v_mfma_f32_16x16x32_bf16 v[96:99], a[8:11], a[200:203], 0
s_waitcnt vmcnt(7)
s_barrier
v_mfma_f32_16x16x32_bf16 v[100:103], a[0:3], a[204:207], 0
ds_read_b64_tr_b16 a[192:193], v40 offset:8192
v_mfma_f32_16x16x32_bf16 v[104:107], a[4:7], a[204:207], 0
ds_read_b64_tr_b16 a[194:195], v40 offset:12288
s_waitcnt lgkmcnt(8)
v_mfma_f32_16x16x32_bf16 v[108:111], a[8:11], a[204:207], 0
buffer_load_dwordx4 v10, s[4:7], s86 offen lds
v_mfma_f32_16x16x32_bf16 v[112:115], a[0:3], a[208:211], 0
ds_read_b64_tr_b16 a[196:197], v41 offset:8192
s_add_u32 m0, m0, 7168
v_mfma_f32_16x16x32_bf16 v[116:119], a[4:7], a[208:211], 0
ds_read_b64_tr_b16 a[198:199], v41 offset:12288
s_waitcnt lgkmcnt(8)
v_mfma_f32_16x16x32_bf16 v[120:123], a[8:11], a[208:211], 0
s_add_u32 s86, s86, 131072
buffer_load_dwordx4 v9, s[4:7], s86 offen lds
v_mfma_f32_16x16x32_bf16 v[124:127], a[0:3], a[212:215], 0
ds_read_b64_tr_b16 a[200:201], v42 offset:8192
s_add_u32 m0, m0, 1024
v_mfma_f32_16x16x32_bf16 v[128:131], a[4:7], a[212:215], 0
ds_read_b64_tr_b16 a[202:203], v42 offset:12288
s_waitcnt lgkmcnt(8)
v_mfma_f32_16x16x32_bf16 v[132:135], a[8:11], a[212:215], 0
buffer_load_dwordx4 v10, s[4:7], s86 offen lds
v_mfma_f32_16x16x32_bf16 v[136:139], a[0:3], a[216:219], 0
ds_read_b64_tr_b16 a[204:205], v43 offset:8192
s_add_u32 m0, m0, 7168
v_mfma_f32_16x16x32_bf16 v[140:143], a[4:7], a[216:219], 0
ds_read_b64_tr_b16 a[206:207], v43 offset:12288
s_waitcnt lgkmcnt(8)
v_mfma_f32_16x16x32_bf16 v[144:147], a[8:11], a[216:219], 0
s_add_u32 s86, s86, 131072
buffer_load_dwordx4 v9, s[4:7], s86 offen lds
v_mfma_f32_16x16x32_bf16 v[148:151], a[0:3], a[220:223], 0
ds_read_b64_tr_b16 a[208:209], v44 offset:8192
s_add_u32 m0, m0, 1024
v_mfma_f32_16x16x32_bf16 v[152:155], a[4:7], a[220:223], 0
ds_read_b64_tr_b16 a[210:211], v44 offset:12288
s_waitcnt lgkmcnt(8)
v_mfma_f32_16x16x32_bf16 v[156:159], a[8:11], a[220:223], 0
buffer_load_dwordx4 v10, s[4:7], s86 offen lds
v_mfma_f32_16x16x32_bf16 v[64:67], a[12:15], a[192:195], v[64:67]
ds_read_b64_tr_b16 a[212:213], v45 offset:8192
s_add_u32 m0, m0, 7168
v_mfma_f32_16x16x32_bf16 v[68:71], a[16:19], a[192:195], v[68:71]
ds_read_b64_tr_b16 a[214:215], v45 offset:12288
s_waitcnt lgkmcnt(8)
v_mfma_f32_16x16x32_bf16 v[72:75], a[20:23], a[192:195], v[72:75]
s_add_u32 s86, s86, 131072
v_mfma_f32_16x16x32_bf16 v[76:79], a[12:15], a[196:199], v[76:79]
ds_read_b64_tr_b16 a[216:217], v46 offset:8192
v_mfma_f32_16x16x32_bf16 v[80:83], a[16:19], a[196:199], v[80:83]
ds_read_b64_tr_b16 a[218:219], v46 offset:12288
s_waitcnt lgkmcnt(8)
v_mfma_f32_16x16x32_bf16 v[84:87], a[20:23], a[196:199], v[84:87]
buffer_load_dwordx4 a[84:87], v13, s[4:7], s81 offen
v_mfma_f32_16x16x32_bf16 v[88:91], a[12:15], a[200:203], v[88:91]
ds_read_b64_tr_b16 a[220:221], v47 offset:8192
v_mfma_f32_16x16x32_bf16 v[92:95], a[16:19], a[200:203], v[92:95]
ds_read_b64_tr_b16 a[222:223], v47 offset:12288
s_waitcnt lgkmcnt(8)
v_mfma_f32_16x16x32_bf16 v[96:99], a[20:23], a[200:203], v[96:99]
s_waitcnt vmcnt(9)
s_barrier
v_mfma_f32_16x16x32_bf16 v[100:103], a[12:15], a[204:207], v[100:103]
ds_read_b64_tr_b16 a[192:193], v40 offset:16384
v_mfma_f32_16x16x32_bf16 v[104:107], a[16:19], a[204:207], v[104:107]
ds_read_b64_tr_b16 a[194:195], v40 offset:20480
s_waitcnt lgkmcnt(8)
v_mfma_f32_16x16x32_bf16 v[108:111], a[20:23], a[204:207], v[108:111]
buffer_load_dwordx4 a[88:91], v55, s[4:7], s81 offen
v_mfma_f32_16x16x32_bf16 v[112:115], a[12:15], a[208:211], v[112:115]
ds_read_b64_tr_b16 a[196:197], v41 offset:16384
v_mfma_f32_16x16x32_bf16 v[116:119], a[16:19], a[208:211], v[116:119]
ds_read_b64_tr_b16 a[198:199], v41 offset:20480
s_waitcnt lgkmcnt(8)
v_mfma_f32_16x16x32_bf16 v[120:123], a[20:23], a[208:211], v[120:123]
buffer_load_dwordx4 a[92:95], v14, s[4:7], s81 offen
v_mfma_f32_16x16x32_bf16 v[124:127], a[12:15], a[212:215], v[124:127]
ds_read_b64_tr_b16 a[200:201], v42 offset:16384
s_add_u32 s81, s81, 1024
v_mfma_f32_16x16x32_bf16 v[128:131], a[16:19], a[212:215], v[128:131]
ds_read_b64_tr_b16 a[202:203], v42 offset:20480
s_waitcnt lgkmcnt(8)
v_mfma_f32_16x16x32_bf16 v[132:135], a[20:23], a[212:215], v[132:135]
buffer_load_dwordx4 a[96:99], v13, s[4:7], s81 offen
v_mfma_f32_16x16x32_bf16 v[136:139], a[12:15], a[216:219], v[136:139]
ds_read_b64_tr_b16 a[204:205], v43 offset:16384
v_mfma_f32_16x16x32_bf16 v[140:143], a[16:19], a[216:219], v[140:143]
ds_read_b64_tr_b16 a[206:207], v43 offset:20480
s_waitcnt lgkmcnt(8)
v_mfma_f32_16x16x32_bf16 v[144:147], a[20:23], a[216:219], v[144:147]
buffer_load_dwordx4 a[100:103], v55, s[4:7], s81 offen
v_mfma_f32_16x16x32_bf16 v[148:151], a[12:15], a[220:223], v[148:151]
ds_read_b64_tr_b16 a[208:209], v44 offset:16384
v_mfma_f32_16x16x32_bf16 v[152:155], a[16:19], a[220:223], v[152:155]
ds_read_b64_tr_b16 a[210:211], v44 offset:20480
s_waitcnt lgkmcnt(8)
v_mfma_f32_16x16x32_bf16 v[156:159], a[20:23], a[220:223], v[156:159]
buffer_load_dwordx4 a[104:107], v14, s[4:7], s81 offen
v_mfma_f32_16x16x32_bf16 v[64:67], a[24:27], a[192:195], v[64:67]
ds_read_b64_tr_b16 a[212:213], v45 offset:16384
s_add_u32 s81, s81, 1024
v_mfma_f32_16x16x32_bf16 v[68:71], a[28:31], a[192:195], v[68:71]
ds_read_b64_tr_b16 a[214:215], v45 offset:20480
s_waitcnt lgkmcnt(8)
v_mfma_f32_16x16x32_bf16 v[72:75], a[32:35], a[192:195], v[72:75]
v_mfma_f32_16x16x32_bf16 v[76:79], a[24:27], a[196:199], v[76:79]
ds_read_b64_tr_b16 a[216:217], v46 offset:16384
v_mfma_f32_16x16x32_bf16 v[80:83], a[28:31], a[196:199], v[80:83]
ds_read_b64_tr_b16 a[218:219], v46 offset:20480
s_waitcnt lgkmcnt(8)
v_mfma_f32_16x16x32_bf16 v[84:87], a[32:35], a[196:199], v[84:87]
buffer_load_dwordx4 a[108:111], v13, s[4:7], s81 offen
v_mfma_f32_16x16x32_bf16 v[88:91], a[24:27], a[200:203], v[88:91]
ds_read_b64_tr_b16 a[220:221], v47 offset:16384
v_mfma_f32_16x16x32_bf16 v[92:95], a[28:31], a[200:203], v[92:95]
ds_read_b64_tr_b16 a[222:223], v47 offset:20480
s_waitcnt lgkmcnt(8)
v_mfma_f32_16x16x32_bf16 v[96:99], a[32:35], a[200:203], v[96:99]
buffer_load_dwordx4 a[112:115], v55, s[4:7], s81 offen
v_mfma_f32_16x16x32_bf16 v[100:103], a[24:27], a[204:207], v[100:103]
ds_read_b64_tr_b16 a[192:193], v40 offset:24576
v_mfma_f32_16x16x32_bf16 v[104:107], a[28:31], a[204:207], v[104:107]
ds_read_b64_tr_b16 a[194:195], v40 offset:28672
s_waitcnt lgkmcnt(8)
v_mfma_f32_16x16x32_bf16 v[108:111], a[32:35], a[204:207], v[108:111]
buffer_load_dwordx4 v[228:231], v2, s[4:7], s87 offen offset:0
v_mfma_f32_16x16x32_bf16 v[112:115], a[24:27], a[208:211], v[112:115]
ds_read_b64_tr_b16 a[196:197], v41 offset:24576
v_mfma_f32_16x16x32_bf16 v[116:119], a[28:31], a[208:211], v[116:119]
ds_read_b64_tr_b16 a[198:199], v41 offset:28672
s_waitcnt lgkmcnt(8)
v_mfma_f32_16x16x32_bf16 v[120:123], a[32:35], a[208:211], v[120:123]
v_mfma_f32_16x16x32_bf16 v[124:127], a[24:27], a[212:215], v[124:127]
ds_read_b64_tr_b16 a[200:201], v42 offset:24576
v_mfma_f32_16x16x32_bf16 v[128:131], a[28:31], a[212:215], v[128:131]
ds_read_b64_tr_b16 a[202:203], v42 offset:28672
s_waitcnt lgkmcnt(8)
v_mfma_f32_16x16x32_bf16 v[132:135], a[32:35], a[212:215], v[132:135]
buffer_load_dwordx4 v[232:235], v2, s[4:7], s87 offen offset:1024
v_mfma_f32_16x16x32_bf16 v[136:139], a[24:27], a[216:219], v[136:139]
ds_read_b64_tr_b16 a[204:205], v43 offset:24576
v_mfma_f32_16x16x32_bf16 v[140:143], a[28:31], a[216:219], v[140:143]
ds_read_b64_tr_b16 a[206:207], v43 offset:28672
s_waitcnt lgkmcnt(8)
v_mfma_f32_16x16x32_bf16 v[144:147], a[32:35], a[216:219], v[144:147]
buffer_load_dwordx4 v[236:239], v2, s[4:7], s87 offen offset:2048
v_mfma_f32_16x16x32_bf16 v[148:151], a[24:27], a[220:223], v[148:151]
ds_read_b64_tr_b16 a[208:209], v44 offset:24576
v_mfma_f32_16x16x32_bf16 v[152:155], a[28:31], a[220:223], v[152:155]
ds_read_b64_tr_b16 a[210:211], v44 offset:28672
s_waitcnt lgkmcnt(8)
v_mfma_f32_16x16x32_bf16 v[156:159], a[32:35], a[220:223], v[156:159]
buffer_load_dwordx4 v[240:243], v2, s[4:7], s87 offen offset:3072
v_mfma_f32_16x16x32_bf16 v[64:67], a[36:39], a[192:195], v[64:67]
ds_read_b64_tr_b16 a[212:213], v45 offset:24576
v_mfma_f32_16x16x32_bf16 v[68:71], a[40:43], a[192:195], v[68:71]
ds_read_b64_tr_b16 a[214:215], v45 offset:28672
s_waitcnt lgkmcnt(8)
v_mfma_f32_16x16x32_bf16 v[72:75], a[44:47], a[192:195], v[72:75]
v_mfma_f32_16x16x32_bf16 v[76:79], a[36:39], a[196:199], v[76:79]
L_pad_b_1:
s_cbranch_execz L_pad_b_2
ds_read_b64_tr_b16 a[216:217], v46 offset:24576
v_mfma_f32_16x16x32_bf16 v[80:83], a[40:43], a[196:199], v[80:83]
ds_read_b64_tr_b16 a[218:219], v46 offset:28672
s_waitcnt lgkmcnt(8)
v_mfma_f32_16x16x32_bf16 v[84:87], a[44:47], a[196:199], v[84:87]
buffer_load_dwordx4 v[244:247], v2, s[4:7], s88 offen offset:0
v_mfma_f32_16x16x32_bf16 v[88:91], a[36:39], a[200:203], v[88:91]
ds_read_b64_tr_b16 a[220:221], v47 offset:24576
v_mfma_f32_16x16x32_bf16 v[92:95], a[40:43], a[200:203], v[92:95]
ds_read_b64_tr_b16 a[222:223], v47 offset:28672
s_waitcnt lgkmcnt(8)
v_mfma_f32_16x16x32_bf16 v[96:99], a[44:47], a[200:203], v[96:99]
s_waitcnt vmcnt(19)
s_barrier
v_mfma_f32_16x16x32_bf16 v[100:103], a[36:39], a[204:207], v[100:103]
ds_read_b64_tr_b16 a[192:193], v40 offset:32768
v_mfma_f32_16x16x32_bf16 v[104:107], a[40:43], a[204:207], v[104:107]
ds_read_b64_tr_b16 a[194:195], v40 offset:36864
s_waitcnt lgkmcnt(8)
v_mfma_f32_16x16x32_bf16 v[108:111], a[44:47], a[204:207], v[108:111]
buffer_load_dwordx4 v[248:251], v2, s[4:7], s88 offen offset:1024
v_mfma_f32_16x16x32_bf16 v[112:115], a[36:39], a[208:211], v[112:115]
ds_read_b64_tr_b16 a[196:197], v41 offset:32768
v_mfma_f32_16x16x32_bf16 v[116:119], a[40:43], a[208:211], v[116:119]
ds_read_b64_tr_b16 a[198:199], v41 offset:36864
s_waitcnt lgkmcnt(8)
v_mfma_f32_16x16x32_bf16 v[120:123], a[44:47], a[208:211], v[120:123]
buffer_load_dwordx2 v[224:225], v58, s[4:7], s89 offen
v_mfma_f32_16x16x32_bf16 v[124:127], a[36:39], a[212:215], v[124:127]
ds_read_b64_tr_b16 a[200:201], v42 offset:32768
v_mfma_f32_16x16x32_bf16 v[128:131], a[40:43], a[212:215], v[128:131]
ds_read_b64_tr_b16 a[202:203], v42 offset:36864
s_waitcnt lgkmcnt(8)
v_mfma_f32_16x16x32_bf16 v[132:135], a[44:47], a[212:215], v[132:135]
buffer_load_dwordx2 v[252:253], v58, s[4:7], s90 offen
v_mfma_f32_16x16x32_bf16 v[136:139], a[36:39], a[216:219], v[136:139]
ds_read_b64_tr_b16 a[204:205], v43 offset:32768
v_mfma_f32_16x16x32_bf16 v[140:143], a[40:43], a[216:219], v[140:143]
ds_read_b64_tr_b16 a[206:207], v43 offset:36864
s_waitcnt lgkmcnt(8)
v_mfma_f32_16x16x32_bf16 v[144:147], a[44:47], a[216:219], v[144:147]
buffer_load_dwordx4 a[116:119], v14, s[4:7], s81 offen
v_mfma_f32_16x16x32_bf16 v[148:151], a[36:39], a[220:223], v[148:151]
ds_read_b64_tr_b16 a[208:209], v44 offset:32768
s_add_u32 s81, s81, 1024
v_mfma_f32_16x16x32_bf16 v[152:155], a[40:43], a[220:223], v[152:155]
ds_read_b64_tr_b16 a[210:211], v44 offset:36864
s_waitcnt lgkmcnt(8)
v_mfma_f32_16x16x32_bf16 v[156:159], a[44:47], a[220:223], v[156:159]
buffer_load_dwordx4 a[120:123], v13, s[4:7], s81 offen
v_mfma_f32_16x16x32_bf16 v[64:67], a[48:51], a[192:195], v[64:67]
ds_read_b64_tr_b16 a[212:213], v45 offset:32768
v_mfma_f32_16x16x32_bf16 v[68:71], a[52:55], a[192:195], v[68:71]
ds_read_b64_tr_b16 a[214:215], v45 offset:36864
s_waitcnt lgkmcnt(8)
v_mfma_f32_16x16x32_bf16 v[72:75], a[56:59], a[192:195], v[72:75]
v_mfma_f32_16x16x32_bf16 v[76:79], a[48:51], a[196:199], v[76:79]
ds_read_b64_tr_b16 a[216:217], v46 offset:32768
v_mfma_f32_16x16x32_bf16 v[80:83], a[52:55], a[196:199], v[80:83]
ds_read_b64_tr_b16 a[218:219], v46 offset:36864
s_waitcnt lgkmcnt(8)
v_mfma_f32_16x16x32_bf16 v[84:87], a[56:59], a[196:199], v[84:87]
buffer_load_dwordx4 a[124:127], v55, s[4:7], s81 offen
v_mfma_f32_16x16x32_bf16 v[88:91], a[48:51], a[200:203], v[88:91]
ds_read_b64_tr_b16 a[220:221], v47 offset:32768
v_mfma_f32_16x16x32_bf16 v[92:95], a[52:55], a[200:203], v[92:95]
ds_read_b64_tr_b16 a[222:223], v47 offset:36864
s_waitcnt lgkmcnt(8)
v_mfma_f32_16x16x32_bf16 v[96:99], a[56:59], a[200:203], v[96:99]
s_waitcnt vmcnt(19)
s_barrier
v_mfma_f32_16x16x32_bf16 v[100:103], a[48:51], a[204:207], v[100:103]
ds_read_b64_tr_b16 a[192:193], v40 offset:40960
v_mfma_f32_16x16x32_bf16 v[104:107], a[52:55], a[204:207], v[104:107]
ds_read_b64_tr_b16 a[194:195], v40 offset:45056
s_waitcnt lgkmcnt(8)
v_mfma_f32_16x16x32_bf16 v[108:111], a[56:59], a[204:207], v[108:111]
buffer_load_dwordx4 v9, s[4:7], s86 offen lds
v_mfma_f32_16x16x32_bf16 v[112:115], a[48:51], a[208:211], v[112:115]
ds_read_b64_tr_b16 a[196:197], v41 offset:40960
s_add_u32 m0, m0, 1024
v_mfma_f32_16x16x32_bf16 v[116:119], a[52:55], a[208:211], v[116:119]
ds_read_b64_tr_b16 a[198:199], v41 offset:45056
s_waitcnt lgkmcnt(8)
v_mfma_f32_16x16x32_bf16 v[120:123], a[56:59], a[208:211], v[120:123]
buffer_load_dwordx4 v10, s[4:7], s86 offen lds
v_mfma_f32_16x16x32_bf16 v[124:127], a[48:51], a[212:215], v[124:127]
ds_read_b64_tr_b16 a[200:201], v42 offset:40960
s_add_u32 m0, m0, 7168
v_mfma_f32_16x16x32_bf16 v[128:131], a[52:55], a[212:215], v[128:131]
ds_read_b64_tr_b16 a[202:203], v42 offset:45056
s_waitcnt lgkmcnt(8)
v_mfma_f32_16x16x32_bf16 v[132:135], a[56:59], a[212:215], v[132:135]
s_add_u32 s86, s86, 131072
buffer_load_dwordx4 v9, s[4:7], s86 offen lds
v_mfma_f32_16x16x32_bf16 v[136:139], a[48:51], a[216:219], v[136:139]
ds_read_b64_tr_b16 a[204:205], v43 offset:40960
s_add_u32 m0, m0, 1024
v_mfma_f32_16x16x32_bf16 v[140:143], a[52:55], a[216:219], v[140:143]
ds_read_b64_tr_b16 a[206:207], v43 offset:45056
s_waitcnt lgkmcnt(8)
v_mfma_f32_16x16x32_bf16 v[144:147], a[56:59], a[216:219], v[144:147]
buffer_load_dwordx4 v10, s[4:7], s86 offen lds
v_mfma_f32_16x16x32_bf16 v[148:151], a[48:51], a[220:223], v[148:151]
ds_read_b64_tr_b16 a[208:209], v44 offset:40960
s_add_u32 m0, m0, 7168
v_mfma_f32_16x16x32_bf16 v[152:155], a[52:55], a[220:223], v[152:155]
ds_read_b64_tr_b16 a[210:211], v44 offset:45056
s_waitcnt lgkmcnt(8)
v_mfma_f32_16x16x32_bf16 v[156:159], a[56:59], a[220:223], v[156:159]
s_add_u32 s86, s86, 131072
buffer_load_dwordx4 v9, s[4:7], s86 offen lds
v_mfma_f32_16x16x32_bf16 v[64:67], a[60:63], a[192:195], v[64:67]
ds_read_b64_tr_b16 a[212:213], v45 offset:40960
s_add_u32 m0, m0, 1024
v_mfma_f32_16x16x32_bf16 v[68:71], a[64:67], a[192:195], v[68:71]
ds_read_b64_tr_b16 a[214:215], v45 offset:45056
s_waitcnt lgkmcnt(8)
v_mfma_f32_16x16x32_bf16 v[72:75], a[68:71], a[192:195], v[72:75]
v_mfma_f32_16x16x32_bf16 v[76:79], a[60:63], a[196:199], v[76:79]
ds_read_b64_tr_b16 a[216:217], v46 offset:40960
v_mfma_f32_16x16x32_bf16 v[80:83], a[64:67], a[196:199], v[80:83]
ds_read_b64_tr_b16 a[218:219], v46 offset:45056
s_waitcnt lgkmcnt(8)
v_mfma_f32_16x16x32_bf16 v[84:87], a[68:71], a[196:199], v[84:87]
buffer_load_dwordx4 v10, s[4:7], s86 offen lds
v_mfma_f32_16x16x32_bf16 v[88:91], a[60:63], a[200:203], v[88:91]
ds_read_b64_tr_b16 a[220:221], v47 offset:40960
s_add_u32 m0, m0, 7168
v_mfma_f32_16x16x32_bf16 v[92:95], a[64:67], a[200:203], v[92:95]
ds_read_b64_tr_b16 a[222:223], v47 offset:45056
s_waitcnt lgkmcnt(8)
v_mfma_f32_16x16x32_bf16 v[96:99], a[68:71], a[200:203], v[96:99]
s_add_u32 s86, s86, 131072
buffer_load_dwordx4 v9, s[4:7], s86 offen lds
v_mfma_f32_16x16x32_bf16 v[100:103], a[60:63], a[204:207], v[100:103]
ds_read_b64_tr_b16 a[192:193], v40 offset:49152
s_add_u32 m0, m0, 1024
v_mfma_f32_16x16x32_bf16 v[104:107], a[64:67], a[204:207], v[104:107]
ds_read_b64_tr_b16 a[194:195], v40 offset:53248
s_waitcnt lgkmcnt(8)
v_mfma_f32_16x16x32_bf16 v[108:111], a[68:71], a[204:207], v[108:111]
buffer_load_dwordx4 v10, s[4:7], s86 offen lds
v_mfma_f32_16x16x32_bf16 v[112:115], a[60:63], a[208:211], v[112:115]
ds_read_b64_tr_b16 a[196:197], v41 offset:49152
s_add_u32 m0, m0, 7168
v_mfma_f32_16x16x32_bf16 v[116:119], a[64:67], a[208:211], v[116:119]
ds_read_b64_tr_b16 a[198:199], v41 offset:53248
s_waitcnt lgkmcnt(8)
v_mfma_f32_16x16x32_bf16 v[120:123], a[68:71], a[208:211], v[120:123]
s_add_u32 s86, s86, 131072
v_mfma_f32_16x16x32_bf16 v[124:127], a[60:63], a[212:215], v[124:127]
ds_read_b64_tr_b16 a[200:201], v42 offset:49152
s_waitcnt vmcnt(11)
v_mfma_f32_16x16x32_bf16 v[128:131], a[64:67], a[212:215], v[128:131]
ds_read_b64_tr_b16 a[202:203], v42 offset:53248
s_waitcnt lgkmcnt(8)
v_mfma_f32_16x16x32_bf16 v[132:135], a[68:71], a[212:215], v[132:135]
buffer_load_dwordx4 v9, s[4:7], s86 offen lds
v_mfma_f32_16x16x32_bf16 v[136:139], a[60:63], a[216:219], v[136:139]
ds_read_b64_tr_b16 a[204:205], v43 offset:49152
s_add_u32 m0, m0, 1024
v_mfma_f32_16x16x32_bf16 v[140:143], a[64:67], a[216:219], v[140:143]
ds_read_b64_tr_b16 a[206:207], v43 offset:53248
s_waitcnt lgkmcnt(8)
v_mfma_f32_16x16x32_bf16 v[144:147], a[68:71], a[216:219], v[144:147]
buffer_load_dwordx4 v10, s[4:7], s86 offen lds
v_mfma_f32_16x16x32_bf16 v[148:151], a[60:63], a[220:223], v[148:151]
ds_read_b64_tr_b16 a[208:209], v44 offset:49152
s_add_u32 m0, m0, 7168
v_mfma_f32_16x16x32_bf16 v[152:155], a[64:67], a[220:223], v[152:155]
ds_read_b64_tr_b16 a[210:211], v44 offset:53248
s_waitcnt lgkmcnt(8)
v_mfma_f32_16x16x32_bf16 v[156:159], a[68:71], a[220:223], v[156:159]
s_add_u32 s86, s86, 131072
buffer_load_dwordx4 v9, s[4:7], s86 offen lds
v_mfma_f32_16x16x32_bf16 v[64:67], a[72:75], a[192:195], v[64:67]
ds_read_b64_tr_b16 a[212:213], v45 offset:49152
s_add_u32 m0, m0, 1024
v_mfma_f32_16x16x32_bf16 v[68:71], a[76:79], a[192:195], v[68:71]
ds_read_b64_tr_b16 a[214:215], v45 offset:53248
s_waitcnt lgkmcnt(8)
v_mfma_f32_16x16x32_bf16 v[72:75], a[80:83], a[192:195], v[72:75]
v_add_f32 v228, v228, v232
v_add_f32_e64 v229, v229, v233
v_mfma_f32_16x16x32_bf16 v[76:79], a[72:75], a[196:199], v[76:79]
ds_read_b64_tr_b16 a[216:217], v46 offset:49152
v_add_f32_e64 v230, v230, v234
v_mfma_f32_16x16x32_bf16 v[80:83], a[76:79], a[196:199], v[80:83]
ds_read_b64_tr_b16 a[218:219], v46 offset:53248
s_waitcnt lgkmcnt(8)
v_mfma_f32_16x16x32_bf16 v[84:87], a[80:83], a[196:199], v[84:87]
buffer_load_dwordx4 v10, s[4:7], s86 offen lds
v_mfma_f32_16x16x32_bf16 v[88:91], a[72:75], a[200:203], v[88:91]
ds_read_b64_tr_b16 a[220:221], v47 offset:49152
s_add_u32 m0, m0, 7168
v_mfma_f32_16x16x32_bf16 v[92:95], a[76:79], a[200:203], v[92:95]
ds_read_b64_tr_b16 a[222:223], v47 offset:53248
s_waitcnt lgkmcnt(8)
v_mfma_f32_16x16x32_bf16 v[96:99], a[80:83], a[200:203], v[96:99]
s_add_u32 s86, s86, 131072
buffer_load_dwordx4 v9, s[4:7], s86 offen lds
v_mfma_f32_16x16x32_bf16 v[100:103], a[72:75], a[204:207], v[100:103]
ds_read_b64_tr_b16 a[192:193], v40 offset:57344
s_add_u32 m0, m0, 1024
v_mfma_f32_16x16x32_bf16 v[104:107], a[76:79], a[204:207], v[104:107]
ds_read_b64_tr_b16 a[194:195], v40 offset:61440
s_waitcnt lgkmcnt(8)
v_mfma_f32_16x16x32_bf16 v[108:111], a[80:83], a[204:207], v[108:111]
buffer_load_dwordx4 v10, s[4:7], s86 offen lds
v_mfma_f32_16x16x32_bf16 v[112:115], a[72:75], a[208:211], v[112:115]
ds_read_b64_tr_b16 a[196:197], v41 offset:57344
s_add_u32 m0, m0, 7168
v_mfma_f32_16x16x32_bf16 v[116:119], a[76:79], a[208:211], v[116:119]
ds_read_b64_tr_b16 a[198:199], v41 offset:61440
s_waitcnt lgkmcnt(8)
v_mfma_f32_16x16x32_bf16 v[120:123], a[80:83], a[208:211], v[120:123]
s_add_u32 s86, s86, 131072
v_add_f32_e64 v231, v231, v235
v_mfma_f32_16x16x32_bf16 v[124:127], a[72:75], a[212:215], v[124:127]
ds_read_b64_tr_b16 a[200:201], v42 offset:57344
v_add_f32 v236, v236, v240
v_mfma_f32_16x16x32_bf16 v[128:131], a[76:79], a[212:215], v[128:131]
ds_read_b64_tr_b16 a[202:203], v42 offset:61440
s_waitcnt lgkmcnt(8)
v_mfma_f32_16x16x32_bf16 v[132:135], a[80:83], a[212:215], v[132:135]
buffer_load_dwordx4 v9, s[4:7], s86 offen lds
v_mfma_f32_16x16x32_bf16 v[136:139], a[72:75], a[216:219], v[136:139]
ds_read_b64_tr_b16 a[204:205], v43 offset:57344
s_add_u32 m0, m0, 1024
v_mfma_f32_16x16x32_bf16 v[140:143], a[76:79], a[216:219], v[140:143]
ds_read_b64_tr_b16 a[206:207], v43 offset:61440
s_waitcnt lgkmcnt(8)
v_mfma_f32_16x16x32_bf16 v[144:147], a[80:83], a[216:219], v[144:147]
buffer_load_dwordx4 v10, s[4:7], s86 offen lds
v_mfma_f32_16x16x32_bf16 v[148:151], a[72:75], a[220:223], v[148:151]
ds_read_b64_tr_b16 a[208:209], v44 offset:57344
s_add_u32 m0, m0, 7168
v_mfma_f32_16x16x32_bf16 v[152:155], a[76:79], a[220:223], v[152:155]
ds_read_b64_tr_b16 a[210:211], v44 offset:61440
s_waitcnt lgkmcnt(8)
v_mfma_f32_16x16x32_bf16 v[156:159], a[80:83], a[220:223], v[156:159]
s_add_u32 s86, s86, 131072
buffer_load_dwordx4 a[128:131], v14, s[4:7], s81 offen
v_mfma_f32_16x16x32_bf16 v[64:67], a[84:87], a[192:195], v[64:67]
ds_read_b64_tr_b16 a[212:213], v45 offset:57344
s_add_u32 s81, s81, 1024
v_mfma_f32_16x16x32_bf16 v[68:71], a[88:91], a[192:195], v[68:71]
ds_read_b64_tr_b16 a[214:215], v45 offset:61440
s_waitcnt lgkmcnt(8)
v_mfma_f32_16x16x32_bf16 v[72:75], a[92:95], a[192:195], v[72:75]
v_add_f32 v237, v237, v241
v_add_f32_e64 v238, v238, v242
v_mfma_f32_16x16x32_bf16 v[76:79], a[84:87], a[196:199], v[76:79]
ds_read_b64_tr_b16 a[216:217], v46 offset:57344
v_add_f32 v239, v239, v243
v_mfma_f32_16x16x32_bf16 v[80:83], a[88:91], a[196:199], v[80:83]
ds_read_b64_tr_b16 a[218:219], v46 offset:61440
s_waitcnt lgkmcnt(8)
v_mfma_f32_16x16x32_bf16 v[84:87], a[92:95], a[196:199], v[84:87]
buffer_load_dwordx4 a[132:135], v13, s[4:7], s81 offen
v_mfma_f32_16x16x32_bf16 v[88:91], a[84:87], a[200:203], v[88:91]
ds_read_b64_tr_b16 a[220:221], v47 offset:57344
v_add_f32_e64 v244, v244, v248
v_mfma_f32_16x16x32_bf16 v[92:95], a[88:91], a[200:203], v[92:95]
ds_read_b64_tr_b16 a[222:223], v47 offset:61440
s_waitcnt lgkmcnt(8)
v_mfma_f32_16x16x32_bf16 v[96:99], a[92:95], a[200:203], v[96:99]
s_waitcnt vmcnt(14)
s_barrier
v_mfma_f32_16x16x32_bf16 v[100:103], a[84:87], a[204:207], v[100:103]
v_add_u32 v40, 0x10000, v40
ds_read_b64_tr_b16 a[192:193], v40 offset:0
v_mfma_f32_16x16x32_bf16 v[104:107], a[88:91], a[204:207], v[104:107]
ds_read_b64_tr_b16 a[194:195], v40 offset:4096
s_waitcnt lgkmcnt(8)
v_mfma_f32_16x16x32_bf16 v[108:111], a[92:95], a[204:207], v[108:111]
buffer_load_dwordx4 a[136:139], v55, s[4:7], s81 offen
v_mfma_f32_16x16x32_bf16 v[112:115], a[84:87], a[208:211], v[112:115]
v_add_u32 v41, 0x10000, v41
ds_read_b64_tr_b16 a[196:197], v41 offset:0
v_mfma_f32_16x16x32_bf16 v[116:119], a[88:91], a[208:211], v[116:119]
ds_read_b64_tr_b16 a[198:199], v41 offset:4096
s_waitcnt lgkmcnt(8)
v_mfma_f32_16x16x32_bf16 v[120:123], a[92:95], a[208:211], v[120:123]
buffer_load_dwordx4 a[140:143], v14, s[4:7], s81 offen
v_mfma_f32_16x16x32_bf16 v[124:127], a[84:87], a[212:215], v[124:127]
v_add_u32 v42, 0x10000, v42
ds_read_b64_tr_b16 a[200:201], v42 offset:0
v_mfma_f32_16x16x32_bf16 v[128:131], a[88:91], a[212:215], v[128:131]
ds_read_b64_tr_b16 a[202:203], v42 offset:4096
s_waitcnt lgkmcnt(8)
v_mfma_f32_16x16x32_bf16 v[132:135], a[92:95], a[212:215], v[132:135]
s_add_u32 s81, s81, 1024
buffer_load_dwordx4 a[144:147], v13, s[4:7], s81 offen
v_mfma_f32_16x16x32_bf16 v[136:139], a[84:87], a[216:219], v[136:139]
v_add_u32 v43, 0x10000, v43
ds_read_b64_tr_b16 a[204:205], v43 offset:0
v_mfma_f32_16x16x32_bf16 v[140:143], a[88:91], a[216:219], v[140:143]
ds_read_b64_tr_b16 a[206:207], v43 offset:4096
s_waitcnt lgkmcnt(8)
v_mfma_f32_16x16x32_bf16 v[144:147], a[92:95], a[216:219], v[144:147]
buffer_load_dwordx4 a[148:151], v55, s[4:7], s81 offen
v_mfma_f32_16x16x32_bf16 v[148:151], a[84:87], a[220:223], v[148:151]
v_add_u32 v44, 0x10000, v44
ds_read_b64_tr_b16 a[208:209], v44 offset:0
v_mfma_f32_16x16x32_bf16 v[152:155], a[88:91], a[220:223], v[152:155]
ds_read_b64_tr_b16 a[210:211], v44 offset:4096
s_waitcnt lgkmcnt(8)
v_mfma_f32_16x16x32_bf16 v[156:159], a[92:95], a[220:223], v[156:159]
buffer_load_dwordx4 a[152:155], v14, s[4:7], s81 offen
v_mfma_f32_16x16x32_bf16 v[64:67], a[96:99], a[192:195], v[64:67]
v_add_u32 v45, 0x10000, v45
ds_read_b64_tr_b16 a[212:213], v45 offset:0
v_mfma_f32_16x16x32_bf16 v[68:71], a[100:103], a[192:195], v[68:71]
ds_read_b64_tr_b16 a[214:215], v45 offset:4096
s_waitcnt lgkmcnt(8)
v_mfma_f32_16x16x32_bf16 v[72:75], a[104:107], a[192:195], v[72:75]
s_add_u32 s81, s81, 1024
v_add_f32 v245, v245, v249
v_mfma_f32_16x16x32_bf16 v[76:79], a[96:99], a[196:199], v[76:79]
v_add_u32 v46, 0x10000, v46
ds_read_b64_tr_b16 a[216:217], v46 offset:0
v_mfma_f32_16x16x32_bf16 v[80:83], a[100:103], a[196:199], v[80:83]
ds_read_b64_tr_b16 a[218:219], v46 offset:4096
s_waitcnt lgkmcnt(8)
v_mfma_f32_16x16x32_bf16 v[84:87], a[104:107], a[196:199], v[84:87]
buffer_load_dwordx4 a[156:159], v13, s[4:7], s81 offen
v_mfma_f32_16x16x32_bf16 v[88:91], a[96:99], a[200:203], v[88:91]
v_add_u32 v47, 0x10000, v47
ds_read_b64_tr_b16 a[220:221], v47 offset:0
v_mfma_f32_16x16x32_bf16 v[92:95], a[100:103], a[200:203], v[92:95]
ds_read_b64_tr_b16 a[222:223], v47 offset:4096
s_waitcnt lgkmcnt(8)
v_mfma_f32_16x16x32_bf16 v[96:99], a[104:107], a[200:203], v[96:99]
buffer_load_dwordx4 a[160:163], v55, s[4:7], s81 offen
v_mfma_f32_16x16x32_bf16 v[100:103], a[96:99], a[204:207], v[100:103]
ds_read_b64_tr_b16 a[192:193], v40 offset:8192
v_add_f32 v246, v246, v250
v_mfma_f32_16x16x32_bf16 v[104:107], a[100:103], a[204:207], v[104:107]
ds_read_b64_tr_b16 a[194:195], v40 offset:12288
s_waitcnt lgkmcnt(8)
v_mfma_f32_16x16x32_bf16 v[108:111], a[104:107], a[204:207], v[108:111]
buffer_load_dwordx4 a[164:167], v14, s[4:7], s81 offen
v_mfma_f32_16x16x32_bf16 v[112:115], a[96:99], a[208:211], v[112:115]
ds_read_b64_tr_b16 a[196:197], v41 offset:8192
s_add_u32 s81, s81, 1024
v_mfma_f32_16x16x32_bf16 v[116:119], a[100:103], a[208:211], v[116:119]
ds_read_b64_tr_b16 a[198:199], v41 offset:12288
s_waitcnt lgkmcnt(8)
v_mfma_f32_16x16x32_bf16 v[120:123], a[104:107], a[208:211], v[120:123]
v_add_f32 v247, v247, v251
v_add_f32 v224, v224, v252
v_mfma_f32_16x16x32_bf16 v[124:127], a[96:99], a[212:215], v[124:127]
ds_read_b64_tr_b16 a[200:201], v42 offset:8192
v_permlane32_swap_b32 v228, v230
v_mfma_f32_16x16x32_bf16 v[128:131], a[100:103], a[212:215], v[128:131]
ds_read_b64_tr_b16 a[202:203], v42 offset:12288
s_waitcnt lgkmcnt(8)
v_mfma_f32_16x16x32_bf16 v[132:135], a[104:107], a[212:215], v[132:135]
buffer_load_dwordx4 a[168:171], v13, s[4:7], s81 offen
v_mfma_f32_16x16x32_bf16 v[136:139], a[96:99], a[216:219], v[136:139]
ds_read_b64_tr_b16 a[204:205], v43 offset:8192
v_permlane32_swap_b32 v229, v231
v_mfma_f32_16x16x32_bf16 v[140:143], a[100:103], a[216:219], v[140:143]
ds_read_b64_tr_b16 a[206:207], v43 offset:12288
s_waitcnt lgkmcnt(8)
v_mfma_f32_16x16x32_bf16 v[144:147], a[104:107], a[216:219], v[144:147]
s_waitcnt vmcnt(11)
s_barrier
v_mfma_f32_16x16x32_bf16 v[148:151], a[96:99], a[220:223], v[148:151]
ds_read_b64_tr_b16 a[208:209], v40 offset:16384
v_permlane32_swap_b32_e64 v236, v238
v_mfma_f32_16x16x32_bf16 v[152:155], a[100:103], a[220:223], v[152:155]
ds_read_b64_tr_b16 a[210:211], v40 offset:20480
s_waitcnt lgkmcnt(8)
v_mfma_f32_16x16x32_bf16 v[156:159], a[104:107], a[220:223], v[156:159]
buffer_load_dwordx4 a[172:175], v55, s[4:7], s81 offen
v_mfma_f32_16x16x32_bf16 v[64:67], a[108:111], a[192:195], v[64:67]
ds_read_b64_tr_b16 a[212:213], v41 offset:16384
v_permlane32_swap_b32 v237, v239
v_mfma_f32_16x16x32_bf16 v[68:71], a[112:115], a[192:195], v[68:71]
ds_read_b64_tr_b16 a[214:215], v41 offset:20480
s_waitcnt lgkmcnt(8)
v_mfma_f32_16x16x32_bf16 v[72:75], a[116:119], a[192:195], v[72:75]
buffer_load_dwordx4 a[176:179], v14, s[4:7], s81 offen
v_mfma_f32_16x16x32_bf16 v[76:79], a[108:111], a[196:199], v[76:79]
ds_read_b64_tr_b16 a[216:217], v42 offset:16384
s_add_u32 s81, s81, 1024
v_mfma_f32_16x16x32_bf16 v[80:83], a[112:115], a[196:199], v[80:83]
ds_read_b64_tr_b16 a[218:219], v42 offset:20480
s_waitcnt lgkmcnt(8)
v_mfma_f32_16x16x32_bf16 v[84:87], a[116:119], a[196:199], v[84:87]
buffer_load_dwordx4 a[180:183], v13, s[4:7], s81 offen
v_mfma_f32_16x16x32_bf16 v[88:91], a[108:111], a[200:203], v[88:91]
ds_read_b64_tr_b16 a[220:221], v43 offset:16384
v_permlane32_swap_b32_e64 v244, v246
v_mfma_f32_16x16x32_bf16 v[92:95], a[112:115], a[200:203], v[92:95]
ds_read_b64_tr_b16 a[222:223], v43 offset:20480
s_waitcnt lgkmcnt(8)
v_mfma_f32_16x16x32_bf16 v[96:99], a[116:119], a[200:203], v[96:99]
buffer_load_dwordx4 a[184:187], v55, s[4:7], s81 offen
v_mfma_f32_16x16x32_bf16 v[100:103], a[108:111], a[204:207], v[100:103]
ds_read_b64_tr_b16 a[192:193], v40 offset:24576
v_permlane32_swap_b32_e64 v245, v247
v_mfma_f32_16x16x32_bf16 v[104:107], a[112:115], a[204:207], v[104:107]
ds_read_b64_tr_b16 a[194:195], v40 offset:28672
s_waitcnt lgkmcnt(8)
v_mfma_f32_16x16x32_bf16 v[108:111], a[116:119], a[204:207], v[108:111]
s_waitcnt vmcnt(14)
buffer_load_dwordx4 a[188:191], v14, s[4:7], s81 offen
v_mfma_f32_16x16x32_bf16 v[64:67], a[120:123], a[208:211], v[64:67]
ds_read_b64_tr_b16 a[196:197], v41 offset:24576
s_add_u32 s81, s81, 1024
v_mfma_f32_16x16x32_bf16 v[68:71], a[124:127], a[208:211], v[68:71]
ds_read_b64_tr_b16 a[198:199], v41 offset:28672
s_waitcnt lgkmcnt(8)
v_mfma_f32_16x16x32_bf16 v[72:75], a[128:131], a[208:211], v[72:75]
v_add_f32 v228, v228, v230
v_add_f32_e64 v229, v229, v231
v_mfma_f32_16x16x32_bf16 v[76:79], a[120:123], a[212:215], v[76:79]
ds_read_b64_tr_b16 a[200:201], v42 offset:24576
v_add_f32_e64 v236, v236, v238
v_mfma_f32_16x16x32_bf16 v[80:83], a[124:127], a[212:215], v[80:83]
ds_read_b64_tr_b16 a[202:203], v42 offset:28672
s_waitcnt lgkmcnt(8)
v_mfma_f32_16x16x32_bf16 v[84:87], a[128:131], a[212:215], v[84:87]
buffer_load_dwordx4 a[224:227], v2, s[4:7], s85 offen offset:0
v_mfma_f32_16x16x32_bf16 v[88:91], a[120:123], a[216:219], v[88:91]
ds_read_b64_tr_b16 a[204:205], v43 offset:24576
v_add_f32_e64 v237, v237, v239
v_mfma_f32_16x16x32_bf16 v[92:95], a[124:127], a[216:219], v[92:95]
ds_read_b64_tr_b16 a[206:207], v43 offset:28672
s_waitcnt lgkmcnt(8)
v_mfma_f32_16x16x32_bf16 v[96:99], a[128:131], a[216:219], v[96:99]
buffer_load_dwordx4 a[228:231], v2, s[4:7], s85 offen offset:1024
v_mfma_f32_16x16x32_bf16 v[100:103], a[120:123], a[220:223], v[100:103]
ds_read_b64_tr_b16 a[208:209], v40 offset:32768
v_add_f32_e64 v244, v244, v246
v_mfma_f32_16x16x32_bf16 v[104:107], a[124:127], a[220:223], v[104:107]
ds_read_b64_tr_b16 a[210:211], v40 offset:36864
s_waitcnt lgkmcnt(8)
v_mfma_f32_16x16x32_bf16 v[108:111], a[128:131], a[220:223], v[108:111]
s_waitcnt vmcnt(14)
buffer_load_dwordx4 a[232:235], v2, s[4:7], s85 offen offset:2048
v_mfma_f32_16x16x32_bf16 v[64:67], a[132:135], a[192:195], v[64:67]
ds_read_b64_tr_b16 a[212:213], v41 offset:32768
v_add_f32 v245, v245, v247
v_mfma_f32_16x16x32_bf16 v[68:71], a[136:139], a[192:195], v[68:71]
ds_read_b64_tr_b16 a[214:215], v41 offset:36864
s_waitcnt lgkmcnt(8)
v_mfma_f32_16x16x32_bf16 v[72:75], a[140:143], a[192:195], v[72:75]
v_add_f32_dpp v224, v224, v224 row_ror:8 row_mask:0xf bank_mask:0xf
v_permlane16_swap_b32_e64 v228, v229
v_mfma_f32_16x16x32_bf16 v[76:79], a[132:135], a[196:199], v[76:79]
ds_read_b64_tr_b16 a[216:217], v42 offset:32768
v_permlane16_swap_b32 v236, v237
v_mfma_f32_16x16x32_bf16 v[80:83], a[136:139], a[196:199], v[80:83]
ds_read_b64_tr_b16 a[218:219], v42 offset:36864
s_waitcnt lgkmcnt(8)
v_mfma_f32_16x16x32_bf16 v[84:87], a[140:143], a[196:199], v[84:87]
buffer_load_dwordx4 a[236:239], v2, s[4:7], s85 offen offset:3072
v_mfma_f32_16x16x32_bf16 v[88:91], a[132:135], a[200:203], v[88:91]
ds_read_b64_tr_b16 a[220:221], v43 offset:32768
s_add_u32 s85, s85, 4096
v_mfma_f32_16x16x32_bf16 v[92:95], a[136:139], a[200:203], v[92:95]
ds_read_b64_tr_b16 a[222:223], v43 offset:36864
s_waitcnt lgkmcnt(8)
v_mfma_f32_16x16x32_bf16 v[96:99], a[140:143], a[200:203], v[96:99]
buffer_load_dwordx4 a[240:243], v2, s[4:7], s85 offen offset:0
v_mfma_f32_16x16x32_bf16 v[100:103], a[132:135], a[204:207], v[100:103]
ds_read_b64_tr_b16 a[192:193], v40 offset:40960
v_permlane16_swap_b32 v244, v245
v_mfma_f32_16x16x32_bf16 v[104:107], a[136:139], a[204:207], v[104:107]
ds_read_b64_tr_b16 a[194:195], v40 offset:45056
s_waitcnt lgkmcnt(8)
v_mfma_f32_16x16x32_bf16 v[108:111], a[140:143], a[204:207], v[108:111]
s_waitcnt vmcnt(14)
buffer_load_dwordx4 a[244:247], v2, s[4:7], s85 offen offset:1024
v_mfma_f32_16x16x32_bf16 v[64:67], a[144:147], a[208:211], v[64:67]
ds_read_b64_tr_b16 a[196:197], v41 offset:40960
v_add_f32_e64 v228, v228, v229
v_mfma_f32_16x16x32_bf16 v[68:71], a[148:151], a[208:211], v[68:71]
ds_read_b64_tr_b16 a[198:199], v41 offset:45056
s_waitcnt lgkmcnt(8)
v_mfma_f32_16x16x32_bf16 v[72:75], a[152:155], a[208:211], v[72:75]
v_add_f32 v236, v236, v237
v_add_f32_e64 v244, v244, v245
v_mfma_f32_16x16x32_bf16 v[76:79], a[144:147], a[212:215], v[76:79]
ds_read_b64_tr_b16 a[200:201], v42 offset:40960
v_cvt_pk_bf16_f32 v11, v224, v224
v_mfma_f32_16x16x32_bf16 v[80:83], a[148:151], a[212:215], v[80:83]
ds_read_b64_tr_b16 a[202:203], v42 offset:45056
s_waitcnt lgkmcnt(8)
v_mfma_f32_16x16x32_bf16 v[84:87], a[152:155], a[212:215], v[84:87]
buffer_load_dwordx4 a[248:251], v2, s[4:7], s85 offen offset:2048
v_mfma_f32_16x16x32_bf16 v[88:91], a[144:147], a[216:219], v[88:91]
ds_read_b64_tr_b16 a[204:205], v43 offset:40960
v_add_f32_dpp v228, v228, v228 row_ror:8 row_mask:0xf bank_mask:0xf
v_mfma_f32_16x16x32_bf16 v[92:95], a[148:151], a[216:219], v[92:95]
ds_read_b64_tr_b16 a[206:207], v43 offset:45056
s_waitcnt lgkmcnt(8)
v_mfma_f32_16x16x32_bf16 v[96:99], a[152:155], a[216:219], v[96:99]
buffer_load_dwordx4 a[252:255], v2, s[4:7], s85 offen offset:3072
v_mfma_f32_16x16x32_bf16 v[100:103], a[144:147], a[220:223], v[100:103]
ds_read_b64_tr_b16 a[208:209], v40 offset:49152
s_add_u32 s85, s85, 4096
v_mfma_f32_16x16x32_bf16 v[104:107], a[148:151], a[220:223], v[104:107]
ds_read_b64_tr_b16 a[210:211], v40 offset:53248
s_waitcnt lgkmcnt(8)
v_mfma_f32_16x16x32_bf16 v[108:111], a[152:155], a[220:223], v[108:111]
s_waitcnt vmcnt(14)
buffer_load_dwordx4 v[160:163], v2, s[4:7], s85 offen offset:0
v_mfma_f32_16x16x32_bf16 v[64:67], a[156:159], a[192:195], v[64:67]
ds_read_b64_tr_b16 a[212:213], v41 offset:49152
v_add_f32_dpp v236, v236, v236 row_ror:8 row_mask:0xf bank_mask:0xf
v_mfma_f32_16x16x32_bf16 v[68:71], a[160:163], a[192:195], v[68:71]
ds_read_b64_tr_b16 a[214:215], v41 offset:53248
s_waitcnt lgkmcnt(8)
v_mfma_f32_16x16x32_bf16 v[72:75], a[164:167], a[192:195], v[72:75]
v_add_f32_dpp v244, v244, v244 row_ror:8 row_mask:0xf bank_mask:0xf
v_mul_f32 v228, v228, v63
v_mfma_f32_16x16x32_bf16 v[76:79], a[156:159], a[196:199], v[76:79]
ds_read_b64_tr_b16 a[216:217], v42 offset:49152
v_mul_f32_e64 v236, v236, v63
v_mfma_f32_16x16x32_bf16 v[80:83], a[160:163], a[196:199], v[80:83]
ds_read_b64_tr_b16 a[218:219], v42 offset:53248
s_waitcnt lgkmcnt(8)
v_mfma_f32_16x16x32_bf16 v[84:87], a[164:167], a[196:199], v[84:87]
buffer_load_dwordx4 v[164:167], v2, s[4:7], s85 offen offset:1024
v_mfma_f32_16x16x32_bf16 v[88:91], a[156:159], a[200:203], v[88:91]
ds_read_b64_tr_b16 a[220:221], v43 offset:49152
v_mul_f32_e64 v244, v244, v63
v_mfma_f32_16x16x32_bf16 v[92:95], a[160:163], a[200:203], v[92:95]
ds_read_b64_tr_b16 a[222:223], v43 offset:53248
s_waitcnt lgkmcnt(8)
v_mfma_f32_16x16x32_bf16 v[96:99], a[164:167], a[200:203], v[96:99]
buffer_load_dwordx4 v[168:171], v2, s[4:7], s85 offen offset:2048
v_mfma_f32_16x16x32_bf16 v[100:103], a[156:159], a[204:207], v[100:103]
ds_read_b64_tr_b16 a[192:193], v40 offset:57344
ds_write_b32 v56, v228 offset:0
v_mfma_f32_16x16x32_bf16 v[104:107], a[160:163], a[204:207], v[104:107]
ds_read_b64_tr_b16 a[194:195], v40 offset:61440
s_waitcnt lgkmcnt(9)
v_mfma_f32_16x16x32_bf16 v[108:111], a[164:167], a[204:207], v[108:111]
s_waitcnt vmcnt(14)
buffer_load_dwordx4 v[172:175], v2, s[4:7], s85 offen offset:3072
v_mfma_f32_16x16x32_bf16 v[64:67], a[168:171], a[208:211], v[64:67]
ds_read_b64_tr_b16 a[196:197], v41 offset:57344
s_add_u32 s85, s85, 4096
v_mfma_f32_16x16x32_bf16 v[68:71], a[172:175], a[208:211], v[68:71]
ds_read_b64_tr_b16 a[198:199], v41 offset:61440
s_waitcnt lgkmcnt(9)
v_mfma_f32_16x16x32_bf16 v[72:75], a[176:179], a[208:211], v[72:75]
ds_write_b32 v56, v236 offset:128
ds_write_b32 v56, v244 offset:256
v_mfma_f32_16x16x32_bf16 v[76:79], a[168:171], a[212:215], v[76:79]
ds_read_b64_tr_b16 a[200:201], v42 offset:57344
ds_read_b128 v[16:19], v12 offset:0
v_mfma_f32_16x16x32_bf16 v[80:83], a[172:175], a[212:215], v[80:83]
ds_read_b64_tr_b16 a[202:203], v42 offset:61440
L_pad_b_2:
s_cbranch_execz L_pad_b_3
s_waitcnt lgkmcnt(12)
v_mfma_f32_16x16x32_bf16 v[84:87], a[176:179], a[212:215], v[84:87]
buffer_load_dwordx4 v[176:179], v2, s[4:7], s85 offen offset:0
v_mfma_f32_16x16x32_bf16 v[88:91], a[168:171], a[216:219], v[88:91]
ds_read_b64_tr_b16 a[204:205], v43 offset:57344
ds_read_b128 v[28:31], v12 offset:64
v_mfma_f32_16x16x32_bf16 v[92:95], a[172:175], a[216:219], v[92:95]
ds_read_b64_tr_b16 a[206:207], v43 offset:61440
s_waitcnt lgkmcnt(13)
v_mfma_f32_16x16x32_bf16 v[96:99], a[176:179], a[216:219], v[96:99]
buffer_load_dwordx4 v[180:183], v2, s[4:7], s85 offen offset:1024
v_mfma_f32_16x16x32_bf16 v[100:103], a[168:171], a[220:223], v[100:103]
ds_read_b64_tr_b16 a[208:209], v44 offset:8192
ds_read_b128 v[20:23], v12 offset:128
v_mfma_f32_16x16x32_bf16 v[104:107], a[172:175], a[220:223], v[104:107]
ds_read_b64_tr_b16 a[210:211], v44 offset:12288
s_waitcnt lgkmcnt(13)
v_mfma_f32_16x16x32_bf16 v[108:111], a[176:179], a[220:223], v[108:111]
s_waitcnt vmcnt(14)
buffer_load_dwordx4 v[184:187], v2, s[4:7], s85 offen offset:2048
v_mfma_f32_16x16x32_bf16 v[64:67], a[180:183], a[192:195], v[64:67]
ds_read_b64_tr_b16 a[212:213], v45 offset:8192
ds_read_b128 v[32:35], v12 offset:192
v_mfma_f32_16x16x32_bf16 v[68:71], a[184:187], a[192:195], v[68:71]
ds_read_b64_tr_b16 a[214:215], v45 offset:12288
s_waitcnt lgkmcnt(14)
v_mfma_f32_16x16x32_bf16 v[72:75], a[188:191], a[192:195], v[72:75]
ds_read_b128 v[24:27], v12 offset:256
ds_read_b128 v[36:39], v12 offset:320
v_mfma_f32_16x16x32_bf16 v[76:79], a[180:183], a[196:199], v[76:79]
ds_read_b64_tr_b16 a[216:217], v46 offset:8192
ds_read_b64_tr_b16 v[48:49], v59 offset:0
v_mfma_f32_16x16x32_bf16 v[80:83], a[184:187], a[196:199], v[80:83]
ds_read_b64_tr_b16 a[218:219], v46 offset:12288
s_waitcnt lgkmcnt(14)
v_mfma_f32_16x16x32_bf16 v[84:87], a[188:191], a[196:199], v[84:87]
buffer_load_dwordx4 v[188:191], v2, s[4:7], s85 offen offset:3072
v_mfma_f32_16x16x32_bf16 v[88:91], a[180:183], a[200:203], v[88:91]
ds_read_b64_tr_b16 a[220:221], v47 offset:8192
s_add_u32 s85, s85, 4096
v_mfma_f32_16x16x32_bf16 v[92:95], a[184:187], a[200:203], v[92:95]
ds_read_b64_tr_b16 a[222:223], v47 offset:12288
s_waitcnt lgkmcnt(13)
v_mfma_f32_16x16x32_bf16 v[96:99], a[188:191], a[200:203], v[96:99]
buffer_load_dwordx4 v[192:195], v2, s[4:7], s85 offen offset:0
v_mfma_f32_16x16x32_bf16 v[100:103], a[180:183], a[204:207], v[100:103]
ds_read_b64_tr_b16 a[192:193], v44 offset:16384
ds_read_b64_tr_b16 v[50:51], v60 offset:1024
v_mfma_f32_16x16x32_bf16 v[104:107], a[184:187], a[204:207], v[104:107]
ds_read_b64_tr_b16 a[194:195], v44 offset:20480
s_waitcnt lgkmcnt(13)
v_mfma_f32_16x16x32_bf16 v[108:111], a[188:191], a[204:207], v[108:111]
buffer_load_dwordx4 v[196:199], v2, s[4:7], s85 offen offset:1024
v_mfma_f32_16x16x32_bf16 v[112:115], a[108:111], a[208:211], v[112:115]
ds_read_b64_tr_b16 a[196:197], v45 offset:16384
ds_read_b64_tr_b16 v[52:53], v60 offset:0
v_mfma_f32_16x16x32_bf16 v[116:119], a[112:115], a[208:211], v[116:119]
ds_read_b64_tr_b16 a[198:199], v45 offset:20480
s_nop 0
s_waitcnt lgkmcnt(13)
v_mfma_f32_16x16x32_bf16 v[120:123], a[116:119], a[208:211], v[120:123]
ds_read_b64_tr_b16 v[54:55], v59 offset:1024
v_mfma_f32_16x16x32_bf16 v[124:127], a[108:111], a[212:215], v[124:127]
ds_read_b64_tr_b16 a[200:201], v46 offset:16384
v_mfma_f32_16x16x32_bf16 v[128:131], a[112:115], a[212:215], v[128:131]
ds_read_b64_tr_b16 a[202:203], v46 offset:20480
s_waitcnt lgkmcnt(11)
v_mfma_f32_16x16x32_bf16 v[132:135], a[116:119], a[212:215], v[132:135]
buffer_load_dwordx4 v[200:203], v2, s[4:7], s85 offen offset:2048
v_mfma_f32_16x16x32_bf16 v[136:139], a[108:111], a[216:219], v[136:139]
ds_read_b64_tr_b16 a[204:205], v47 offset:16384
v_mfma_f32_16x16x32_bf16 v[140:143], a[112:115], a[216:219], v[140:143]
ds_read_b64_tr_b16 a[206:207], v47 offset:20480
s_waitcnt lgkmcnt(11)
v_mfma_f32_16x16x32_bf16 v[144:147], a[116:119], a[216:219], v[144:147]
buffer_load_dwordx4 v[204:207], v2, s[4:7], s85 offen offset:3072
v_mfma_f32_16x16x32_bf16 v[148:151], a[108:111], a[220:223], v[148:151]
ds_read_b64_tr_b16 a[208:209], v44 offset:24576
s_add_u32 s85, s85, 4096
v_mfma_f32_16x16x32_bf16 v[152:155], a[112:115], a[220:223], v[152:155]
ds_read_b64_tr_b16 a[210:211], v44 offset:28672
s_waitcnt lgkmcnt(10)
v_mfma_f32_16x16x32_bf16 v[156:159], a[116:119], a[220:223], v[156:159]
buffer_load_dwordx4 v[208:211], v2, s[4:7], s85 offen offset:0
v_mfma_f32_16x16x32_bf16 v[112:115], a[120:123], a[192:195], v[112:115]
ds_read_b64_tr_b16 a[212:213], v45 offset:24576
v_mfma_f32_16x16x32_bf16 v[116:119], a[124:127], a[192:195], v[116:119]
ds_read_b64_tr_b16 a[214:215], v45 offset:28672
s_waitcnt lgkmcnt(9)
v_mfma_f32_16x16x32_bf16 v[120:123], a[128:131], a[192:195], v[120:123]
v_mfma_f32_16x16x32_bf16 v[124:127], a[120:123], a[196:199], v[124:127]
ds_read_b64_tr_b16 a[216:217], v46 offset:24576
v_mfma_f32_16x16x32_bf16 v[128:131], a[124:127], a[196:199], v[128:131]
ds_read_b64_tr_b16 a[218:219], v46 offset:28672
s_waitcnt lgkmcnt(8)
v_mfma_f32_16x16x32_bf16 v[132:135], a[128:131], a[196:199], v[132:135]
buffer_load_dwordx4 v[212:215], v2, s[4:7], s85 offen offset:1024
v_mfma_f32_16x16x32_bf16 v[136:139], a[120:123], a[200:203], v[136:139]
ds_read_b64_tr_b16 a[220:221], v47 offset:24576
v_mfma_f32_16x16x32_bf16 v[140:143], a[124:127], a[200:203], v[140:143]
ds_read_b64_tr_b16 a[222:223], v47 offset:28672
s_waitcnt lgkmcnt(8)
v_mfma_f32_16x16x32_bf16 v[144:147], a[128:131], a[200:203], v[144:147]
buffer_load_dwordx4 v[216:219], v2, s[4:7], s85 offen offset:2048
v_mfma_f32_16x16x32_bf16 v[148:151], a[120:123], a[204:207], v[148:151]
ds_read_b64_tr_b16 a[192:193], v44 offset:32768
v_mfma_f32_16x16x32_bf16 v[152:155], a[124:127], a[204:207], v[152:155]
ds_read_b64_tr_b16 a[194:195], v44 offset:36864
s_waitcnt lgkmcnt(8)
v_mfma_f32_16x16x32_bf16 v[156:159], a[128:131], a[204:207], v[156:159]
buffer_load_dwordx4 v[220:223], v2, s[4:7], s85 offen offset:3072
s_add_u32 s85, s85, 4096
s_barrier
ds_read_b128 v[224:227], v7 offset:0
ds_read_b128 v[228:231], v7 offset:256
ds_read_b128 v[232:235], v7 offset:512
ds_read_b128 v[236:239], v7 offset:768
v_mov_b32 v13, 1073741824
v_cmp_eq_u32 vcc, 0, v1
v_subrev_u32 v14, 192, v0
v_lshlrev_b32_e64 v10, 7, v1
v_cndmask_b32 v9, v13, 0, vcc
v_cmp_gt_u32_e64 vcc, 4, v14
v_mov_b32_e64 v12, 1
v_and_b32 v11, 0xffff0000, v11
v_cndmask_b32 v10, v13, v10, vcc
v_cndmask_b32 v14, 0, 16, vcc
s_waitcnt lgkmcnt(3)
v_pk_fma_f32 v[56:57], v[226:227], v[16:17], v[28:29] op_sel:[0,0,0] op_sel_hi:[0,1,1] neg_lo:[1,0,0] neg_hi:[1,0,0]
v_pk_fma_f32 v[58:59], v[226:227], v[18:19], v[30:31] op_sel:[0,0,0] op_sel_hi:[0,1,1] neg_lo:[1,0,0] neg_hi:[1,0,0]
v_pk_fma_f32 v[56:57], v[224:225], v[64:65], v[56:57] op_sel:[0,0,0] op_sel_hi:[0,1,1]
v_exp_f32 v56, v56
v_exp_f32 v57, v57
v_pk_fma_f32 v[58:59], v[224:225], v[66:67], v[58:59] op_sel:[1,0,0] op_sel_hi:[1,1,1]
v_pk_add_f32 v[56:57], v[56:57], 1.0 op_sel_hi:[1,0]
v_rcp_f32 v56, v56
v_rcp_f32_e64 v57, v57
s_waitcnt lgkmcnt(2)
v_pk_fma_f32 v[60:61], v[230:231], v[16:17], v[28:29] op_sel:[0,0,0] op_sel_hi:[0,1,1] neg_lo:[1,0,0] neg_hi:[1,0,0]
v_pk_mul_f32 v[56:57], v[56:57], v[58:59]
v_cvt_pk_bf16_f32 v64, v56, v57
v_pk_fma_f32 v[62:63], v[230:231], v[18:19], v[30:31] op_sel:[0,0,0] op_sel_hi:[0,1,1] neg_lo:[1,0,0] neg_hi:[1,0,0]
v_pk_fma_f32 v[60:61], v[228:229], v[76:77], v[60:61] op_sel:[0,0,0] op_sel_hi:[0,1,1]
v_exp_f32 v60, v60
v_exp_f32 v61, v61
v_pk_fma_f32 v[62:63], v[228:229], v[78:79], v[62:63] op_sel:[1,0,0] op_sel_hi:[1,1,1]
v_pk_add_f32 v[60:61], v[60:61], 1.0 op_sel_hi:[1,0]
v_rcp_f32 v60, v60
v_rcp_f32_e64 v61, v61
s_waitcnt lgkmcnt(1)
v_pk_fma_f32 v[56:57], v[234:235], v[16:17], v[28:29] op_sel:[0,0,0] op_sel_hi:[0,1,1] neg_lo:[1,0,0] neg_hi:[1,0,0]
v_pk_mul_f32 v[60:61], v[60:61], v[62:63]
v_cvt_pk_bf16_f32 v65, v60, v61
v_pk_fma_f32 v[58:59], v[234:235], v[18:19], v[30:31] op_sel:[0,0,0] op_sel_hi:[0,1,1] neg_lo:[1,0,0] neg_hi:[1,0,0]
v_pk_fma_f32 v[56:57], v[232:233], v[88:89], v[56:57] op_sel:[0,0,0] op_sel_hi:[0,1,1]
v_exp_f32 v56, v56
v_exp_f32 v57, v57
v_pk_fma_f32 v[58:59], v[232:233], v[90:91], v[58:59] op_sel:[1,0,0] op_sel_hi:[1,1,1]
v_pk_add_f32 v[56:57], v[56:57], 1.0 op_sel_hi:[1,0]
v_rcp_f32 v56, v56
v_rcp_f32_e64 v57, v57
s_waitcnt lgkmcnt(0)
v_pk_fma_f32 v[60:61], v[238:239], v[16:17], v[28:29] op_sel:[0,0,0] op_sel_hi:[0,1,1] neg_lo:[1,0,0] neg_hi:[1,0,0]
v_pk_mul_f32 v[56:57], v[56:57], v[58:59]
v_cvt_pk_bf16_f32 v66, v56, v57
v_pk_fma_f32 v[62:63], v[238:239], v[18:19], v[30:31] op_sel:[0,0,0] op_sel_hi:[0,1,1] neg_lo:[1,0,0] neg_hi:[1,0,0]
v_pk_fma_f32 v[60:61], v[236:237], v[100:101], v[60:61] op_sel:[0,0,0] op_sel_hi:[0,1,1]
v_exp_f32 v60, v60
v_exp_f32 v61, v61
v_pk_fma_f32 v[62:63], v[236:237], v[102:103], v[62:63] op_sel:[1,0,0] op_sel_hi:[1,1,1]
v_pk_add_f32 v[60:61], v[60:61], 1.0 op_sel_hi:[1,0]
v_rcp_f32 v60, v60
v_rcp_f32 v61, v61
v_pk_fma_f32 v[56:57], v[226:227], v[20:21], v[32:33] op_sel:[0,0,0] op_sel_hi:[0,1,1] neg_lo:[1,0,0] neg_hi:[1,0,0]
v_pk_mul_f32 v[60:61], v[60:61], v[62:63]
v_permlane32_swap_b32_e64 v64, v66
v_cvt_pk_bf16_f32 v67, v60, v61
v_pk_fma_f32 v[58:59], v[226:227], v[22:23], v[34:35] op_sel:[0,0,0] op_sel_hi:[0,1,1] neg_lo:[1,0,0] neg_hi:[1,0,0]
v_pk_fma_f32 v[56:57], v[224:225], v[68:69], v[56:57] op_sel:[0,0,0] op_sel_hi:[0,1,1]
v_permlane32_swap_b32 v65, v67
v_exp_f32 v56, v56
v_exp_f32 v57, v57
v_permlane16_swap_b32 v64, v65
v_permlane16_swap_b32_e64 v66, v67
buffer_store_dwordx4 v[64:67], v8, s[4:7], s53 offen sc1
v_pk_fma_f32 v[58:59], v[224:225], v[70:71], v[58:59] op_sel:[1,0,0] op_sel_hi:[1,1,1]
v_pk_add_f32 v[56:57], v[56:57], 1.0 op_sel_hi:[1,0]
v_rcp_f32 v56, v56
v_rcp_f32 v57, v57
v_pk_fma_f32 v[60:61], v[230:231], v[20:21], v[32:33] op_sel:[0,0,0] op_sel_hi:[0,1,1] neg_lo:[1,0,0] neg_hi:[1,0,0]
v_pk_mul_f32 v[56:57], v[56:57], v[58:59]
v_cvt_pk_bf16_f32 v68, v56, v57
v_pk_fma_f32 v[62:63], v[230:231], v[22:23], v[34:35] op_sel:[0,0,0] op_sel_hi:[0,1,1] neg_lo:[1,0,0] neg_hi:[1,0,0]
v_pk_fma_f32 v[60:61], v[228:229], v[80:81], v[60:61] op_sel:[0,0,0] op_sel_hi:[0,1,1]
v_exp_f32 v60, v60
v_exp_f32 v61, v61
v_pk_fma_f32 v[62:63], v[228:229], v[82:83], v[62:63] op_sel:[1,0,0] op_sel_hi:[1,1,1]
v_pk_add_f32 v[60:61], v[60:61], 1.0 op_sel_hi:[1,0]
v_rcp_f32 v60, v60
v_rcp_f32 v61, v61
v_pk_fma_f32 v[56:57], v[234:235], v[20:21], v[32:33] op_sel:[0,0,0] op_sel_hi:[0,1,1] neg_lo:[1,0,0] neg_hi:[1,0,0]
v_pk_mul_f32 v[60:61], v[60:61], v[62:63]
v_cvt_pk_bf16_f32 v69, v60, v61
v_pk_fma_f32 v[58:59], v[234:235], v[22:23], v[34:35] op_sel:[0,0,0] op_sel_hi:[0,1,1] neg_lo:[1,0,0] neg_hi:[1,0,0]
v_pk_fma_f32 v[56:57], v[232:233], v[92:93], v[56:57] op_sel:[0,0,0] op_sel_hi:[0,1,1]
v_exp_f32 v56, v56
v_exp_f32 v57, v57
v_pk_fma_f32 v[58:59], v[232:233], v[94:95], v[58:59] op_sel:[1,0,0] op_sel_hi:[1,1,1]
v_pk_add_f32 v[56:57], v[56:57], 1.0 op_sel_hi:[1,0]
v_rcp_f32 v56, v56
v_rcp_f32 v57, v57
v_pk_fma_f32 v[60:61], v[238:239], v[20:21], v[32:33] op_sel:[0,0,0] op_sel_hi:[0,1,1] neg_lo:[1,0,0] neg_hi:[1,0,0]
v_pk_mul_f32 v[56:57], v[56:57], v[58:59]
v_cvt_pk_bf16_f32 v70, v56, v57
v_pk_fma_f32 v[62:63], v[238:239], v[22:23], v[34:35] op_sel:[0,0,0] op_sel_hi:[0,1,1] neg_lo:[1,0,0] neg_hi:[1,0,0]
v_pk_fma_f32 v[60:61], v[236:237], v[104:105], v[60:61] op_sel:[0,0,0] op_sel_hi:[0,1,1]
v_exp_f32 v60, v60
v_exp_f32 v61, v61
v_pk_fma_f32 v[62:63], v[236:237], v[106:107], v[62:63] op_sel:[1,0,0] op_sel_hi:[1,1,1]
v_pk_add_f32 v[60:61], v[60:61], 1.0 op_sel_hi:[1,0]
v_rcp_f32 v60, v60
v_rcp_f32 v61, v61
v_pk_fma_f32 v[56:57], v[226:227], v[24:25], v[36:37] op_sel:[0,0,0] op_sel_hi:[0,1,1] neg_lo:[1,0,0] neg_hi:[1,0,0]
v_pk_mul_f32 v[60:61], v[60:61], v[62:63]
v_permlane32_swap_b32_e64 v68, v70
v_cvt_pk_bf16_f32 v71, v60, v61
v_pk_fma_f32 v[58:59], v[226:227], v[26:27], v[38:39] op_sel:[0,0,0] op_sel_hi:[0,1,1] neg_lo:[1,0,0] neg_hi:[1,0,0]
v_pk_fma_f32 v[56:57], v[224:225], v[72:73], v[56:57] op_sel:[0,0,0] op_sel_hi:[0,1,1]
v_permlane32_swap_b32 v69, v71
v_exp_f32 v56, v56
v_exp_f32 v57, v57
v_permlane16_swap_b32 v68, v69
v_permlane16_swap_b32_e64 v70, v71
buffer_store_dwordx4 v[68:71], v8, s[4:7], s93 offen sc1
v_pk_fma_f32 v[58:59], v[224:225], v[74:75], v[58:59] op_sel:[1,0,0] op_sel_hi:[1,1,1]
v_pk_add_f32 v[56:57], v[56:57], 1.0 op_sel_hi:[1,0]
v_rcp_f32 v56, v56
v_rcp_f32 v57, v57
v_pk_fma_f32 v[60:61], v[230:231], v[24:25], v[36:37] op_sel:[0,0,0] op_sel_hi:[0,1,1] neg_lo:[1,0,0] neg_hi:[1,0,0]
v_pk_mul_f32 v[56:57], v[56:57], v[58:59]
v_cvt_pk_bf16_f32 v72, v56, v57
v_pk_fma_f32 v[62:63], v[230:231], v[26:27], v[38:39] op_sel:[0,0,0] op_sel_hi:[0,1,1] neg_lo:[1,0,0] neg_hi:[1,0,0]
v_pk_fma_f32 v[60:61], v[228:229], v[84:85], v[60:61] op_sel:[0,0,0] op_sel_hi:[0,1,1]
v_exp_f32 v60, v60
v_exp_f32 v61, v61
v_pk_fma_f32 v[62:63], v[228:229], v[86:87], v[62:63] op_sel:[1,0,0] op_sel_hi:[1,1,1]
v_pk_add_f32 v[60:61], v[60:61], 1.0 op_sel_hi:[1,0]
v_rcp_f32 v60, v60
v_rcp_f32 v61, v61
v_pk_fma_f32 v[56:57], v[234:235], v[24:25], v[36:37] op_sel:[0,0,0] op_sel_hi:[0,1,1] neg_lo:[1,0,0] neg_hi:[1,0,0]
v_pk_mul_f32 v[60:61], v[60:61], v[62:63]
v_cvt_pk_bf16_f32 v73, v60, v61
v_pk_fma_f32 v[58:59], v[234:235], v[26:27], v[38:39] op_sel:[0,0,0] op_sel_hi:[0,1,1] neg_lo:[1,0,0] neg_hi:[1,0,0]
v_pk_fma_f32 v[56:57], v[232:233], v[96:97], v[56:57] op_sel:[0,0,0] op_sel_hi:[0,1,1]
v_exp_f32 v56, v56
v_exp_f32 v57, v57
v_pk_fma_f32 v[58:59], v[232:233], v[98:99], v[58:59] op_sel:[1,0,0] op_sel_hi:[1,1,1]
v_pk_add_f32 v[56:57], v[56:57], 1.0 op_sel_hi:[1,0]
v_rcp_f32 v56, v56
v_rcp_f32 v57, v57
v_pk_fma_f32 v[60:61], v[238:239], v[24:25], v[36:37] op_sel:[0,0,0] op_sel_hi:[0,1,1] neg_lo:[1,0,0] neg_hi:[1,0,0]
v_pk_mul_f32 v[56:57], v[56:57], v[58:59]
v_cvt_pk_bf16_f32 v74, v56, v57
v_pk_fma_f32 v[62:63], v[238:239], v[26:27], v[38:39] op_sel:[0,0,0] op_sel_hi:[0,1,1] neg_lo:[1,0,0] neg_hi:[1,0,0]
v_pk_fma_f32 v[60:61], v[236:237], v[108:109], v[60:61] op_sel:[0,0,0] op_sel_hi:[0,1,1]
v_exp_f32 v60, v60
v_exp_f32 v61, v61
v_pk_fma_f32 v[62:63], v[236:237], v[110:111], v[62:63] op_sel:[1,0,0] op_sel_hi:[1,1,1]
v_pk_add_f32 v[60:61], v[60:61], 1.0 op_sel_hi:[1,0]
v_rcp_f32 v60, v60
v_rcp_f32 v61, v61
v_permlane32_swap_b32_e64 v72, v74
v_pk_mul_f32 v[60:61], v[60:61], v[62:63]
v_cvt_pk_bf16_f32 v75, v60, v61
s_nop 1
v_permlane32_swap_b32_e64 v73, v75
s_nop 1
v_permlane16_swap_b32 v72, v73
v_permlane16_swap_b32_e64 v74, v75
buffer_store_dwordx4 v[72:75], v8, s[4:7], s57 offen sc1
v_mfma_f32_16x16x32_bf16 v[112:115], a[132:135], a[208:211], v[112:115]
ds_read_b64_tr_b16 a[196:197], v45 offset:32768
s_mul_i32 s86, s35, 360448
v_mfma_f32_16x16x32_bf16 v[116:119], a[136:139], a[208:211], v[116:119]
ds_read_b64_tr_b16 a[198:199], v45 offset:36864
s_lshl_b32 s87, s33, 10
v_mfma_f32_16x16x32_bf16 v[120:123], a[140:143], a[208:211], v[120:123]
s_add_u32 s86, s86, s87
s_add_u32 s86, s86, 10485760
v_mfma_f32_16x16x32_bf16 v[124:127], a[132:135], a[212:215], v[124:127]
ds_read_b64_tr_b16 a[200:201], v46 offset:32768
s_xor_b32 s87, s3, 0
v_mfma_f32_16x16x32_bf16 v[128:131], a[136:139], a[212:215], v[128:131]
ds_read_b64_tr_b16 a[202:203], v46 offset:36864
s_mul_i32 s88, s87, 45056
v_mfma_f32_16x16x32_bf16 v[132:135], a[140:143], a[212:215], v[132:135]
buffer_load_dwordx4 a[0:3], v2, s[4:7], s85 offen offset:0
v_mfma_f32_16x16x32_bf16 v[136:139], a[132:135], a[216:219], v[136:139]
ds_read_b64_tr_b16 a[204:205], v47 offset:32768
v_add_u32 v248, s88, v2
v_mfma_f32_16x16x32_bf16 v[140:143], a[136:139], a[216:219], v[140:143]
ds_read_b64_tr_b16 a[206:207], v47 offset:36864
s_xor_b32 s87, s3, 1
v_mfma_f32_16x16x32_bf16 v[144:147], a[140:143], a[216:219], v[144:147]
buffer_load_dwordx4 a[4:7], v2, s[4:7], s85 offen offset:1024
v_mfma_f32_16x16x32_bf16 v[148:151], a[132:135], a[220:223], v[148:151]
ds_read_b64_tr_b16 a[208:209], v44 offset:40960
s_mul_i32 s88, s87, 45056
v_mfma_f32_16x16x32_bf16 v[152:155], a[136:139], a[220:223], v[152:155]
ds_read_b64_tr_b16 a[210:211], v44 offset:45056
v_add_u32_e64 v249, s88, v2
v_mfma_f32_16x16x32_bf16 v[156:159], a[140:143], a[220:223], v[156:159]
buffer_load_dwordx4 a[8:11], v2, s[4:7], s85 offen offset:2048
v_mfma_f32_16x16x32_bf16 v[112:115], a[144:147], a[192:195], v[112:115]
ds_read_b64_tr_b16 a[212:213], v45 offset:40960
v_mov_b32_e64 v250, 1073741824
v_mfma_f32_16x16x32_bf16 v[116:119], a[148:151], a[192:195], v[116:119]
ds_read_b64_tr_b16 a[214:215], v45 offset:45056
s_waitcnt lgkmcnt(8)
v_mfma_f32_16x16x32_bf16 v[120:123], a[152:155], a[192:195], v[120:123]
v_mfma_f32_16x16x32_bf16 v[124:127], a[144:147], a[196:199], v[124:127]
ds_read_b64_tr_b16 a[216:217], v46 offset:40960
v_mfma_f32_16x16x32_bf16 v[128:131], a[148:151], a[196:199], v[128:131]
ds_read_b64_tr_b16 a[218:219], v46 offset:45056
s_waitcnt lgkmcnt(8)
v_mfma_f32_16x16x32_bf16 v[132:135], a[152:155], a[196:199], v[132:135]
buffer_load_dwordx4 a[12:15], v2, s[4:7], s85 offen offset:3072
v_mfma_f32_16x16x32_bf16 v[136:139], a[144:147], a[200:203], v[136:139]
ds_read_b64_tr_b16 a[220:221], v47 offset:40960
s_add_u32 s85, s85, 4096
v_mfma_f32_16x16x32_bf16 v[140:143], a[148:151], a[200:203], v[140:143]
ds_read_b64_tr_b16 a[222:223], v47 offset:45056
s_waitcnt lgkmcnt(8)
v_mfma_f32_16x16x32_bf16 v[144:147], a[152:155], a[200:203], v[144:147]
buffer_load_dwordx4 a[16:19], v2, s[4:7], s85 offen offset:0
v_mfma_f32_16x16x32_bf16 v[148:151], a[144:147], a[204:207], v[148:151]
ds_read_b64_tr_b16 a[192:193], v44 offset:49152
v_mfma_f32_16x16x32_bf16 v[152:155], a[148:151], a[204:207], v[152:155]
ds_read_b64_tr_b16 a[194:195], v44 offset:53248
s_waitcnt lgkmcnt(8)
v_mfma_f32_16x16x32_bf16 v[156:159], a[152:155], a[204:207], v[156:159]
buffer_load_dwordx4 a[20:23], v2, s[4:7], s85 offen offset:1024
v_mfma_f32_16x16x32_bf16 v[112:115], a[156:159], a[208:211], v[112:115]
ds_read_b64_tr_b16 a[196:197], v45 offset:49152
v_mfma_f32_16x16x32_bf16 v[116:119], a[160:163], a[208:211], v[116:119]
ds_read_b64_tr_b16 a[198:199], v45 offset:53248
s_waitcnt lgkmcnt(8)
v_mfma_f32_16x16x32_bf16 v[120:123], a[164:167], a[208:211], v[120:123]
v_mfma_f32_16x16x32_bf16 v[124:127], a[156:159], a[212:215], v[124:127]
ds_read_b64_tr_b16 a[200:201], v46 offset:49152
v_mfma_f32_16x16x32_bf16 v[128:131], a[160:163], a[212:215], v[128:131]
ds_read_b64_tr_b16 a[202:203], v46 offset:53248
s_waitcnt lgkmcnt(8)
v_mfma_f32_16x16x32_bf16 v[132:135], a[164:167], a[212:215], v[132:135]
buffer_load_dwordx4 a[24:27], v2, s[4:7], s85 offen offset:2048
v_mfma_f32_16x16x32_bf16 v[136:139], a[156:159], a[216:219], v[136:139]
ds_read_b64_tr_b16 a[204:205], v47 offset:49152
v_mfma_f32_16x16x32_bf16 v[140:143], a[160:163], a[216:219], v[140:143]
ds_read_b64_tr_b16 a[206:207], v47 offset:53248
s_waitcnt lgkmcnt(8)
v_mfma_f32_16x16x32_bf16 v[144:147], a[164:167], a[216:219], v[144:147]
buffer_load_dwordx4 a[28:31], v2, s[4:7], s85 offen offset:3072
v_mfma_f32_16x16x32_bf16 v[148:151], a[156:159], a[220:223], v[148:151]
ds_read_b64_tr_b16 a[208:209], v44 offset:57344
s_add_u32 s85, s85, 4096
v_mfma_f32_16x16x32_bf16 v[152:155], a[160:163], a[220:223], v[152:155]
ds_read_b64_tr_b16 a[210:211], v44 offset:61440
s_waitcnt lgkmcnt(8)
v_mfma_f32_16x16x32_bf16 v[156:159], a[164:167], a[220:223], v[156:159]
buffer_load_dwordx4 a[32:35], v2, s[4:7], s85 offen offset:0
v_mfma_f32_16x16x32_bf16 v[112:115], a[168:171], a[192:195], v[112:115]
ds_read_b64_tr_b16 a[212:213], v45 offset:57344
v_mfma_f32_16x16x32_bf16 v[116:119], a[172:175], a[192:195], v[116:119]
ds_read_b64_tr_b16 a[214:215], v45 offset:61440
s_waitcnt lgkmcnt(8)
v_mfma_f32_16x16x32_bf16 v[120:123], a[176:179], a[192:195], v[120:123]
s_waitcnt vmcnt(9)
buffer_atomic_add v12, v9, s[4:7], s56 offen offset:12 sc1
v_mfma_f32_16x16x32_bf16 v[124:127], a[168:171], a[196:199], v[124:127]
ds_read_b64_tr_b16 a[216:217], v46 offset:57344
v_mfma_f32_16x16x32_bf16 v[128:131], a[172:175], a[196:199], v[128:131]
ds_read_b64_tr_b16 a[218:219], v46 offset:61440
s_waitcnt lgkmcnt(8)
v_mfma_f32_16x16x32_bf16 v[132:135], a[176:179], a[196:199], v[132:135]
buffer_load_dwordx4 a[36:39], v2, s[4:7], s85 offen offset:1024
v_mfma_f32_16x16x32_bf16 v[136:139], a[168:171], a[200:203], v[136:139]
ds_read_b64_tr_b16 a[220:221], v47 offset:57344
v_mfma_f32_16x16x32_bf16 v[140:143], a[172:175], a[200:203], v[140:143]
ds_read_b64_tr_b16 a[222:223], v47 offset:61440
s_waitcnt lgkmcnt(8)
v_mfma_f32_16x16x32_bf16 v[144:147], a[176:179], a[200:203], v[144:147]
buffer_load_dwordx4 a[40:43], v2, s[4:7], s85 offen offset:2048
v_mfma_f32_16x16x32_bf16 v[148:151], a[168:171], a[204:207], v[148:151]
v_mfma_f32_16x16x32_bf16 v[152:155], a[172:175], a[204:207], v[152:155]
s_waitcnt lgkmcnt(6)
v_mfma_f32_16x16x32_bf16 v[156:159], a[176:179], a[204:207], v[156:159]
buffer_load_dwordx4 a[44:47], v2, s[4:7], s85 offen offset:3072
v_mfma_f32_16x16x32_bf16 v[112:115], a[180:183], a[208:211], v[112:115]
s_add_u32 s85, s85, 4096
v_mfma_f32_16x16x32_bf16 v[116:119], a[184:187], a[208:211], v[116:119]
s_waitcnt lgkmcnt(4)
v_mfma_f32_16x16x32_bf16 v[120:123], a[188:191], a[208:211], v[120:123]
v_mfma_f32_16x16x32_bf16 v[124:127], a[180:183], a[212:215], v[124:127]
v_mfma_f32_16x16x32_bf16 v[128:131], a[184:187], a[212:215], v[128:131]
s_waitcnt lgkmcnt(2)
v_mfma_f32_16x16x32_bf16 v[132:135], a[188:191], a[212:215], v[132:135]
buffer_load_dwordx4 a[48:51], v2, s[4:7], s85 offen offset:0
v_mfma_f32_16x16x32_bf16 v[136:139], a[180:183], a[216:219], v[136:139]
v_mfma_f32_16x16x32_bf16 v[140:143], a[184:187], a[216:219], v[140:143]
s_waitcnt lgkmcnt(0)
v_mfma_f32_16x16x32_bf16 v[144:147], a[188:191], a[216:219], v[144:147]
buffer_load_dwordx4 a[52:55], v2, s[4:7], s85 offen offset:1024
v_mfma_f32_16x16x32_bf16 v[148:151], a[180:183], a[220:223], v[148:151]
v_mfma_f32_16x16x32_bf16 v[152:155], a[184:187], a[220:223], v[152:155]
v_mfma_f32_16x16x32_bf16 v[156:159], a[188:191], a[220:223], v[156:159]
buffer_load_dwordx4 a[56:59], v2, s[4:7], s85 offen offset:2048
buffer_load_dwordx4 a[60:63], v2, s[4:7], s85 offen offset:3072
s_add_u32 s85, s85, 4096
buffer_load_dwordx4 a[64:67], v2, s[4:7], s85 offen offset:0
buffer_load_dwordx4 a[68:71], v2, s[4:7], s85 offen offset:1024
s_barrier
ds_read_b128 v[224:227], v7 offset:1024
ds_read_b128 v[228:231], v7 offset:1280
ds_read_b128 v[232:235], v7 offset:1536
ds_read_b128 v[236:239], v7 offset:1792
s_waitcnt lgkmcnt(3)
v_pk_fma_f32 v[56:57], v[226:227], v[16:17], v[28:29] op_sel:[0,0,0] op_sel_hi:[0,1,1] neg_lo:[1,0,0] neg_hi:[1,0,0]
v_pk_fma_f32 v[58:59], v[226:227], v[18:19], v[30:31] op_sel:[0,0,0] op_sel_hi:[0,1,1] neg_lo:[1,0,0] neg_hi:[1,0,0]
v_pk_fma_f32 v[56:57], v[224:225], v[112:113], v[56:57] op_sel:[0,0,0] op_sel_hi:[0,1,1]
v_exp_f32 v56, v56
v_exp_f32 v57, v57
v_pk_fma_f32 v[58:59], v[224:225], v[114:115], v[58:59] op_sel:[1,0,0] op_sel_hi:[1,1,1]
v_pk_add_f32 v[56:57], v[56:57], 1.0 op_sel_hi:[1,0]
v_rcp_f32_e64 v56, v56
v_rcp_f32 v57, v57
s_waitcnt lgkmcnt(2)
v_pk_fma_f32 v[60:61], v[230:231], v[16:17], v[28:29] op_sel:[0,0,0] op_sel_hi:[0,1,1] neg_lo:[1,0,0] neg_hi:[1,0,0]
v_pk_mul_f32 v[56:57], v[56:57], v[58:59]
v_cvt_pk_bf16_f32 v112, v56, v57
v_pk_fma_f32 v[62:63], v[230:231], v[18:19], v[30:31] op_sel:[0,0,0] op_sel_hi:[0,1,1] neg_lo:[1,0,0] neg_hi:[1,0,0]
v_pk_fma_f32 v[60:61], v[228:229], v[124:125], v[60:61] op_sel:[0,0,0] op_sel_hi:[0,1,1]
v_exp_f32 v60, v60
v_exp_f32 v61, v61
v_pk_fma_f32 v[62:63], v[228:229], v[126:127], v[62:63] op_sel:[1,0,0] op_sel_hi:[1,1,1]
v_pk_add_f32 v[60:61], v[60:61], 1.0 op_sel_hi:[1,0]
v_rcp_f32 v60, v60
v_rcp_f32_e64 v61, v61
s_waitcnt lgkmcnt(1)
v_pk_fma_f32 v[56:57], v[234:235], v[16:17], v[28:29] op_sel:[0,0,0] op_sel_hi:[0,1,1] neg_lo:[1,0,0] neg_hi:[1,0,0]
v_pk_mul_f32 v[60:61], v[60:61], v[62:63]
v_cvt_pk_bf16_f32 v113, v60, v61
v_pk_fma_f32 v[58:59], v[234:235], v[18:19], v[30:31] op_sel:[0,0,0] op_sel_hi:[0,1,1] neg_lo:[1,0,0] neg_hi:[1,0,0]
v_pk_fma_f32 v[56:57], v[232:233], v[136:137], v[56:57] op_sel:[0,0,0] op_sel_hi:[0,1,1]
v_exp_f32 v56, v56
v_exp_f32 v57, v57
v_pk_fma_f32 v[58:59], v[232:233], v[138:139], v[58:59] op_sel:[1,0,0] op_sel_hi:[1,1,1]
v_pk_add_f32 v[56:57], v[56:57], 1.0 op_sel_hi:[1,0]
v_rcp_f32_e64 v56, v56
v_rcp_f32 v57, v57
s_waitcnt lgkmcnt(0)
v_pk_fma_f32 v[60:61], v[238:239], v[16:17], v[28:29] op_sel:[0,0,0] op_sel_hi:[0,1,1] neg_lo:[1,0,0] neg_hi:[1,0,0]
v_pk_mul_f32 v[56:57], v[56:57], v[58:59]
v_cvt_pk_bf16_f32 v114, v56, v57
v_pk_fma_f32 v[62:63], v[238:239], v[18:19], v[30:31] op_sel:[0,0,0] op_sel_hi:[0,1,1] neg_lo:[1,0,0] neg_hi:[1,0,0]
v_pk_fma_f32 v[60:61], v[236:237], v[148:149], v[60:61] op_sel:[0,0,0] op_sel_hi:[0,1,1]
v_exp_f32 v60, v60
v_exp_f32 v61, v61
v_pk_fma_f32 v[62:63], v[236:237], v[150:151], v[62:63] op_sel:[1,0,0] op_sel_hi:[1,1,1]
v_pk_add_f32 v[60:61], v[60:61], 1.0 op_sel_hi:[1,0]
v_rcp_f32 v60, v60
v_rcp_f32 v61, v61
v_pk_fma_f32 v[56:57], v[226:227], v[20:21], v[32:33] op_sel:[0,0,0] op_sel_hi:[0,1,1] neg_lo:[1,0,0] neg_hi:[1,0,0]
v_pk_mul_f32 v[60:61], v[60:61], v[62:63]
v_permlane32_swap_b32 v112, v114
v_cvt_pk_bf16_f32 v115, v60, v61
v_pk_fma_f32 v[58:59], v[226:227], v[22:23], v[34:35] op_sel:[0,0,0] op_sel_hi:[0,1,1] neg_lo:[1,0,0] neg_hi:[1,0,0]
v_pk_fma_f32 v[56:57], v[224:225], v[116:117], v[56:57] op_sel:[0,0,0] op_sel_hi:[0,1,1]
v_permlane32_swap_b32 v113, v115
v_exp_f32 v56, v56
v_exp_f32 v57, v57
v_permlane16_swap_b32 v112, v113
v_permlane16_swap_b32 v114, v115
buffer_store_dwordx4 v[112:115], v15, s[4:7], s53 offen sc1
v_pk_fma_f32 v[58:59], v[224:225], v[118:119], v[58:59] op_sel:[1,0,0] op_sel_hi:[1,1,1]
v_pk_add_f32 v[56:57], v[56:57], 1.0 op_sel_hi:[1,0]
v_rcp_f32 v56, v56
v_rcp_f32 v57, v57
v_pk_fma_f32 v[60:61], v[230:231], v[20:21], v[32:33] op_sel:[0,0,0] op_sel_hi:[0,1,1] neg_lo:[1,0,0] neg_hi:[1,0,0]
v_pk_mul_f32 v[56:57], v[56:57], v[58:59]
v_cvt_pk_bf16_f32 v116, v56, v57
v_pk_fma_f32 v[62:63], v[230:231], v[22:23], v[34:35] op_sel:[0,0,0] op_sel_hi:[0,1,1] neg_lo:[1,0,0] neg_hi:[1,0,0]
v_pk_fma_f32 v[60:61], v[228:229], v[128:129], v[60:61] op_sel:[0,0,0] op_sel_hi:[0,1,1]
v_exp_f32 v60, v60
v_exp_f32 v61, v61
v_pk_fma_f32 v[62:63], v[228:229], v[130:131], v[62:63] op_sel:[1,0,0] op_sel_hi:[1,1,1]
v_pk_add_f32 v[60:61], v[60:61], 1.0 op_sel_hi:[1,0]
v_rcp_f32 v60, v60
v_rcp_f32 v61, v61
v_pk_fma_f32 v[56:57], v[234:235], v[20:21], v[32:33] op_sel:[0,0,0] op_sel_hi:[0,1,1] neg_lo:[1,0,0] neg_hi:[1,0,0]
v_pk_mul_f32 v[60:61], v[60:61], v[62:63]
v_cvt_pk_bf16_f32 v117, v60, v61
v_pk_fma_f32 v[58:59], v[234:235], v[22:23], v[34:35] op_sel:[0,0,0] op_sel_hi:[0,1,1] neg_lo:[1,0,0] neg_hi:[1,0,0]
v_pk_fma_f32 v[56:57], v[232:233], v[140:141], v[56:57] op_sel:[0,0,0] op_sel_hi:[0,1,1]
v_exp_f32 v56, v56
v_exp_f32 v57, v57
v_pk_fma_f32 v[58:59], v[232:233], v[142:143], v[58:59] op_sel:[1,0,0] op_sel_hi:[1,1,1]
v_pk_add_f32 v[56:57], v[56:57], 1.0 op_sel_hi:[1,0]
v_rcp_f32 v56, v56
v_rcp_f32 v57, v57
v_pk_fma_f32 v[60:61], v[238:239], v[20:21], v[32:33] op_sel:[0,0,0] op_sel_hi:[0,1,1] neg_lo:[1,0,0] neg_hi:[1,0,0]
v_pk_mul_f32 v[56:57], v[56:57], v[58:59]
v_cvt_pk_bf16_f32 v118, v56, v57
v_pk_fma_f32 v[62:63], v[238:239], v[22:23], v[34:35] op_sel:[0,0,0] op_sel_hi:[0,1,1] neg_lo:[1,0,0] neg_hi:[1,0,0]
v_pk_fma_f32 v[60:61], v[236:237], v[152:153], v[60:61] op_sel:[0,0,0] op_sel_hi:[0,1,1]
v_exp_f32 v60, v60
v_exp_f32 v61, v61
v_pk_fma_f32 v[62:63], v[236:237], v[154:155], v[62:63] op_sel:[1,0,0] op_sel_hi:[1,1,1]
v_pk_add_f32 v[60:61], v[60:61], 1.0 op_sel_hi:[1,0]
v_rcp_f32 v60, v60
v_rcp_f32 v61, v61
v_pk_fma_f32 v[56:57], v[226:227], v[24:25], v[36:37] op_sel:[0,0,0] op_sel_hi:[0,1,1] neg_lo:[1,0,0] neg_hi:[1,0,0]
v_pk_mul_f32 v[60:61], v[60:61], v[62:63]
v_permlane32_swap_b32_e64 v116, v118
v_cvt_pk_bf16_f32 v119, v60, v61
v_pk_fma_f32 v[58:59], v[226:227], v[26:27], v[38:39] op_sel:[0,0,0] op_sel_hi:[0,1,1] neg_lo:[1,0,0] neg_hi:[1,0,0]
v_pk_fma_f32 v[56:57], v[224:225], v[120:121], v[56:57] op_sel:[0,0,0] op_sel_hi:[0,1,1]
v_permlane32_swap_b32 v117, v119
v_exp_f32 v56, v56
v_exp_f32 v57, v57
v_permlane16_swap_b32 v116, v117
v_permlane16_swap_b32_e64 v118, v119
buffer_store_dwordx4 v[116:119], v15, s[4:7], s93 offen sc1
v_pk_fma_f32 v[58:59], v[224:225], v[122:123], v[58:59] op_sel:[1,0,0] op_sel_hi:[1,1,1]
v_pk_add_f32 v[56:57], v[56:57], 1.0 op_sel_hi:[1,0]
v_rcp_f32 v56, v56
v_rcp_f32 v57, v57
v_pk_fma_f32 v[60:61], v[230:231], v[24:25], v[36:37] op_sel:[0,0,0] op_sel_hi:[0,1,1] neg_lo:[1,0,0] neg_hi:[1,0,0]
v_pk_mul_f32 v[56:57], v[56:57], v[58:59]
v_cvt_pk_bf16_f32 v120, v56, v57
v_pk_fma_f32 v[62:63], v[230:231], v[26:27], v[38:39] op_sel:[0,0,0] op_sel_hi:[0,1,1] neg_lo:[1,0,0] neg_hi:[1,0,0]
v_pk_fma_f32 v[60:61], v[228:229], v[132:133], v[60:61] op_sel:[0,0,0] op_sel_hi:[0,1,1]
v_exp_f32 v60, v60
v_exp_f32 v61, v61
v_pk_fma_f32 v[62:63], v[228:229], v[134:135], v[62:63] op_sel:[1,0,0] op_sel_hi:[1,1,1]
v_pk_add_f32 v[60:61], v[60:61], 1.0 op_sel_hi:[1,0]
v_rcp_f32 v60, v60
v_rcp_f32 v61, v61
v_pk_fma_f32 v[56:57], v[234:235], v[24:25], v[36:37] op_sel:[0,0,0] op_sel_hi:[0,1,1] neg_lo:[1,0,0] neg_hi:[1,0,0]
v_pk_mul_f32 v[60:61], v[60:61], v[62:63]
v_cvt_pk_bf16_f32 v121, v60, v61
v_pk_fma_f32 v[58:59], v[234:235], v[26:27], v[38:39] op_sel:[0,0,0] op_sel_hi:[0,1,1] neg_lo:[1,0,0] neg_hi:[1,0,0]
v_pk_fma_f32 v[56:57], v[232:233], v[144:145], v[56:57] op_sel:[0,0,0] op_sel_hi:[0,1,1]
v_exp_f32 v56, v56
v_exp_f32 v57, v57
v_pk_fma_f32 v[58:59], v[232:233], v[146:147], v[58:59] op_sel:[1,0,0] op_sel_hi:[1,1,1]
v_pk_add_f32 v[56:57], v[56:57], 1.0 op_sel_hi:[1,0]
v_rcp_f32 v56, v56
v_rcp_f32 v57, v57
v_pk_fma_f32 v[60:61], v[238:239], v[24:25], v[36:37] op_sel:[0,0,0] op_sel_hi:[0,1,1] neg_lo:[1,0,0] neg_hi:[1,0,0]
v_pk_mul_f32 v[56:57], v[56:57], v[58:59]
v_cvt_pk_bf16_f32 v122, v56, v57
v_pk_fma_f32 v[62:63], v[238:239], v[26:27], v[38:39] op_sel:[0,0,0] op_sel_hi:[0,1,1] neg_lo:[1,0,0] neg_hi:[1,0,0]
v_pk_fma_f32 v[60:61], v[236:237], v[156:157], v[60:61] op_sel:[0,0,0] op_sel_hi:[0,1,1]
v_exp_f32 v60, v60
v_exp_f32 v61, v61
v_pk_fma_f32 v[62:63], v[236:237], v[158:159], v[62:63] op_sel:[1,0,0] op_sel_hi:[1,1,1]
v_pk_add_f32 v[60:61], v[60:61], 1.0 op_sel_hi:[1,0]
v_rcp_f32 v60, v60
v_rcp_f32 v61, v61
v_permlane32_swap_b32 v120, v122
v_pk_mul_f32 v[60:61], v[60:61], v[62:63]
v_cvt_pk_bf16_f32 v123, v60, v61
s_nop 1
v_permlane32_swap_b32 v121, v123
s_nop 1
v_permlane16_swap_b32 v120, v121
v_permlane16_swap_b32 v122, v123
buffer_store_dwordx4 v[120:123], v15, s[4:7], s57 offen sc1
buffer_load_dwordx4 a[72:75], v2, s[4:7], s85 offen offset:2048
buffer_load_dwordx4 a[76:79], v2, s[4:7], s85 offen offset:3072
s_add_u32 s85, s85, 4096
s_lshl_b32 s53, s35, 3
s_add_u32 s53, s53, s3
s_lshl_b32 s53, s53, 14
s_lshl_b32 s54, s62, 6
s_add_u32 s53, s53, s54
s_add_u32 s54, s53, 65536
s_xor_b32 s87, s33, 0
s_mul_i32 s88, s87, 6144
v_add_u32 v15, s88, v2
s_xor_b32 s87, s33, 1
s_mul_i32 s88, s87, 6144
v_add_u32 v58, s88, v2
s_xor_b32 s87, s33, 2
s_mul_i32 s88, s87, 6144
v_add_u32 v59, s88, v2
s_xor_b32 s87, s33, 3
L_pad_b_3:
s_cbranch_execz L_ret_b
s_mul_i32 s88, s87, 6144
v_add_u32_e64 v60, s88, v2
s_lshl_b32 s87, s33, 11
s_add_u32 s87, s87, 49152
v_bfe_u32 v62, v3, 1, 2
v_xor_b32_e64 v62, v62, v4
v_lshlrev_b32_e64 v61, 6, v3
v_lshl_add_u32 v61, v62, 4, v61
v_add_u32_e64 v61, s87, v61
v_bfe_u32 v62, v1, 3, 2
v_xor_b32_e64 v62, v62, v1
v_lshl_add_u32 v62, v62, 4, s87
v_lshrrev_b32_e64 v7, 2, v1
v_lshlrev_b32_e64 v7, 10, v7
v_and_b32_e64 v6, 3, v1
v_lshl_add_u32 v7, v6, 4, v7
s_waitcnt vmcnt(3)
s_add_u32 s58, s56, 8192
buffer_atomic_add v12, v9, s[4:7], s58 offen offset:12 sc1
s_barrier

s_branch L_g1_join
L_g1_w3:
L_pad_c_0:
s_cbranch_execz L_pad_c_1
s_mov_b32 s40, 0x00100001
s_mov_b32 s41, 0x10000100
s_mov_b32 s42, 0x00200002
s_mov_b32 s43, 0x20000200
s_mov_b32 s44, 0x00400004
s_mov_b32 s45, 0x40000400
s_mov_b32 s46, 0x00800008
s_mov_b32 s47, 0x80000800
s_mov_b32 s48, 0x3b000000
s_mov_b32 s49, 0x3b000000
s_waitcnt vmcnt(8)
s_barrier
ds_read_b64_tr_b16 a[192:193], v40 offset:0
ds_read_b64_tr_b16 a[194:195], v40 offset:4096
ds_read_b64_tr_b16 a[196:197], v41 offset:0
ds_read_b64_tr_b16 a[198:199], v41 offset:4096
ds_read_b64_tr_b16 a[200:201], v42 offset:0
ds_read_b64_tr_b16 a[202:203], v42 offset:4096
ds_read_b64_tr_b16 a[204:205], v43 offset:0
ds_read_b64_tr_b16 a[206:207], v43 offset:4096
ds_read_b64_tr_b16 a[208:209], v44 offset:0
ds_read_b64_tr_b16 a[210:211], v44 offset:4096
buffer_atomic_add v233, v230, s[4:7], s101 offen offset:16 sc1
s_waitcnt lgkmcnt(8)
v_mfma_f32_16x16x32_bf16 v[64:67], a[0:3], a[192:195], 0
ds_read_b64_tr_b16 a[212:213], v45 offset:0
v_mfma_f32_16x16x32_bf16 v[68:71], a[4:7], a[192:195], 0
ds_read_b64_tr_b16 a[214:215], v45 offset:4096
s_waitcnt lgkmcnt(8)
v_mfma_f32_16x16x32_bf16 v[72:75], a[192:195], a[192:195], 0
v_mfma_f32_16x16x32_bf16 v[76:79], a[0:3], a[196:199], 0
ds_read_b64_tr_b16 a[216:217], v46 offset:0
v_mfma_f32_16x16x32_bf16 v[80:83], a[4:7], a[196:199], 0
ds_read_b64_tr_b16 a[218:219], v46 offset:4096
s_waitcnt lgkmcnt(8)
v_mfma_f32_16x16x32_bf16 v[84:87], a[196:199], a[196:199], 0
buffer_load_dwordx4 v9, s[4:7], s86 offen lds
v_mfma_f32_16x16x32_bf16 v[88:91], a[0:3], a[200:203], 0
ds_read_b64_tr_b16 a[220:221], v47 offset:0
s_add_u32 m0, m0, 1024
v_mfma_f32_16x16x32_bf16 v[92:95], a[4:7], a[200:203], 0
ds_read_b64_tr_b16 a[222:223], v47 offset:4096
s_waitcnt lgkmcnt(8)
v_mfma_f32_16x16x32_bf16 v[96:99], a[200:203], a[200:203], 0
s_waitcnt vmcnt(8)
s_barrier
v_mfma_f32_16x16x32_bf16 v[100:103], a[0:3], a[204:207], 0
ds_read_b64_tr_b16 a[192:193], v40 offset:8192
v_mfma_f32_16x16x32_bf16 v[104:107], a[4:7], a[204:207], 0
ds_read_b64_tr_b16 a[194:195], v40 offset:12288
s_waitcnt lgkmcnt(8)
v_mfma_f32_16x16x32_bf16 v[108:111], a[204:207], a[204:207], 0
buffer_load_dwordx4 v10, s[4:7], s86 offen lds
v_mfma_f32_16x16x32_bf16 v[112:115], a[0:3], a[208:211], 0
ds_read_b64_tr_b16 a[196:197], v41 offset:8192
s_add_u32 m0, m0, 7168
v_mfma_f32_16x16x32_bf16 v[116:119], a[4:7], a[208:211], 0
ds_read_b64_tr_b16 a[198:199], v41 offset:12288
s_waitcnt lgkmcnt(8)
v_mfma_f32_16x16x32_bf16 v[120:123], a[208:211], a[208:211], 0
s_add_u32 s86, s86, 131072
buffer_load_dwordx4 v9, s[4:7], s86 offen lds
v_mfma_f32_16x16x32_bf16 v[124:127], a[0:3], a[212:215], 0
ds_read_b64_tr_b16 a[200:201], v42 offset:8192
s_add_u32 m0, m0, 1024
v_mfma_f32_16x16x32_bf16 v[128:131], a[4:7], a[212:215], 0
ds_read_b64_tr_b16 a[202:203], v42 offset:12288
s_waitcnt lgkmcnt(8)
s_nop 0
v_mfma_f32_16x16x32_bf16 v[132:135], a[212:215], a[212:215], 0
buffer_load_dwordx4 v10, s[4:7], s86 offen lds
v_mfma_f32_16x16x32_bf16 v[136:139], a[0:3], a[216:219], 0
ds_read_b64_tr_b16 a[204:205], v43 offset:8192
s_add_u32 m0, m0, 7168
v_mfma_f32_16x16x32_bf16 v[140:143], a[4:7], a[216:219], 0
ds_read_b64_tr_b16 a[206:207], v43 offset:12288
s_waitcnt lgkmcnt(8)
v_mfma_f32_16x16x32_bf16 v[144:147], a[216:219], a[216:219], 0
s_add_u32 s86, s86, 131072
buffer_load_dwordx4 v9, s[4:7], s86 offen lds
v_mfma_f32_16x16x32_bf16 v[148:151], a[0:3], a[220:223], 0
ds_read_b64_tr_b16 a[208:209], v44 offset:8192
s_add_u32 m0, m0, 1024
v_mfma_f32_16x16x32_bf16 v[152:155], a[4:7], a[220:223], 0
ds_read_b64_tr_b16 a[210:211], v44 offset:12288
s_waitcnt lgkmcnt(8)
v_mfma_f32_16x16x32_bf16 v[156:159], a[220:223], a[220:223], 0
v_mfma_f32_16x16x32_bf16 v[64:67], a[12:15], a[192:195], v[64:67]
ds_read_b64_tr_b16 a[212:213], v45 offset:8192
v_mfma_f32_16x16x32_bf16 v[68:71], a[16:19], a[192:195], v[68:71]
ds_read_b64_tr_b16 a[214:215], v45 offset:12288
s_waitcnt lgkmcnt(8)
v_mfma_f32_16x16x32_bf16 v[72:75], a[192:195], a[192:195], v[72:75]
buffer_load_dwordx4 v10, s[4:7], s86 offen lds
v_mfma_f32_16x16x32_bf16 v[76:79], a[12:15], a[196:199], v[76:79]
ds_read_b64_tr_b16 a[216:217], v46 offset:8192
s_add_u32 m0, m0, 7168
v_mfma_f32_16x16x32_bf16 v[80:83], a[16:19], a[196:199], v[80:83]
ds_read_b64_tr_b16 a[218:219], v46 offset:12288
s_waitcnt lgkmcnt(8)
v_mfma_f32_16x16x32_bf16 v[84:87], a[196:199], a[196:199], v[84:87]
s_add_u32 s86, s86, 131072
buffer_load_dwordx4 a[84:87], v13, s[4:7], s81 offen
v_mfma_f32_16x16x32_bf16 v[88:91], a[12:15], a[200:203], v[88:91]
ds_read_b64_tr_b16 a[220:221], v47 offset:8192
v_mfma_f32_16x16x32_bf16 v[92:95], a[16:19], a[200:203], v[92:95]
ds_read_b64_tr_b16 a[222:223], v47 offset:12288
s_waitcnt lgkmcnt(8)
v_mfma_f32_16x16x32_bf16 v[96:99], a[200:203], a[200:203], v[96:99]
s_waitcnt vmcnt(10)
s_barrier
v_mfma_f32_16x16x32_bf16 v[100:103], a[12:15], a[204:207], v[100:103]
ds_read_b64_tr_b16 a[192:193], v40 offset:16384
v_mfma_f32_16x16x32_bf16 v[104:107], a[16:19], a[204:207], v[104:107]
ds_read_b64_tr_b16 a[194:195], v40 offset:20480
s_waitcnt lgkmcnt(8)
v_mfma_f32_16x16x32_bf16 v[108:111], a[204:207], a[204:207], v[108:111]
buffer_load_dwordx4 a[88:91], v55, s[4:7], s81 offen
v_mfma_f32_16x16x32_bf16 v[112:115], a[12:15], a[208:211], v[112:115]
ds_read_b64_tr_b16 a[196:197], v41 offset:16384
s_add_u32 s81, s81, 1024
v_mfma_f32_16x16x32_bf16 v[116:119], a[16:19], a[208:211], v[116:119]
ds_read_b64_tr_b16 a[198:199], v41 offset:20480
s_waitcnt lgkmcnt(8)
v_mfma_f32_16x16x32_bf16 v[120:123], a[208:211], a[208:211], v[120:123]
buffer_load_dwordx4 v[228:231], v2, s[4:7], s87 offen offset:0
v_mfma_f32_16x16x32_bf16 v[124:127], a[12:15], a[212:215], v[124:127]
ds_read_b64_tr_b16 a[200:201], v42 offset:16384
v_mfma_f32_16x16x32_bf16 v[128:131], a[16:19], a[212:215], v[128:131]
ds_read_b64_tr_b16 a[202:203], v42 offset:20480
s_waitcnt lgkmcnt(8)
v_mfma_f32_16x16x32_bf16 v[132:135], a[212:215], a[212:215], v[132:135]
buffer_load_dwordx4 v[232:235], v2, s[4:7], s87 offen offset:1024
v_mfma_f32_16x16x32_bf16 v[136:139], a[12:15], a[216:219], v[136:139]
ds_read_b64_tr_b16 a[204:205], v43 offset:16384
v_mfma_f32_16x16x32_bf16 v[140:143], a[16:19], a[216:219], v[140:143]
ds_read_b64_tr_b16 a[206:207], v43 offset:20480
s_waitcnt lgkmcnt(8)
v_mfma_f32_16x16x32_bf16 v[144:147], a[216:219], a[216:219], v[144:147]
v_mfma_f32_16x16x32_bf16 v[148:151], a[12:15], a[220:223], v[148:151]
ds_read_b64_tr_b16 a[208:209], v44 offset:16384
v_mfma_f32_16x16x32_bf16 v[152:155], a[16:19], a[220:223], v[152:155]
ds_read_b64_tr_b16 a[210:211], v44 offset:20480
s_waitcnt lgkmcnt(8)
v_mfma_f32_16x16x32_bf16 v[156:159], a[220:223], a[220:223], v[156:159]
buffer_load_dwordx4 v[236:239], v2, s[4:7], s87 offen offset:2048
v_mfma_f32_16x16x32_bf16 v[64:67], a[24:27], a[192:195], v[64:67]
ds_read_b64_tr_b16 a[212:213], v45 offset:16384
v_mov_b32 v53, 0
v_mfma_f32_16x16x32_bf16 v[68:71], a[28:31], a[192:195], v[68:71]
ds_read_b64_tr_b16 a[214:215], v45 offset:20480
s_waitcnt lgkmcnt(8)
v_mfma_f32_16x16x32_bf16 v[72:75], a[192:195], a[192:195], v[72:75]
buffer_atomic_add v53, v54, s[4:7], s79 offen offset:16 sc0 sc1
v_mfma_f32_16x16x32_bf16 v[76:79], a[24:27], a[196:199], v[76:79]
ds_read_b64_tr_b16 a[216:217], v46 offset:16384
v_mfma_f32_16x16x32_bf16 v[80:83], a[28:31], a[196:199], v[80:83]
ds_read_b64_tr_b16 a[218:219], v46 offset:20480
s_waitcnt lgkmcnt(8)
v_mfma_f32_16x16x32_bf16 v[84:87], a[196:199], a[196:199], v[84:87]
v_mfma_f32_16x16x32_bf16 v[88:91], a[24:27], a[200:203], v[88:91]
ds_read_b64_tr_b16 a[220:221], v47 offset:16384
v_mfma_f32_16x16x32_bf16 v[92:95], a[28:31], a[200:203], v[92:95]
ds_read_b64_tr_b16 a[222:223], v47 offset:20480
s_waitcnt lgkmcnt(8)
v_mfma_f32_16x16x32_bf16 v[96:99], a[200:203], a[200:203], v[96:99]
buffer_load_dwordx4 v[240:243], v2, s[4:7], s87 offen offset:3072
v_mfma_f32_16x16x32_bf16 v[100:103], a[24:27], a[204:207], v[100:103]
ds_read_b64_tr_b16 a[192:193], v40 offset:24576
v_mfma_f32_16x16x32_bf16 v[104:107], a[28:31], a[204:207], v[104:107]
ds_read_b64_tr_b16 a[194:195], v40 offset:28672
s_waitcnt lgkmcnt(8)
v_mfma_f32_16x16x32_bf16 v[108:111], a[204:207], a[204:207], v[108:111]
buffer_load_dwordx2 v[224:225], v58, s[4:7], s89 offen
v_mfma_f32_16x16x32_bf16 v[112:115], a[24:27], a[208:211], v[112:115]
ds_read_b64_tr_b16 a[196:197], v41 offset:24576
v_mfma_f32_16x16x32_bf16 v[116:119], a[28:31], a[208:211], v[116:119]
ds_read_b64_tr_b16 a[198:199], v41 offset:28672
s_waitcnt lgkmcnt(8)
v_mfma_f32_16x16x32_bf16 v[120:123], a[208:211], a[208:211], v[120:123]
buffer_load_dwordx2 v[252:253], v58, s[4:7], s90 offen
v_mfma_f32_16x16x32_bf16 v[124:127], a[24:27], a[212:215], v[124:127]
ds_read_b64_tr_b16 a[200:201], v42 offset:24576
v_mfma_f32_16x16x32_bf16 v[128:131], a[28:31], a[212:215], v[128:131]
ds_read_b64_tr_b16 a[202:203], v42 offset:28672
s_waitcnt lgkmcnt(8)
v_mfma_f32_16x16x32_bf16 v[132:135], a[212:215], a[212:215], v[132:135]
v_mfma_f32_16x16x32_bf16 v[136:139], a[24:27], a[216:219], v[136:139]
ds_read_b64_tr_b16 a[204:205], v43 offset:24576
v_mfma_f32_16x16x32_bf16 v[140:143], a[28:31], a[216:219], v[140:143]
ds_read_b64_tr_b16 a[206:207], v43 offset:28672
s_waitcnt lgkmcnt(8)
v_mfma_f32_16x16x32_bf16 v[144:147], a[216:219], a[216:219], v[144:147]
buffer_load_dwordx4 a[96:99], v13, s[4:7], s81 offen
v_mfma_f32_16x16x32_bf16 v[148:151], a[24:27], a[220:223], v[148:151]
ds_read_b64_tr_b16 a[208:209], v44 offset:24576
v_mfma_f32_16x16x32_bf16 v[152:155], a[28:31], a[220:223], v[152:155]
ds_read_b64_tr_b16 a[210:211], v44 offset:28672
s_waitcnt lgkmcnt(8)
v_mfma_f32_16x16x32_bf16 v[156:159], a[220:223], a[220:223], v[156:159]
buffer_load_dwordx4 a[100:103], v55, s[4:7], s81 offen
v_mfma_f32_16x16x32_bf16 v[64:67], a[36:39], a[192:195], v[64:67]
ds_read_b64_tr_b16 a[212:213], v45 offset:24576
s_add_u32 s81, s81, 1024
v_mfma_f32_16x16x32_bf16 v[68:71], a[40:43], a[192:195], v[68:71]
ds_read_b64_tr_b16 a[214:215], v45 offset:28672
s_waitcnt lgkmcnt(8)
v_mfma_f32_16x16x32_bf16 v[72:75], a[192:195], a[192:195], v[72:75]
v_mfma_f32_16x16x32_bf16 v[76:79], a[36:39], a[196:199], v[76:79]
ds_read_b64_tr_b16 a[216:217], v46 offset:24576
v_mfma_f32_16x16x32_bf16 v[80:83], a[40:43], a[196:199], v[80:83]
ds_read_b64_tr_b16 a[218:219], v46 offset:28672
s_waitcnt lgkmcnt(8)
v_mfma_f32_16x16x32_bf16 v[84:87], a[196:199], a[196:199], v[84:87]
buffer_load_dwordx4 a[108:111], v13, s[4:7], s81 offen
v_mfma_f32_16x16x32_bf16 v[88:91], a[36:39], a[200:203], v[88:91]
ds_read_b64_tr_b16 a[220:221], v47 offset:24576
v_mfma_f32_16x16x32_bf16 v[92:95], a[40:43], a[200:203], v[92:95]
ds_read_b64_tr_b16 a[222:223], v47 offset:28672
s_waitcnt lgkmcnt(8)
v_mfma_f32_16x16x32_bf16 v[96:99], a[200:203], a[200:203], v[96:99]
s_waitcnt vmcnt(19)
s_barrier
v_mfma_f32_16x16x32_bf16 v[100:103], a[36:39], a[204:207], v[100:103]
ds_read_b64_tr_b16 a[192:193], v40 offset:32768
v_mfma_f32_16x16x32_bf16 v[104:107], a[40:43], a[204:207], v[104:107]
ds_read_b64_tr_b16 a[194:195], v40 offset:36864
s_waitcnt lgkmcnt(8)
v_mfma_f32_16x16x32_bf16 v[108:111], a[204:207], a[204:207], v[108:111]
buffer_load_dwordx4 a[112:115], v55, s[4:7], s81 offen
v_mfma_f32_16x16x32_bf16 v[112:115], a[36:39], a[208:211], v[112:115]
ds_read_b64_tr_b16 a[196:197], v41 offset:32768
s_add_u32 s81, s81, 1024
v_mfma_f32_16x16x32_bf16 v[116:119], a[40:43], a[208:211], v[116:119]
ds_read_b64_tr_b16 a[198:199], v41 offset:36864
s_waitcnt lgkmcnt(8)
v_mfma_f32_16x16x32_bf16 v[120:123], a[208:211], a[208:211], v[120:123]
buffer_load_dwordx4 a[120:123], v13, s[4:7], s81 offen
v_mfma_f32_16x16x32_bf16 v[124:127], a[36:39], a[212:215], v[124:127]
ds_read_b64_tr_b16 a[200:201], v42 offset:32768
v_mfma_f32_16x16x32_bf16 v[128:131], a[40:43], a[212:215], v[128:131]
ds_read_b64_tr_b16 a[202:203], v42 offset:36864
s_waitcnt lgkmcnt(8)
v_mfma_f32_16x16x32_bf16 v[132:135], a[212:215], a[212:215], v[132:135]
buffer_load_dwordx4 a[124:127], v55, s[4:7], s81 offen
v_mfma_f32_16x16x32_bf16 v[136:139], a[36:39], a[216:219], v[136:139]
ds_read_b64_tr_b16 a[204:205], v43 offset:32768
s_add_u32 s81, s81, 1024
v_mfma_f32_16x16x32_bf16 v[140:143], a[40:43], a[216:219], v[140:143]
ds_read_b64_tr_b16 a[206:207], v43 offset:36864
s_waitcnt lgkmcnt(8)
v_mfma_f32_16x16x32_bf16 v[144:147], a[216:219], a[216:219], v[144:147]
buffer_load_dwordx4 a[132:135], v13, s[4:7], s81 offen
v_mfma_f32_16x16x32_bf16 v[148:151], a[36:39], a[220:223], v[148:151]
ds_read_b64_tr_b16 a[208:209], v44 offset:32768
v_mfma_f32_16x16x32_bf16 v[152:155], a[40:43], a[220:223], v[152:155]
ds_read_b64_tr_b16 a[210:211], v44 offset:36864
s_waitcnt lgkmcnt(8)
v_mfma_f32_16x16x32_bf16 v[156:159], a[220:223], a[220:223], v[156:159]
v_mfma_f32_16x16x32_bf16 v[64:67], a[48:51], a[192:195], v[64:67]
ds_read_b64_tr_b16 a[212:213], v45 offset:32768
v_mfma_f32_16x16x32_bf16 v[68:71], a[52:55], a[192:195], v[68:71]
ds_read_b64_tr_b16 a[214:215], v45 offset:36864
s_waitcnt lgkmcnt(8)
v_mfma_f32_16x16x32_bf16 v[72:75], a[192:195], a[192:195], v[72:75]
buffer_load_dwordx4 a[136:139], v55, s[4:7], s81 offen
v_mfma_f32_16x16x32_bf16 v[76:79], a[48:51], a[196:199], v[76:79]
ds_read_b64_tr_b16 a[216:217], v46 offset:32768
s_add_u32 s81, s81, 1024
v_mfma_f32_16x16x32_bf16 v[80:83], a[52:55], a[196:199], v[80:83]
ds_read_b64_tr_b16 a[218:219], v46 offset:36864
s_waitcnt lgkmcnt(8)
v_mfma_f32_16x16x32_bf16 v[84:87], a[196:199], a[196:199], v[84:87]
buffer_load_dwordx4 a[144:147], v13, s[4:7], s81 offen
v_mfma_f32_16x16x32_bf16 v[88:91], a[48:51], a[200:203], v[88:91]
ds_read_b64_tr_b16 a[220:221], v47 offset:32768
v_mfma_f32_16x16x32_bf16 v[92:95], a[52:55], a[200:203], v[92:95]
ds_read_b64_tr_b16 a[222:223], v47 offset:36864
s_waitcnt lgkmcnt(8)
v_mfma_f32_16x16x32_bf16 v[96:99], a[200:203], a[200:203], v[96:99]
s_waitcnt vmcnt(18)
s_waitcnt vmcnt(12)
v_cmp_ne_u32 vcc, v52, v53
s_nop 1
s_cbranch_vccnz L_sp_s2b_slow
L_sp_s2b_ok:
s_barrier
v_mfma_f32_16x16x32_bf16 v[100:103], a[48:51], a[204:207], v[100:103]
ds_read_b64_tr_b16 a[192:193], v40 offset:40960
v_mfma_f32_16x16x32_bf16 v[104:107], a[52:55], a[204:207], v[104:107]
ds_read_b64_tr_b16 a[194:195], v40 offset:45056
s_waitcnt lgkmcnt(8)
v_mfma_f32_16x16x32_bf16 v[108:111], a[204:207], a[204:207], v[108:111]
buffer_load_dwordx4 v9, s[4:7], s86 offen lds
v_mfma_f32_16x16x32_bf16 v[112:115], a[48:51], a[208:211], v[112:115]
ds_read_b64_tr_b16 a[196:197], v41 offset:40960
s_add_u32 m0, m0, 1024
v_mfma_f32_16x16x32_bf16 v[116:119], a[52:55], a[208:211], v[116:119]
ds_read_b64_tr_b16 a[198:199], v41 offset:45056
s_waitcnt lgkmcnt(8)
v_mfma_f32_16x16x32_bf16 v[120:123], a[208:211], a[208:211], v[120:123]
buffer_load_dwordx4 v10, s[4:7], s86 offen lds
v_mfma_f32_16x16x32_bf16 v[124:127], a[48:51], a[212:215], v[124:127]
ds_read_b64_tr_b16 a[200:201], v42 offset:40960
s_add_u32 m0, m0, 7168
v_mfma_f32_16x16x32_bf16 v[128:131], a[52:55], a[212:215], v[128:131]
ds_read_b64_tr_b16 a[202:203], v42 offset:45056
s_waitcnt lgkmcnt(8)
v_mfma_f32_16x16x32_bf16 v[132:135], a[212:215], a[212:215], v[132:135]
s_add_u32 s86, s86, 131072
buffer_load_dwordx4 v9, s[4:7], s86 offen lds
v_mfma_f32_16x16x32_bf16 v[136:139], a[48:51], a[216:219], v[136:139]
ds_read_b64_tr_b16 a[204:205], v43 offset:40960
s_add_u32 m0, m0, 1024
v_mfma_f32_16x16x32_bf16 v[140:143], a[52:55], a[216:219], v[140:143]
ds_read_b64_tr_b16 a[206:207], v43 offset:45056
s_waitcnt lgkmcnt(8)
v_mfma_f32_16x16x32_bf16 v[144:147], a[216:219], a[216:219], v[144:147]
s_waitcnt vmcnt(12)
v_add_f32 v228, v228, v232
v_mfma_f32_16x16x32_bf16 v[148:151], a[48:51], a[220:223], v[148:151]
ds_read_b64_tr_b16 a[208:209], v44 offset:40960
v_add_f32 v229, v229, v233
v_mfma_f32_16x16x32_bf16 v[152:155], a[52:55], a[220:223], v[152:155]
ds_read_b64_tr_b16 a[210:211], v44 offset:45056
s_waitcnt lgkmcnt(8)
v_mfma_f32_16x16x32_bf16 v[156:159], a[220:223], a[220:223], v[156:159]
buffer_load_dwordx4 v10, s[4:7], s86 offen lds
v_mfma_f32_16x16x32_bf16 v[64:67], a[60:63], a[192:195], v[64:67]
ds_read_b64_tr_b16 a[212:213], v45 offset:40960
s_add_u32 m0, m0, 7168
v_mfma_f32_16x16x32_bf16 v[68:71], a[64:67], a[192:195], v[68:71]
ds_read_b64_tr_b16 a[214:215], v45 offset:45056
s_waitcnt lgkmcnt(8)
v_mfma_f32_16x16x32_bf16 v[72:75], a[192:195], a[192:195], v[72:75]
s_add_u32 s86, s86, 131072
buffer_load_dwordx4 v9, s[4:7], s86 offen lds
v_mfma_f32_16x16x32_bf16 v[76:79], a[60:63], a[196:199], v[76:79]
ds_read_b64_tr_b16 a[216:217], v46 offset:40960
s_add_u32 m0, m0, 1024
v_mfma_f32_16x16x32_bf16 v[80:83], a[64:67], a[196:199], v[80:83]
ds_read_b64_tr_b16 a[218:219], v46 offset:45056
s_waitcnt lgkmcnt(8)
v_mfma_f32_16x16x32_bf16 v[84:87], a[196:199], a[196:199], v[84:87]
buffer_load_dwordx4 v10, s[4:7], s86 offen lds
v_mfma_f32_16x16x32_bf16 v[88:91], a[60:63], a[200:203], v[88:91]
ds_read_b64_tr_b16 a[220:221], v47 offset:40960
s_add_u32 m0, m0, 7168
v_mfma_f32_16x16x32_bf16 v[92:95], a[64:67], a[200:203], v[92:95]
ds_read_b64_tr_b16 a[222:223], v47 offset:45056
s_waitcnt lgkmcnt(8)
v_mfma_f32_16x16x32_bf16 v[96:99], a[200:203], a[200:203], v[96:99]
s_add_u32 s86, s86, 131072
v_add_f32 v230, v230, v234
v_mfma_f32_16x16x32_bf16 v[100:103], a[60:63], a[204:207], v[100:103]
ds_read_b64_tr_b16 a[192:193], v40 offset:49152
v_add_f32_e64 v231, v231, v235
v_mfma_f32_16x16x32_bf16 v[104:107], a[64:67], a[204:207], v[104:107]
ds_read_b64_tr_b16 a[194:195], v40 offset:53248
s_waitcnt lgkmcnt(8)
v_mfma_f32_16x16x32_bf16 v[108:111], a[204:207], a[204:207], v[108:111]
buffer_load_dwordx4 v9, s[4:7], s86 offen lds
v_mfma_f32_16x16x32_bf16 v[112:115], a[60:63], a[208:211], v[112:115]
ds_read_b64_tr_b16 a[196:197], v41 offset:49152
s_add_u32 m0, m0, 1024
v_mfma_f32_16x16x32_bf16 v[116:119], a[64:67], a[208:211], v[116:119]
ds_read_b64_tr_b16 a[198:199], v41 offset:53248
s_waitcnt lgkmcnt(8)
v_mfma_f32_16x16x32_bf16 v[120:123], a[208:211], a[208:211], v[120:123]
buffer_load_dwordx4 v10, s[4:7], s86 offen lds
v_mfma_f32_16x16x32_bf16 v[124:127], a[60:63], a[212:215], v[124:127]
ds_read_b64_tr_b16 a[200:201], v42 offset:49152
s_add_u32 m0, m0, 7168
v_mfma_f32_16x16x32_bf16 v[128:131], a[64:67], a[212:215], v[128:131]
ds_read_b64_tr_b16 a[202:203], v42 offset:53248
s_waitcnt lgkmcnt(8)
v_mfma_f32_16x16x32_bf16 v[132:135], a[212:215], a[212:215], v[132:135]
s_add_u32 s86, s86, 131072
v_add_f32 v236, v236, v240
v_mfma_f32_16x16x32_bf16 v[136:139], a[60:63], a[216:219], v[136:139]
ds_read_b64_tr_b16 a[204:205], v43 offset:49152
v_add_f32 v237, v237, v241
v_mfma_f32_16x16x32_bf16 v[140:143], a[64:67], a[216:219], v[140:143]
ds_read_b64_tr_b16 a[206:207], v43 offset:53248
s_waitcnt lgkmcnt(8)
v_mfma_f32_16x16x32_bf16 v[144:147], a[216:219], a[216:219], v[144:147]
buffer_load_dwordx4 v9, s[4:7], s86 offen lds
v_mfma_f32_16x16x32_bf16 v[148:151], a[60:63], a[220:223], v[148:151]
ds_read_b64_tr_b16 a[208:209], v44 offset:49152
s_add_u32 m0, m0, 1024
v_mfma_f32_16x16x32_bf16 v[152:155], a[64:67], a[220:223], v[152:155]
ds_read_b64_tr_b16 a[210:211], v44 offset:53248
s_waitcnt lgkmcnt(8)
v_mfma_f32_16x16x32_bf16 v[156:159], a[220:223], a[220:223], v[156:159]
buffer_load_dwordx4 v10, s[4:7], s86 offen lds
v_mfma_f32_16x16x32_bf16 v[64:67], a[72:75], a[192:195], v[64:67]
ds_read_b64_tr_b16 a[212:213], v45 offset:49152
s_add_u32 m0, m0, 7168
v_mfma_f32_16x16x32_bf16 v[68:71], a[76:79], a[192:195], v[68:71]
ds_read_b64_tr_b16 a[214:215], v45 offset:53248
s_waitcnt lgkmcnt(8)
v_mfma_f32_16x16x32_bf16 v[72:75], a[192:195], a[192:195], v[72:75]
s_add_u32 s86, s86, 131072
buffer_load_dwordx4 v9, s[4:7], s86 offen lds
v_mfma_f32_16x16x32_bf16 v[76:79], a[72:75], a[196:199], v[76:79]
ds_read_b64_tr_b16 a[216:217], v46 offset:49152
s_add_u32 m0, m0, 1024
v_mfma_f32_16x16x32_bf16 v[80:83], a[76:79], a[196:199], v[80:83]
ds_read_b64_tr_b16 a[218:219], v46 offset:53248
s_waitcnt lgkmcnt(8)
v_mfma_f32_16x16x32_bf16 v[84:87], a[196:199], a[196:199], v[84:87]
v_add_f32 v238, v238, v242
v_add_f32_e64 v239, v239, v243
v_mfma_f32_16x16x32_bf16 v[88:91], a[72:75], a[200:203], v[88:91]
ds_read_b64_tr_b16 a[220:221], v47 offset:49152
v_add_f32_e64 v224, v224, v252
v_mfma_f32_16x16x32_bf16 v[92:95], a[76:79], a[200:203], v[92:95]
ds_read_b64_tr_b16 a[222:223], v47 offset:53248
s_waitcnt lgkmcnt(8)
v_mfma_f32_16x16x32_bf16 v[96:99], a[200:203], a[200:203], v[96:99]
buffer_load_dwordx4 v10, s[4:7], s86 offen lds
v_mfma_f32_16x16x32_bf16 v[100:103], a[72:75], a[204:207], v[100:103]
ds_read_b64_tr_b16 a[192:193], v40 offset:57344
s_add_u32 m0, m0, 7168
v_mfma_f32_16x16x32_bf16 v[104:107], a[76:79], a[204:207], v[104:107]
ds_read_b64_tr_b16 a[194:195], v40 offset:61440
s_waitcnt lgkmcnt(8)
v_mfma_f32_16x16x32_bf16 v[108:111], a[204:207], a[204:207], v[108:111]
s_add_u32 s86, s86, 131072
buffer_load_dwordx4 v9, s[4:7], s86 offen lds
v_mfma_f32_16x16x32_bf16 v[112:115], a[72:75], a[208:211], v[112:115]
ds_read_b64_tr_b16 a[196:197], v41 offset:57344
s_add_u32 m0, m0, 1024
v_mfma_f32_16x16x32_bf16 v[116:119], a[76:79], a[208:211], v[116:119]
ds_read_b64_tr_b16 a[198:199], v41 offset:61440
s_waitcnt lgkmcnt(8)
v_mfma_f32_16x16x32_bf16 v[120:123], a[208:211], a[208:211], v[120:123]
v_permlane32_swap_b32 v228, v230
v_permlane32_swap_b32_e64 v229, v231
v_mfma_f32_16x16x32_bf16 v[124:127], a[72:75], a[212:215], v[124:127]
ds_read_b64_tr_b16 a[200:201], v42 offset:57344
v_permlane32_swap_b32 v236, v238
v_mfma_f32_16x16x32_bf16 v[128:131], a[76:79], a[212:215], v[128:131]
ds_read_b64_tr_b16 a[202:203], v42 offset:61440
s_waitcnt lgkmcnt(8)
v_mfma_f32_16x16x32_bf16 v[132:135], a[212:215], a[212:215], v[132:135]
buffer_load_dwordx4 v10, s[4:7], s86 offen lds
v_mfma_f32_16x16x32_bf16 v[136:139], a[72:75], a[216:219], v[136:139]
ds_read_b64_tr_b16 a[204:205], v43 offset:57344
s_add_u32 m0, m0, 7168
v_mfma_f32_16x16x32_bf16 v[140:143], a[76:79], a[216:219], v[140:143]
ds_read_b64_tr_b16 a[206:207], v43 offset:61440
s_waitcnt lgkmcnt(8)
v_mfma_f32_16x16x32_bf16 v[144:147], a[216:219], a[216:219], v[144:147]
s_add_u32 s86, s86, 131072
buffer_load_dwordx4 v9, s[4:7], s86 offen lds
v_mfma_f32_16x16x32_bf16 v[148:151], a[72:75], a[220:223], v[148:151]
ds_read_b64_tr_b16 a[208:209], v44 offset:57344
s_add_u32 m0, m0, 1024
v_mfma_f32_16x16x32_bf16 v[152:155], a[76:79], a[220:223], v[152:155]
ds_read_b64_tr_b16 a[210:211], v44 offset:61440
s_waitcnt lgkmcnt(8)
v_mfma_f32_16x16x32_bf16 v[156:159], a[220:223], a[220:223], v[156:159]
buffer_load_dwordx4 v10, s[4:7], s86 offen lds
v_mfma_f32_16x16x32_bf16 v[64:67], a[84:87], a[192:195], v[64:67]
ds_read_b64_tr_b16 a[212:213], v45 offset:57344
s_add_u32 m0, m0, 7168
v_mfma_f32_16x16x32_bf16 v[68:71], a[88:91], a[192:195], v[68:71]
ds_read_b64_tr_b16 a[214:215], v45 offset:61440
s_waitcnt lgkmcnt(8)
v_mfma_f32_16x16x32_bf16 v[72:75], a[192:195], a[192:195], v[72:75]
s_add_u32 s86, s86, 131072
v_permlane32_swap_b32 v237, v239
v_mfma_f32_16x16x32_bf16 v[76:79], a[84:87], a[196:199], v[76:79]
ds_read_b64_tr_b16 a[216:217], v46 offset:57344
v_add_f32 v228, v228, v230
v_mfma_f32_16x16x32_bf16 v[80:83], a[88:91], a[196:199], v[80:83]
ds_read_b64_tr_b16 a[218:219], v46 offset:61440
s_waitcnt lgkmcnt(8)
v_mfma_f32_16x16x32_bf16 v[84:87], a[196:199], a[196:199], v[84:87]
buffer_load_dwordx4 a[148:151], v55, s[4:7], s81 offen
v_mfma_f32_16x16x32_bf16 v[88:91], a[84:87], a[200:203], v[88:91]
ds_read_b64_tr_b16 a[220:221], v47 offset:57344
s_add_u32 s81, s81, 1024
v_mfma_f32_16x16x32_bf16 v[92:95], a[88:91], a[200:203], v[92:95]
ds_read_b64_tr_b16 a[222:223], v47 offset:61440
s_waitcnt lgkmcnt(8)
v_mfma_f32_16x16x32_bf16 v[96:99], a[200:203], a[200:203], v[96:99]
s_waitcnt vmcnt(13)
s_barrier
v_mfma_f32_16x16x32_bf16 v[100:103], a[84:87], a[204:207], v[100:103]
v_add_u32 v40, 0x10000, v40
ds_read_b64_tr_b16 a[192:193], v40 offset:0
v_mfma_f32_16x16x32_bf16 v[104:107], a[88:91], a[204:207], v[104:107]
ds_read_b64_tr_b16 a[194:195], v40 offset:4096
s_waitcnt lgkmcnt(8)
v_mfma_f32_16x16x32_bf16 v[108:111], a[204:207], a[204:207], v[108:111]
buffer_load_dwordx4 a[156:159], v13, s[4:7], s81 offen
v_mfma_f32_16x16x32_bf16 v[112:115], a[84:87], a[208:211], v[112:115]
v_add_u32 v41, 0x10000, v41
ds_read_b64_tr_b16 a[196:197], v41 offset:0
v_mfma_f32_16x16x32_bf16 v[116:119], a[88:91], a[208:211], v[116:119]
ds_read_b64_tr_b16 a[198:199], v41 offset:4096
s_waitcnt lgkmcnt(8)
v_mfma_f32_16x16x32_bf16 v[120:123], a[208:211], a[208:211], v[120:123]
buffer_load_dwordx4 a[160:163], v55, s[4:7], s81 offen
v_mfma_f32_16x16x32_bf16 v[124:127], a[84:87], a[212:215], v[124:127]
v_add_u32 v42, 0x10000, v42
ds_read_b64_tr_b16 a[200:201], v42 offset:0
v_mfma_f32_16x16x32_bf16 v[128:131], a[88:91], a[212:215], v[128:131]
ds_read_b64_tr_b16 a[202:203], v42 offset:4096
s_waitcnt lgkmcnt(8)
v_mfma_f32_16x16x32_bf16 v[132:135], a[212:215], a[212:215], v[132:135]
s_add_u32 s81, s81, 1024
buffer_load_dwordx4 a[168:171], v13, s[4:7], s81 offen
v_mfma_f32_16x16x32_bf16 v[136:139], a[84:87], a[216:219], v[136:139]
v_add_u32 v43, 0x10000, v43
ds_read_b64_tr_b16 a[204:205], v43 offset:0
v_mfma_f32_16x16x32_bf16 v[140:143], a[88:91], a[216:219], v[140:143]
ds_read_b64_tr_b16 a[206:207], v43 offset:4096
s_waitcnt lgkmcnt(8)
v_mfma_f32_16x16x32_bf16 v[144:147], a[216:219], a[216:219], v[144:147]
buffer_load_dwordx4 a[172:175], v55, s[4:7], s81 offen
v_mfma_f32_16x16x32_bf16 v[148:151], a[84:87], a[220:223], v[148:151]
v_add_u32 v44, 0x10000, v44
ds_read_b64_tr_b16 a[208:209], v44 offset:0
v_mfma_f32_16x16x32_bf16 v[152:155], a[88:91], a[220:223], v[152:155]
ds_read_b64_tr_b16 a[210:211], v44 offset:4096
s_waitcnt lgkmcnt(8)
v_mfma_f32_16x16x32_bf16 v[156:159], a[220:223], a[220:223], v[156:159]
s_add_u32 s81, s81, 1024
v_add_f32_e64 v229, v229, v231
v_mfma_f32_16x16x32_bf16 v[64:67], a[96:99], a[192:195], v[64:67]
v_add_u32 v45, 0x10000, v45
ds_read_b64_tr_b16 a[212:213], v45 offset:0
v_mfma_f32_16x16x32_bf16 v[68:71], a[100:103], a[192:195], v[68:71]
ds_read_b64_tr_b16 a[214:215], v45 offset:4096
s_waitcnt lgkmcnt(8)
v_mfma_f32_16x16x32_bf16 v[72:75], a[192:195], a[192:195], v[72:75]
buffer_load_dwordx4 a[180:183], v13, s[4:7], s81 offen
v_mfma_f32_16x16x32_bf16 v[76:79], a[96:99], a[196:199], v[76:79]
L_pad_c_1:
s_cbranch_execz L_pad_c_2
v_add_u32 v46, 0x10000, v46
ds_read_b64_tr_b16 a[216:217], v46 offset:0
v_mfma_f32_16x16x32_bf16 v[80:83], a[100:103], a[196:199], v[80:83]
ds_read_b64_tr_b16 a[218:219], v46 offset:4096
s_waitcnt lgkmcnt(8)
v_mfma_f32_16x16x32_bf16 v[84:87], a[196:199], a[196:199], v[84:87]
buffer_load_dwordx4 a[184:187], v55, s[4:7], s81 offen
v_mfma_f32_16x16x32_bf16 v[88:91], a[96:99], a[200:203], v[88:91]
v_add_u32 v47, 0x10000, v47
ds_read_b64_tr_b16 a[220:221], v47 offset:0
v_mfma_f32_16x16x32_bf16 v[92:95], a[100:103], a[200:203], v[92:95]
ds_read_b64_tr_b16 a[222:223], v47 offset:4096
s_waitcnt lgkmcnt(8)
v_mfma_f32_16x16x32_bf16 v[96:99], a[200:203], a[200:203], v[96:99]
s_add_u32 s81, s81, 1024
v_add_f32 v236, v236, v238
v_mfma_f32_16x16x32_bf16 v[100:103], a[96:99], a[204:207], v[100:103]
ds_read_b64_tr_b16 a[192:193], v40 offset:8192
v_add_f32 v237, v237, v239
v_mfma_f32_16x16x32_bf16 v[104:107], a[100:103], a[204:207], v[104:107]
ds_read_b64_tr_b16 a[194:195], v40 offset:12288
s_waitcnt lgkmcnt(8)
v_mfma_f32_16x16x32_bf16 v[108:111], a[204:207], a[204:207], v[108:111]
buffer_load_dwordx4 a[224:227], v2, s[4:7], s85 offen offset:0
v_mfma_f32_16x16x32_bf16 v[112:115], a[96:99], a[208:211], v[112:115]
ds_read_b64_tr_b16 a[196:197], v41 offset:8192
v_add_f32_dpp v224, v224, v224 row_ror:8 row_mask:0xf bank_mask:0xf
v_mfma_f32_16x16x32_bf16 v[116:119], a[100:103], a[208:211], v[116:119]
ds_read_b64_tr_b16 a[198:199], v41 offset:12288
s_waitcnt lgkmcnt(8)
v_mfma_f32_16x16x32_bf16 v[120:123], a[208:211], a[208:211], v[120:123]
buffer_load_dwordx4 a[228:231], v2, s[4:7], s85 offen offset:1024
v_mfma_f32_16x16x32_bf16 v[124:127], a[96:99], a[212:215], v[124:127]
ds_read_b64_tr_b16 a[200:201], v42 offset:8192
v_permlane16_swap_b32 v228, v229
v_mfma_f32_16x16x32_bf16 v[128:131], a[100:103], a[212:215], v[128:131]
ds_read_b64_tr_b16 a[202:203], v42 offset:12288
s_waitcnt lgkmcnt(8)
v_mfma_f32_16x16x32_bf16 v[132:135], a[212:215], a[212:215], v[132:135]
buffer_load_dwordx4 a[232:235], v2, s[4:7], s85 offen offset:2048
v_mfma_f32_16x16x32_bf16 v[136:139], a[96:99], a[216:219], v[136:139]
ds_read_b64_tr_b16 a[204:205], v43 offset:8192
v_permlane16_swap_b32_e64 v236, v237
v_mfma_f32_16x16x32_bf16 v[140:143], a[100:103], a[216:219], v[140:143]
ds_read_b64_tr_b16 a[206:207], v43 offset:12288
s_waitcnt lgkmcnt(8)
v_mfma_f32_16x16x32_bf16 v[144:147], a[216:219], a[216:219], v[144:147]
s_waitcnt vmcnt(10)
s_barrier
v_mfma_f32_16x16x32_bf16 v[148:151], a[96:99], a[220:223], v[148:151]
ds_read_b64_tr_b16 a[208:209], v40 offset:16384
v_add_f32 v228, v228, v229
v_mfma_f32_16x16x32_bf16 v[152:155], a[100:103], a[220:223], v[152:155]
ds_read_b64_tr_b16 a[210:211], v40 offset:20480
s_waitcnt lgkmcnt(8)
v_mfma_f32_16x16x32_bf16 v[156:159], a[220:223], a[220:223], v[156:159]
buffer_load_dwordx4 a[236:239], v2, s[4:7], s85 offen offset:3072
v_mfma_f32_16x16x32_bf16 v[64:67], a[108:111], a[192:195], v[64:67]
ds_read_b64_tr_b16 a[212:213], v41 offset:16384
s_add_u32 s85, s85, 4096
v_mfma_f32_16x16x32_bf16 v[68:71], a[112:115], a[192:195], v[68:71]
ds_read_b64_tr_b16 a[214:215], v41 offset:20480
s_waitcnt lgkmcnt(8)
v_mfma_f32_16x16x32_bf16 v[72:75], a[192:195], a[192:195], v[72:75]
buffer_load_dwordx4 a[240:243], v2, s[4:7], s85 offen offset:0
v_mfma_f32_16x16x32_bf16 v[76:79], a[108:111], a[196:199], v[76:79]
ds_read_b64_tr_b16 a[216:217], v42 offset:16384
v_add_f32 v236, v236, v237
v_mfma_f32_16x16x32_bf16 v[80:83], a[112:115], a[196:199], v[80:83]
ds_read_b64_tr_b16 a[218:219], v42 offset:20480
s_waitcnt lgkmcnt(8)
v_mfma_f32_16x16x32_bf16 v[84:87], a[196:199], a[196:199], v[84:87]
v_cvt_pk_bf16_f32 v11, v224, v224
v_add_f32_dpp v228, v228, v228 row_ror:8 row_mask:0xf bank_mask:0xf
v_mfma_f32_16x16x32_bf16 v[88:91], a[108:111], a[200:203], v[88:91]
ds_read_b64_tr_b16 a[220:221], v43 offset:16384
v_add_f32_dpp v236, v236, v236 row_ror:8 row_mask:0xf bank_mask:0xf
v_mfma_f32_16x16x32_bf16 v[92:95], a[112:115], a[200:203], v[92:95]
ds_read_b64_tr_b16 a[222:223], v43 offset:20480
s_waitcnt lgkmcnt(8)
v_mfma_f32_16x16x32_bf16 v[96:99], a[200:203], a[200:203], v[96:99]
buffer_load_dwordx4 a[244:247], v2, s[4:7], s85 offen offset:1024
v_mfma_f32_16x16x32_bf16 v[100:103], a[108:111], a[204:207], v[100:103]
ds_read_b64_tr_b16 a[192:193], v40 offset:24576
v_mul_f32_e64 v228, v228, v63
v_mfma_f32_16x16x32_bf16 v[104:107], a[112:115], a[204:207], v[104:107]
ds_read_b64_tr_b16 a[194:195], v40 offset:28672
s_waitcnt lgkmcnt(8)
v_mfma_f32_16x16x32_bf16 v[108:111], a[204:207], a[204:207], v[108:111]
buffer_load_dwordx4 a[248:251], v2, s[4:7], s85 offen offset:2048
v_mfma_f32_16x16x32_bf16 v[64:67], a[120:123], a[208:211], v[64:67]
ds_read_b64_tr_b16 a[196:197], v41 offset:24576
v_mul_f32 v236, v236, v63
v_mfma_f32_16x16x32_bf16 v[68:71], a[124:127], a[208:211], v[68:71]
ds_read_b64_tr_b16 a[198:199], v41 offset:28672
s_waitcnt lgkmcnt(8)
v_mfma_f32_16x16x32_bf16 v[72:75], a[208:211], a[208:211], v[72:75]
buffer_load_dwordx4 a[252:255], v2, s[4:7], s85 offen offset:3072
v_mfma_f32_16x16x32_bf16 v[76:79], a[120:123], a[212:215], v[76:79]
ds_read_b64_tr_b16 a[200:201], v42 offset:24576
s_add_u32 s85, s85, 4096
v_mfma_f32_16x16x32_bf16 v[80:83], a[124:127], a[212:215], v[80:83]
ds_read_b64_tr_b16 a[202:203], v42 offset:28672
s_waitcnt lgkmcnt(8)
v_mfma_f32_16x16x32_bf16 v[84:87], a[212:215], a[212:215], v[84:87]
ds_write_b32 v56, v228 offset:0
ds_write_b32 v56, v236 offset:128
v_mfma_f32_16x16x32_bf16 v[88:91], a[120:123], a[216:219], v[88:91]
ds_read_b64_tr_b16 a[204:205], v43 offset:24576
ds_read_b128 v[16:19], v12 offset:0
v_mfma_f32_16x16x32_bf16 v[92:95], a[124:127], a[216:219], v[92:95]
ds_read_b64_tr_b16 a[206:207], v43 offset:28672
s_waitcnt lgkmcnt(11)
v_mfma_f32_16x16x32_bf16 v[96:99], a[216:219], a[216:219], v[96:99]
buffer_load_dwordx4 v[160:163], v2, s[4:7], s85 offen offset:0
v_mfma_f32_16x16x32_bf16 v[100:103], a[120:123], a[220:223], v[100:103]
ds_read_b64_tr_b16 a[208:209], v40 offset:32768
ds_read_b128 v[28:31], v12 offset:64
v_mfma_f32_16x16x32_bf16 v[104:107], a[124:127], a[220:223], v[104:107]
ds_read_b64_tr_b16 a[210:211], v40 offset:36864
s_waitcnt lgkmcnt(12)
v_mfma_f32_16x16x32_bf16 v[108:111], a[220:223], a[220:223], v[108:111]
buffer_load_dwordx4 v[164:167], v2, s[4:7], s85 offen offset:1024
v_mfma_f32_16x16x32_bf16 v[64:67], a[132:135], a[192:195], v[64:67]
ds_read_b64_tr_b16 a[212:213], v41 offset:32768
ds_read_b128 v[20:23], v12 offset:128
v_mfma_f32_16x16x32_bf16 v[68:71], a[136:139], a[192:195], v[68:71]
ds_read_b64_tr_b16 a[214:215], v41 offset:36864
s_waitcnt lgkmcnt(13)
v_mfma_f32_16x16x32_bf16 v[72:75], a[192:195], a[192:195], v[72:75]
ds_read_b128 v[32:35], v12 offset:192
ds_read_b64_tr_b16 v[48:49], v59 offset:0
v_mfma_f32_16x16x32_bf16 v[76:79], a[132:135], a[196:199], v[76:79]
ds_read_b64_tr_b16 a[216:217], v42 offset:32768
ds_read_b64_tr_b16 v[50:51], v60 offset:1024
v_mfma_f32_16x16x32_bf16 v[80:83], a[136:139], a[196:199], v[80:83]
ds_read_b64_tr_b16 a[218:219], v42 offset:36864
s_waitcnt lgkmcnt(15)
v_mfma_f32_16x16x32_bf16 v[84:87], a[196:199], a[196:199], v[84:87]
buffer_load_dwordx4 v[168:171], v2, s[4:7], s85 offen offset:2048
v_mfma_f32_16x16x32_bf16 v[88:91], a[132:135], a[200:203], v[88:91]
ds_read_b64_tr_b16 a[220:221], v43 offset:32768
ds_read_b64_tr_b16 v[52:53], v60 offset:0
v_mfma_f32_16x16x32_bf16 v[92:95], a[136:139], a[200:203], v[92:95]
ds_read_b64_tr_b16 a[222:223], v43 offset:36864
s_waitcnt lgkmcnt(14)
v_mfma_f32_16x16x32_bf16 v[96:99], a[200:203], a[200:203], v[96:99]
buffer_load_dwordx4 v[172:175], v2, s[4:7], s85 offen offset:3072
v_mfma_f32_16x16x32_bf16 v[100:103], a[132:135], a[204:207], v[100:103]
ds_read_b64_tr_b16 a[192:193], v40 offset:40960
s_add_u32 s85, s85, 4096
v_mfma_f32_16x16x32_bf16 v[104:107], a[136:139], a[204:207], v[104:107]
ds_read_b64_tr_b16 a[194:195], v40 offset:45056
s_waitcnt lgkmcnt(13)
v_mfma_f32_16x16x32_bf16 v[108:111], a[204:207], a[204:207], v[108:111]
s_waitcnt vmcnt(18)
buffer_load_dwordx4 v[176:179], v2, s[4:7], s85 offen offset:0
v_mfma_f32_16x16x32_bf16 v[64:67], a[144:147], a[208:211], v[64:67]
ds_read_b64_tr_b16 a[196:197], v41 offset:40960
ds_read_b64_tr_b16 v[54:55], v59 offset:1024
v_mfma_f32_16x16x32_bf16 v[68:71], a[148:151], a[208:211], v[68:71]
ds_read_b64_tr_b16 a[198:199], v41 offset:45056
s_waitcnt lgkmcnt(13)
v_mfma_f32_16x16x32_bf16 v[72:75], a[208:211], a[208:211], v[72:75]
v_mfma_f32_16x16x32_bf16 v[76:79], a[144:147], a[212:215], v[76:79]
ds_read_b64_tr_b16 a[200:201], v42 offset:40960
v_mfma_f32_16x16x32_bf16 v[80:83], a[148:151], a[212:215], v[80:83]
ds_read_b64_tr_b16 a[202:203], v42 offset:45056
s_waitcnt lgkmcnt(10)
v_mfma_f32_16x16x32_bf16 v[84:87], a[212:215], a[212:215], v[84:87]
buffer_load_dwordx4 v[180:183], v2, s[4:7], s85 offen offset:1024
v_mfma_f32_16x16x32_bf16 v[88:91], a[144:147], a[216:219], v[88:91]
ds_read_b64_tr_b16 a[204:205], v43 offset:40960
v_mfma_f32_16x16x32_bf16 v[92:95], a[148:151], a[216:219], v[92:95]
ds_read_b64_tr_b16 a[206:207], v43 offset:45056
s_waitcnt lgkmcnt(9)
v_mfma_f32_16x16x32_bf16 v[96:99], a[216:219], a[216:219], v[96:99]
buffer_load_dwordx4 v[184:187], v2, s[4:7], s85 offen offset:2048
v_mfma_f32_16x16x32_bf16 v[100:103], a[144:147], a[220:223], v[100:103]
ds_read_b64_tr_b16 a[208:209], v40 offset:49152
v_mfma_f32_16x16x32_bf16 v[104:107], a[148:151], a[220:223], v[104:107]
ds_read_b64_tr_b16 a[210:211], v40 offset:53248
s_waitcnt lgkmcnt(9)
v_mfma_f32_16x16x32_bf16 v[108:111], a[220:223], a[220:223], v[108:111]
s_waitcnt vmcnt(19)
v_mfma_f32_16x16x32_bf16 v[64:67], a[156:159], a[192:195], v[64:67]
ds_read_b64_tr_b16 a[212:213], v41 offset:49152
v_mfma_f32_16x16x32_bf16 v[68:71], a[160:163], a[192:195], v[68:71]
ds_read_b64_tr_b16 a[214:215], v41 offset:53248
s_waitcnt lgkmcnt(8)
v_mfma_f32_16x16x32_bf16 v[72:75], a[192:195], a[192:195], v[72:75]
buffer_load_dwordx4 v[188:191], v2, s[4:7], s85 offen offset:3072
v_mfma_f32_16x16x32_bf16 v[76:79], a[156:159], a[196:199], v[76:79]
ds_read_b64_tr_b16 a[216:217], v42 offset:49152
s_add_u32 s85, s85, 4096
v_mfma_f32_16x16x32_bf16 v[80:83], a[160:163], a[196:199], v[80:83]
ds_read_b64_tr_b16 a[218:219], v42 offset:53248
s_waitcnt lgkmcnt(8)
v_mfma_f32_16x16x32_bf16 v[84:87], a[196:199], a[196:199], v[84:87]
buffer_load_dwordx4 v[192:195], v2, s[4:7], s85 offen offset:0
v_mfma_f32_16x16x32_bf16 v[88:91], a[156:159], a[200:203], v[88:91]
ds_read_b64_tr_b16 a[220:221], v43 offset:49152
v_mfma_f32_16x16x32_bf16 v[92:95], a[160:163], a[200:203], v[92:95]
ds_read_b64_tr_b16 a[222:223], v43 offset:53248
s_waitcnt lgkmcnt(8)
v_mfma_f32_16x16x32_bf16 v[96:99], a[200:203], a[200:203], v[96:99]
buffer_load_dwordx4 v[196:199], v2, s[4:7], s85 offen offset:1024
v_mfma_f32_16x16x32_bf16 v[100:103], a[156:159], a[204:207], v[100:103]
ds_read_b64_tr_b16 a[192:193], v40 offset:57344
v_mfma_f32_16x16x32_bf16 v[104:107], a[160:163], a[204:207], v[104:107]
ds_read_b64_tr_b16 a[194:195], v40 offset:61440
s_waitcnt lgkmcnt(8)
v_mfma_f32_16x16x32_bf16 v[108:111], a[204:207], a[204:207], v[108:111]
s_waitcnt vmcnt(20)
v_mfma_f32_16x16x32_bf16 v[64:67], a[168:171], a[208:211], v[64:67]
ds_read_b64_tr_b16 a[196:197], v41 offset:57344
v_mfma_f32_16x16x32_bf16 v[68:71], a[172:175], a[208:211], v[68:71]
ds_read_b64_tr_b16 a[198:199], v41 offset:61440
s_waitcnt lgkmcnt(8)
v_mfma_f32_16x16x32_bf16 v[72:75], a[208:211], a[208:211], v[72:75]
buffer_load_dwordx4 v[200:203], v2, s[4:7], s85 offen offset:2048
v_mfma_f32_16x16x32_bf16 v[76:79], a[168:171], a[212:215], v[76:79]
ds_read_b64_tr_b16 a[200:201], v42 offset:57344
v_mfma_f32_16x16x32_bf16 v[80:83], a[172:175], a[212:215], v[80:83]
ds_read_b64_tr_b16 a[202:203], v42 offset:61440
s_waitcnt lgkmcnt(8)
v_mfma_f32_16x16x32_bf16 v[84:87], a[212:215], a[212:215], v[84:87]
buffer_load_dwordx4 v[204:207], v2, s[4:7], s85 offen offset:3072
v_mfma_f32_16x16x32_bf16 v[88:91], a[168:171], a[216:219], v[88:91]
ds_read_b64_tr_b16 a[204:205], v43 offset:57344
s_add_u32 s85, s85, 4096
v_mfma_f32_16x16x32_bf16 v[92:95], a[172:175], a[216:219], v[92:95]
ds_read_b64_tr_b16 a[206:207], v43 offset:61440
s_waitcnt lgkmcnt(8)
v_mfma_f32_16x16x32_bf16 v[96:99], a[216:219], a[216:219], v[96:99]
v_mfma_f32_16x16x32_bf16 v[100:103], a[168:171], a[220:223], v[100:103]
ds_read_b64_tr_b16 a[208:209], v44 offset:8192
v_mfma_f32_16x16x32_bf16 v[104:107], a[172:175], a[220:223], v[104:107]
ds_read_b64_tr_b16 a[210:211], v44 offset:12288
s_waitcnt lgkmcnt(8)
v_mfma_f32_16x16x32_bf16 v[108:111], a[220:223], a[220:223], v[108:111]
s_waitcnt vmcnt(20)
buffer_load_dwordx4 v[208:211], v2, s[4:7], s85 offen offset:0
v_mfma_f32_16x16x32_bf16 v[64:67], a[180:183], a[192:195], v[64:67]
ds_read_b64_tr_b16 a[212:213], v45 offset:8192
v_mfma_f32_16x16x32_bf16 v[68:71], a[184:187], a[192:195], v[68:71]
ds_read_b64_tr_b16 a[214:215], v45 offset:12288
s_waitcnt lgkmcnt(8)
v_mfma_f32_16x16x32_bf16 v[72:75], a[192:195], a[192:195], v[72:75]
buffer_load_dwordx4 v[212:215], v2, s[4:7], s85 offen offset:1024
v_mfma_f32_16x16x32_bf16 v[76:79], a[180:183], a[196:199], v[76:79]
ds_read_b64_tr_b16 a[216:217], v46 offset:8192
v_mfma_f32_16x16x32_bf16 v[80:83], a[184:187], a[196:199], v[80:83]
ds_read_b64_tr_b16 a[218:219], v46 offset:12288
s_waitcnt lgkmcnt(8)
v_mfma_f32_16x16x32_bf16 v[84:87], a[196:199], a[196:199], v[84:87]
v_mfma_f32_16x16x32_bf16 v[88:91], a[180:183], a[200:203], v[88:91]
ds_read_b64_tr_b16 a[220:221], v47 offset:8192
v_cndmask_b32 v72, 0, v72, s[40:41]
v_mfma_f32_16x16x32_bf16 v[92:95], a[184:187], a[200:203], v[92:95]
ds_read_b64_tr_b16 a[222:223], v47 offset:12288
s_waitcnt lgkmcnt(8)
v_mfma_f32_16x16x32_bf16 v[96:99], a[200:203], a[200:203], v[96:99]
v_cndmask_b32 v72, v72, v73, s[42:43]
v_cndmask_b32 v72, v72, v74, s[44:45]
v_mfma_f32_16x16x32_bf16 v[100:103], a[180:183], a[204:207], v[100:103]
ds_read_b64_tr_b16 a[192:193], v44 offset:16384
v_cndmask_b32 v72, v72, v75, s[46:47]
v_mfma_f32_16x16x32_bf16 v[104:107], a[184:187], a[204:207], v[104:107]
ds_read_b64_tr_b16 a[194:195], v44 offset:20480
s_waitcnt lgkmcnt(8)
v_mfma_f32_16x16x32_bf16 v[108:111], a[204:207], a[204:207], v[108:111]
v_mov_b32 v73, v68
v_cndmask_b32 v84, 0, v84, s[40:41]
v_mfma_f32_16x16x32_bf16 v[112:115], a[108:111], a[208:211], v[112:115]
ds_read_b64_tr_b16 a[196:197], v45 offset:16384
v_cndmask_b32 v84, v84, v85, s[42:43]
v_mfma_f32_16x16x32_bf16 v[116:119], a[112:115], a[208:211], v[116:119]
ds_read_b64_tr_b16 a[198:199], v45 offset:20480
s_waitcnt lgkmcnt(8)
v_mfma_f32_16x16x32_bf16 v[120:123], a[208:211], a[208:211], v[120:123]
v_cndmask_b32 v84, v84, v86, s[44:45]
v_cndmask_b32 v84, v84, v87, s[46:47]
v_mfma_f32_16x16x32_bf16 v[124:127], a[108:111], a[212:215], v[124:127]
ds_read_b64_tr_b16 a[200:201], v46 offset:16384
v_mov_b32_e64 v85, v80
v_mfma_f32_16x16x32_bf16 v[128:131], a[112:115], a[212:215], v[128:131]
ds_read_b64_tr_b16 a[202:203], v46 offset:20480
s_waitcnt lgkmcnt(8)
v_mfma_f32_16x16x32_bf16 v[132:135], a[212:215], a[212:215], v[132:135]
v_cndmask_b32 v96, 0, v96, s[40:41]
v_cndmask_b32 v96, v96, v97, s[42:43]
v_mfma_f32_16x16x32_bf16 v[136:139], a[108:111], a[216:219], v[136:139]
ds_read_b64_tr_b16 a[204:205], v47 offset:16384
v_cndmask_b32 v96, v96, v98, s[44:45]
v_mfma_f32_16x16x32_bf16 v[140:143], a[112:115], a[216:219], v[140:143]
ds_read_b64_tr_b16 a[206:207], v47 offset:20480
s_waitcnt lgkmcnt(8)
v_mfma_f32_16x16x32_bf16 v[144:147], a[216:219], a[216:219], v[144:147]
v_cndmask_b32 v96, v96, v99, s[46:47]
v_mov_b32 v97, v92
v_mfma_f32_16x16x32_bf16 v[148:151], a[108:111], a[220:223], v[148:151]
ds_read_b64_tr_b16 a[208:209], v44 offset:24576
v_cndmask_b32 v108, 0, v108, s[40:41]
v_mfma_f32_16x16x32_bf16 v[152:155], a[112:115], a[220:223], v[152:155]
ds_read_b64_tr_b16 a[210:211], v44 offset:28672
s_waitcnt lgkmcnt(8)
v_mfma_f32_16x16x32_bf16 v[156:159], a[220:223], a[220:223], v[156:159]
v_cndmask_b32 v108, v108, v109, s[42:43]
v_cndmask_b32 v108, v108, v110, s[44:45]
v_mfma_f32_16x16x32_bf16 v[112:115], a[120:123], a[192:195], v[112:115]
ds_read_b64_tr_b16 a[212:213], v45 offset:24576
v_cndmask_b32 v108, v108, v111, s[46:47]
v_mfma_f32_16x16x32_bf16 v[116:119], a[124:127], a[192:195], v[116:119]
ds_read_b64_tr_b16 a[214:215], v45 offset:28672
s_waitcnt lgkmcnt(8)
v_mfma_f32_16x16x32_bf16 v[120:123], a[192:195], a[192:195], v[120:123]
v_mov_b32 v109, v104
v_permlane32_swap_b32 v72, v96
v_mfma_f32_16x16x32_bf16 v[124:127], a[120:123], a[196:199], v[124:127]
ds_read_b64_tr_b16 a[216:217], v46 offset:24576
v_permlane32_swap_b32_e64 v73, v97
v_mfma_f32_16x16x32_bf16 v[128:131], a[124:127], a[196:199], v[128:131]
ds_read_b64_tr_b16 a[218:219], v46 offset:28672
s_waitcnt lgkmcnt(8)
v_mfma_f32_16x16x32_bf16 v[132:135], a[196:199], a[196:199], v[132:135]
v_permlane32_swap_b32 v84, v108
v_permlane32_swap_b32_e64 v85, v109
v_mfma_f32_16x16x32_bf16 v[136:139], a[120:123], a[200:203], v[136:139]
ds_read_b64_tr_b16 a[220:221], v47 offset:24576
v_add_f32_e64 v72, v72, v96
v_mfma_f32_16x16x32_bf16 v[140:143], a[124:127], a[200:203], v[140:143]
ds_read_b64_tr_b16 a[222:223], v47 offset:28672
s_waitcnt lgkmcnt(8)
v_mfma_f32_16x16x32_bf16 v[144:147], a[200:203], a[200:203], v[144:147]
v_add_f32 v84, v84, v108
v_permlane16_swap_b32_e64 v97, v109
v_mfma_f32_16x16x32_bf16 v[148:151], a[120:123], a[204:207], v[148:151]
ds_read_b64_tr_b16 a[192:193], v44 offset:32768
v_mov_b32 v59, 0x3727c5ac
v_mfma_f32_16x16x32_bf16 v[152:155], a[124:127], a[204:207], v[152:155]
ds_read_b64_tr_b16 a[194:195], v44 offset:36864
s_waitcnt lgkmcnt(8)
v_mfma_f32_16x16x32_bf16 v[156:159], a[204:207], a[204:207], v[156:159]
v_permlane16_swap_b32 v72, v84
v_mul_f32 v109, s48, v109
v_add_f32 v72, v72, v84
v_fma_f32 v72, v72, s49, v59
v_fma_f32 v72, -v109, v109, v72
v_max_f32 v72, v72, v59
v_rsq_f32 v57, v72
v_add_u32 v6, 132864, v2
v_mul_f32 v56, 0xbfb8aa3b, v57
v_mul_f32_e64 v58, v109, v57
ds_write_b128 v6, v[56:59] offset:0
s_waitcnt lgkmcnt(0)
s_barrier
ds_read_b128 v[224:227], v7 offset:0
ds_read_b128 v[228:231], v7 offset:256
ds_read_b128 v[232:235], v7 offset:512
ds_read_b128 v[236:239], v7 offset:768
v_mov_b32 v13, 1073741824
v_cmp_eq_u32 vcc, 0, v1
v_subrev_u32 v14, 192, v0
v_lshlrev_b32 v10, 7, v1
v_cndmask_b32 v9, v13, 0, vcc
v_cmp_gt_u32 vcc, 4, v14
v_mov_b32 v12, 1
v_and_b32 v11, 0xffff0000, v11
v_cndmask_b32_e64 v10, v13, v10, vcc
v_cndmask_b32 v14, 0, 16, vcc
s_waitcnt lgkmcnt(3)
v_pk_fma_f32 v[56:57], v[226:227], v[16:17], v[28:29] op_sel:[0,0,0] op_sel_hi:[0,1,1] neg_lo:[1,0,0] neg_hi:[1,0,0]
v_pk_fma_f32 v[58:59], v[226:227], v[18:19], v[30:31] op_sel:[0,0,0] op_sel_hi:[0,1,1] neg_lo:[1,0,0] neg_hi:[1,0,0]
v_pk_fma_f32 v[56:57], v[224:225], v[64:65], v[56:57] op_sel:[0,0,0] op_sel_hi:[0,1,1]
v_exp_f32 v56, v56
v_exp_f32 v57, v57
v_pk_fma_f32 v[58:59], v[224:225], v[66:67], v[58:59] op_sel:[1,0,0] op_sel_hi:[1,1,1]
v_pk_add_f32 v[56:57], v[56:57], 1.0 op_sel_hi:[1,0]
v_rcp_f32 v56, v56
v_rcp_f32_e64 v57, v57
s_waitcnt lgkmcnt(2)
v_pk_fma_f32 v[60:61], v[230:231], v[16:17], v[28:29] op_sel:[0,0,0] op_sel_hi:[0,1,1] neg_lo:[1,0,0] neg_hi:[1,0,0]
v_pk_mul_f32 v[56:57], v[56:57], v[58:59]
v_cvt_pk_bf16_f32 v64, v56, v57
v_pk_fma_f32 v[62:63], v[230:231], v[18:19], v[30:31] op_sel:[0,0,0] op_sel_hi:[0,1,1] neg_lo:[1,0,0] neg_hi:[1,0,0]
v_pk_fma_f32 v[60:61], v[228:229], v[76:77], v[60:61] op_sel:[0,0,0] op_sel_hi:[0,1,1]
v_exp_f32 v60, v60
v_exp_f32 v61, v61
v_pk_fma_f32 v[62:63], v[228:229], v[78:79], v[62:63] op_sel:[1,0,0] op_sel_hi:[1,1,1]
v_pk_add_f32 v[60:61], v[60:61], 1.0 op_sel_hi:[1,0]
v_rcp_f32 v60, v60
v_rcp_f32_e64 v61, v61
s_waitcnt lgkmcnt(1)
v_pk_fma_f32 v[56:57], v[234:235], v[16:17], v[28:29] op_sel:[0,0,0] op_sel_hi:[0,1,1] neg_lo:[1,0,0] neg_hi:[1,0,0]
v_pk_mul_f32 v[60:61], v[60:61], v[62:63]
v_cvt_pk_bf16_f32 v65, v60, v61
v_pk_fma_f32 v[58:59], v[234:235], v[18:19], v[30:31] op_sel:[0,0,0] op_sel_hi:[0,1,1] neg_lo:[1,0,0] neg_hi:[1,0,0]
v_pk_fma_f32 v[56:57], v[232:233], v[88:89], v[56:57] op_sel:[0,0,0] op_sel_hi:[0,1,1]
v_exp_f32 v56, v56
v_exp_f32 v57, v57
v_pk_fma_f32 v[58:59], v[232:233], v[90:91], v[58:59] op_sel:[1,0,0] op_sel_hi:[1,1,1]
v_pk_add_f32 v[56:57], v[56:57], 1.0 op_sel_hi:[1,0]
v_rcp_f32 v56, v56
v_rcp_f32_e64 v57, v57
s_waitcnt lgkmcnt(0)
v_pk_fma_f32 v[60:61], v[238:239], v[16:17], v[28:29] op_sel:[0,0,0] op_sel_hi:[0,1,1] neg_lo:[1,0,0] neg_hi:[1,0,0]
v_pk_mul_f32 v[56:57], v[56:57], v[58:59]
v_cvt_pk_bf16_f32 v66, v56, v57
v_pk_fma_f32 v[62:63], v[238:239], v[18:19], v[30:31] op_sel:[0,0,0] op_sel_hi:[0,1,1] neg_lo:[1,0,0] neg_hi:[1,0,0]
v_pk_fma_f32 v[60:61], v[236:237], v[100:101], v[60:61] op_sel:[0,0,0] op_sel_hi:[0,1,1]
v_exp_f32 v60, v60
v_exp_f32 v61, v61
v_pk_fma_f32 v[62:63], v[236:237], v[102:103], v[62:63] op_sel:[1,0,0] op_sel_hi:[1,1,1]
v_pk_add_f32 v[60:61], v[60:61], 1.0 op_sel_hi:[1,0]
v_rcp_f32 v60, v60
v_rcp_f32 v61, v61
v_pk_fma_f32 v[56:57], v[226:227], v[20:21], v[32:33] op_sel:[0,0,0] op_sel_hi:[0,1,1] neg_lo:[1,0,0] neg_hi:[1,0,0]
v_pk_mul_f32 v[60:61], v[60:61], v[62:63]
v_permlane32_swap_b32_e64 v64, v66
v_cvt_pk_bf16_f32 v67, v60, v61
v_pk_fma_f32 v[58:59], v[226:227], v[22:23], v[34:35] op_sel:[0,0,0] op_sel_hi:[0,1,1] neg_lo:[1,0,0] neg_hi:[1,0,0]
v_pk_fma_f32 v[56:57], v[224:225], v[68:69], v[56:57] op_sel:[0,0,0] op_sel_hi:[0,1,1]
v_permlane32_swap_b32 v65, v67
v_exp_f32 v56, v56
v_exp_f32 v57, v57
v_permlane16_swap_b32 v64, v65
v_permlane16_swap_b32_e64 v66, v67
buffer_store_dwordx4 v[64:67], v8, s[4:7], s53 offen sc1
v_pk_fma_f32 v[58:59], v[224:225], v[70:71], v[58:59] op_sel:[1,0,0] op_sel_hi:[1,1,1]
v_pk_add_f32 v[56:57], v[56:57], 1.0 op_sel_hi:[1,0]
v_rcp_f32 v56, v56
v_rcp_f32 v57, v57
v_pk_fma_f32 v[60:61], v[230:231], v[20:21], v[32:33] op_sel:[0,0,0] op_sel_hi:[0,1,1] neg_lo:[1,0,0] neg_hi:[1,0,0]
v_pk_mul_f32 v[56:57], v[56:57], v[58:59]
v_cvt_pk_bf16_f32 v68, v56, v57
v_pk_fma_f32 v[62:63], v[230:231], v[22:23], v[34:35] op_sel:[0,0,0] op_sel_hi:[0,1,1] neg_lo:[1,0,0] neg_hi:[1,0,0]
v_pk_fma_f32 v[60:61], v[228:229], v[80:81], v[60:61] op_sel:[0,0,0] op_sel_hi:[0,1,1]
v_exp_f32 v60, v60
v_exp_f32 v61, v61
v_pk_fma_f32 v[62:63], v[228:229], v[82:83], v[62:63] op_sel:[1,0,0] op_sel_hi:[1,1,1]
v_pk_add_f32 v[60:61], v[60:61], 1.0 op_sel_hi:[1,0]
v_rcp_f32 v60, v60
v_rcp_f32 v61, v61
v_pk_fma_f32 v[56:57], v[234:235], v[20:21], v[32:33] op_sel:[0,0,0] op_sel_hi:[0,1,1] neg_lo:[1,0,0] neg_hi:[1,0,0]
v_pk_mul_f32 v[60:61], v[60:61], v[62:63]
v_cvt_pk_bf16_f32 v69, v60, v61
v_pk_fma_f32 v[58:59], v[234:235], v[22:23], v[34:35] op_sel:[0,0,0] op_sel_hi:[0,1,1] neg_lo:[1,0,0] neg_hi:[1,0,0]
v_pk_fma_f32 v[56:57], v[232:233], v[92:93], v[56:57] op_sel:[0,0,0] op_sel_hi:[0,1,1]
v_exp_f32 v56, v56
v_exp_f32 v57, v57
v_pk_fma_f32 v[58:59], v[232:233], v[94:95], v[58:59] op_sel:[1,0,0] op_sel_hi:[1,1,1]
v_pk_add_f32 v[56:57], v[56:57], 1.0 op_sel_hi:[1,0]
v_rcp_f32 v56, v56
v_rcp_f32 v57, v57
v_pk_fma_f32 v[60:61], v[238:239], v[20:21], v[32:33] op_sel:[0,0,0] op_sel_hi:[0,1,1] neg_lo:[1,0,0] neg_hi:[1,0,0]
v_pk_mul_f32 v[56:57], v[56:57], v[58:59]
v_cvt_pk_bf16_f32 v70, v56, v57
v_pk_fma_f32 v[62:63], v[238:239], v[22:23], v[34:35] op_sel:[0,0,0] op_sel_hi:[0,1,1] neg_lo:[1,0,0] neg_hi:[1,0,0]
v_pk_fma_f32 v[60:61], v[236:237], v[104:105], v[60:61] op_sel:[0,0,0] op_sel_hi:[0,1,1]
v_exp_f32 v60, v60
v_exp_f32 v61, v61
v_pk_fma_f32 v[62:63], v[236:237], v[106:107], v[62:63] op_sel:[1,0,0] op_sel_hi:[1,1,1]
v_pk_add_f32 v[60:61], v[60:61], 1.0 op_sel_hi:[1,0]
v_rcp_f32 v60, v60
v_rcp_f32 v61, v61
v_permlane32_swap_b32 v68, v70
v_pk_mul_f32 v[60:61], v[60:61], v[62:63]
v_cvt_pk_bf16_f32 v71, v60, v61
s_nop 1
v_permlane32_swap_b32 v69, v71
s_nop 1
v_permlane16_swap_b32_e64 v68, v69
v_permlane16_swap_b32_e64 v70, v71
buffer_store_dwordx4 v[68:71], v8, s[4:7], s93 offen sc1
v_mfma_f32_16x16x32_bf16 v[112:115], a[132:135], a[208:211], v[112:115]
ds_read_b64_tr_b16 a[196:197], v45 offset:32768
s_mul_i32 s86, s35, 360448
v_mfma_f32_16x16x32_bf16 v[116:119], a[136:139], a[208:211], v[116:119]
ds_read_b64_tr_b16 a[198:199], v45 offset:36864
s_lshl_b32 s87, s33, 10
v_mfma_f32_16x16x32_bf16 v[120:123], a[208:211], a[208:211], v[120:123]
buffer_load_dwordx4 v[216:219], v2, s[4:7], s85 offen offset:2048
v_mfma_f32_16x16x32_bf16 v[124:127], a[132:135], a[212:215], v[124:127]
ds_read_b64_tr_b16 a[200:201], v46 offset:32768
s_add_u32 s86, s86, s87
v_mfma_f32_16x16x32_bf16 v[128:131], a[136:139], a[212:215], v[128:131]
ds_read_b64_tr_b16 a[202:203], v46 offset:36864
s_add_u32 s86, s86, 10485760
v_mfma_f32_16x16x32_bf16 v[132:135], a[212:215], a[212:215], v[132:135]
buffer_load_dwordx4 v[220:223], v2, s[4:7], s85 offen offset:3072
v_mfma_f32_16x16x32_bf16 v[136:139], a[132:135], a[216:219], v[136:139]
ds_read_b64_tr_b16 a[204:205], v47 offset:32768
s_add_u32 s85, s85, 4096
v_mfma_f32_16x16x32_bf16 v[140:143], a[136:139], a[216:219], v[140:143]
ds_read_b64_tr_b16 a[206:207], v47 offset:36864
s_xor_b32 s87, s3, 0
v_mfma_f32_16x16x32_bf16 v[144:147], a[216:219], a[216:219], v[144:147]
buffer_load_dwordx4 a[0:3], v2, s[4:7], s85 offen offset:0
v_mfma_f32_16x16x32_bf16 v[148:151], a[132:135], a[220:223], v[148:151]
ds_read_b64_tr_b16 a[208:209], v44 offset:40960
s_mul_i32 s88, s87, 45056
v_mfma_f32_16x16x32_bf16 v[152:155], a[136:139], a[220:223], v[152:155]
ds_read_b64_tr_b16 a[210:211], v44 offset:45056
v_add_u32 v248, s88, v2
v_mfma_f32_16x16x32_bf16 v[156:159], a[220:223], a[220:223], v[156:159]
buffer_load_dwordx4 a[4:7], v2, s[4:7], s85 offen offset:1024
v_mfma_f32_16x16x32_bf16 v[112:115], a[144:147], a[192:195], v[112:115]
ds_read_b64_tr_b16 a[212:213], v45 offset:40960
s_xor_b32 s87, s3, 1
v_mfma_f32_16x16x32_bf16 v[116:119], a[148:151], a[192:195], v[116:119]
ds_read_b64_tr_b16 a[214:215], v45 offset:45056
s_waitcnt lgkmcnt(8)
v_mfma_f32_16x16x32_bf16 v[120:123], a[192:195], a[192:195], v[120:123]
buffer_load_dwordx4 a[8:11], v2, s[4:7], s85 offen offset:2048
v_mfma_f32_16x16x32_bf16 v[124:127], a[144:147], a[196:199], v[124:127]
ds_read_b64_tr_b16 a[216:217], v46 offset:40960
s_mul_i32 s88, s87, 45056
v_mfma_f32_16x16x32_bf16 v[128:131], a[148:151], a[196:199], v[128:131]
ds_read_b64_tr_b16 a[218:219], v46 offset:45056
s_waitcnt lgkmcnt(8)
v_mfma_f32_16x16x32_bf16 v[132:135], a[196:199], a[196:199], v[132:135]
buffer_load_dwordx4 a[12:15], v2, s[4:7], s85 offen offset:3072
v_mfma_f32_16x16x32_bf16 v[136:139], a[144:147], a[200:203], v[136:139]
ds_read_b64_tr_b16 a[220:221], v47 offset:40960
s_add_u32 s85, s85, 4096
v_mfma_f32_16x16x32_bf16 v[140:143], a[148:151], a[200:203], v[140:143]
ds_read_b64_tr_b16 a[222:223], v47 offset:45056
s_waitcnt lgkmcnt(8)
v_mfma_f32_16x16x32_bf16 v[144:147], a[200:203], a[200:203], v[144:147]
buffer_load_dwordx4 a[16:19], v2, s[4:7], s85 offen offset:0
v_mfma_f32_16x16x32_bf16 v[148:151], a[144:147], a[204:207], v[148:151]
ds_read_b64_tr_b16 a[192:193], v44 offset:49152
v_add_u32_e64 v249, s88, v2
v_mfma_f32_16x16x32_bf16 v[152:155], a[148:151], a[204:207], v[152:155]
ds_read_b64_tr_b16 a[194:195], v44 offset:53248
s_waitcnt lgkmcnt(8)
v_mfma_f32_16x16x32_bf16 v[156:159], a[204:207], a[204:207], v[156:159]
v_mov_b32 v250, 1073741824
v_mfma_f32_16x16x32_bf16 v[112:115], a[156:159], a[208:211], v[112:115]
ds_read_b64_tr_b16 a[196:197], v45 offset:49152
v_mfma_f32_16x16x32_bf16 v[116:119], a[160:163], a[208:211], v[116:119]
ds_read_b64_tr_b16 a[198:199], v45 offset:53248
s_waitcnt lgkmcnt(8)
v_mfma_f32_16x16x32_bf16 v[120:123], a[208:211], a[208:211], v[120:123]
buffer_load_dwordx4 a[20:23], v2, s[4:7], s85 offen offset:1024
v_mfma_f32_16x16x32_bf16 v[124:127], a[156:159], a[212:215], v[124:127]
ds_read_b64_tr_b16 a[200:201], v46 offset:49152
v_mfma_f32_16x16x32_bf16 v[128:131], a[160:163], a[212:215], v[128:131]
ds_read_b64_tr_b16 a[202:203], v46 offset:53248
s_waitcnt lgkmcnt(8)
v_mfma_f32_16x16x32_bf16 v[132:135], a[212:215], a[212:215], v[132:135]
buffer_load_dwordx4 a[24:27], v2, s[4:7], s85 offen offset:2048
v_mfma_f32_16x16x32_bf16 v[136:139], a[156:159], a[216:219], v[136:139]
ds_read_b64_tr_b16 a[204:205], v47 offset:49152
v_mfma_f32_16x16x32_bf16 v[140:143], a[160:163], a[216:219], v[140:143]
ds_read_b64_tr_b16 a[206:207], v47 offset:53248
s_waitcnt lgkmcnt(8)
v_mfma_f32_16x16x32_bf16 v[144:147], a[216:219], a[216:219], v[144:147]
buffer_load_dwordx4 a[28:31], v2, s[4:7], s85 offen offset:3072
v_mfma_f32_16x16x32_bf16 v[148:151], a[156:159], a[220:223], v[148:151]
ds_read_b64_tr_b16 a[208:209], v44 offset:57344
s_add_u32 s85, s85, 4096
v_mfma_f32_16x16x32_bf16 v[152:155], a[160:163], a[220:223], v[152:155]
ds_read_b64_tr_b16 a[210:211], v44 offset:61440
s_waitcnt lgkmcnt(8)
v_mfma_f32_16x16x32_bf16 v[156:159], a[220:223], a[220:223], v[156:159]
v_mfma_f32_16x16x32_bf16 v[112:115], a[168:171], a[192:195], v[112:115]
ds_read_b64_tr_b16 a[212:213], v45 offset:57344
v_mfma_f32_16x16x32_bf16 v[116:119], a[172:175], a[192:195], v[116:119]
ds_read_b64_tr_b16 a[214:215], v45 offset:61440
s_waitcnt lgkmcnt(8)
v_mfma_f32_16x16x32_bf16 v[120:123], a[192:195], a[192:195], v[120:123]
s_waitcnt vmcnt(10)
buffer_atomic_add v12, v9, s[4:7], s56 offen offset:12 sc1
L_pad_c_2:
s_cbranch_execz L_ret_c
v_mfma_f32_16x16x32_bf16 v[124:127], a[168:171], a[196:199], v[124:127]
ds_read_b64_tr_b16 a[216:217], v46 offset:57344
v_mfma_f32_16x16x32_bf16 v[128:131], a[172:175], a[196:199], v[128:131]
ds_read_b64_tr_b16 a[218:219], v46 offset:61440
s_waitcnt lgkmcnt(8)
v_mfma_f32_16x16x32_bf16 v[132:135], a[196:199], a[196:199], v[132:135]
buffer_load_dwordx4 a[32:35], v2, s[4:7], s85 offen offset:0
v_mfma_f32_16x16x32_bf16 v[136:139], a[168:171], a[200:203], v[136:139]
ds_read_b64_tr_b16 a[220:221], v47 offset:57344
v_mfma_f32_16x16x32_bf16 v[140:143], a[172:175], a[200:203], v[140:143]
ds_read_b64_tr_b16 a[222:223], v47 offset:61440
s_waitcnt lgkmcnt(8)
v_mfma_f32_16x16x32_bf16 v[144:147], a[200:203], a[200:203], v[144:147]
buffer_load_dwordx4 a[36:39], v2, s[4:7], s85 offen offset:1024
v_mfma_f32_16x16x32_bf16 v[148:151], a[168:171], a[204:207], v[148:151]
v_mfma_f32_16x16x32_bf16 v[152:155], a[172:175], a[204:207], v[152:155]
s_waitcnt lgkmcnt(6)
v_mfma_f32_16x16x32_bf16 v[156:159], a[204:207], a[204:207], v[156:159]
buffer_load_dwordx4 a[40:43], v2, s[4:7], s85 offen offset:2048
v_mfma_f32_16x16x32_bf16 v[112:115], a[180:183], a[208:211], v[112:115]
v_mfma_f32_16x16x32_bf16 v[116:119], a[184:187], a[208:211], v[116:119]
s_waitcnt lgkmcnt(4)
v_mfma_f32_16x16x32_bf16 v[120:123], a[208:211], a[208:211], v[120:123]
buffer_load_dwordx4 a[44:47], v2, s[4:7], s85 offen offset:3072
v_mfma_f32_16x16x32_bf16 v[124:127], a[180:183], a[212:215], v[124:127]
s_add_u32 s85, s85, 4096
v_mfma_f32_16x16x32_bf16 v[128:131], a[184:187], a[212:215], v[128:131]
s_waitcnt lgkmcnt(2)
v_mfma_f32_16x16x32_bf16 v[132:135], a[212:215], a[212:215], v[132:135]
v_mfma_f32_16x16x32_bf16 v[136:139], a[180:183], a[216:219], v[136:139]
s_nop 0
v_cndmask_b32 v120, 0, v120, s[40:41]
v_cndmask_b32 v120, v120, v121, s[42:43]
v_mfma_f32_16x16x32_bf16 v[140:143], a[184:187], a[216:219], v[140:143]
s_waitcnt lgkmcnt(0)
v_cndmask_b32 v120, v120, v122, s[44:45]
v_mfma_f32_16x16x32_bf16 v[144:147], a[216:219], a[216:219], v[144:147]
v_cndmask_b32 v120, v120, v123, s[46:47]
v_mov_b32_e64 v121, v116
v_mfma_f32_16x16x32_bf16 v[148:151], a[180:183], a[220:223], v[148:151]
v_cndmask_b32 v132, 0, v132, s[40:41]
v_cndmask_b32 v132, v132, v133, s[42:43]
v_mfma_f32_16x16x32_bf16 v[152:155], a[184:187], a[220:223], v[152:155]
v_cndmask_b32 v132, v132, v134, s[44:45]
v_cndmask_b32 v132, v132, v135, s[46:47]
v_mfma_f32_16x16x32_bf16 v[156:159], a[220:223], a[220:223], v[156:159]
v_mov_b32_e64 v133, v128
v_cndmask_b32 v144, 0, v144, s[40:41]
v_cndmask_b32 v144, v144, v145, s[42:43]
v_cndmask_b32 v144, v144, v146, s[44:45]
v_cndmask_b32 v144, v144, v147, s[46:47]
v_mov_b32 v145, v140
s_nop 1
v_cndmask_b32 v156, 0, v156, s[40:41]
v_cndmask_b32 v156, v156, v157, s[42:43]
v_cndmask_b32 v156, v156, v158, s[44:45]
v_cndmask_b32 v156, v156, v159, s[46:47]
v_mov_b32 v157, v152
v_permlane32_swap_b32 v120, v144
v_permlane32_swap_b32 v121, v145
v_permlane32_swap_b32 v132, v156
v_permlane32_swap_b32 v133, v157
v_add_f32 v120, v120, v144
v_add_f32 v132, v132, v156
v_permlane16_swap_b32 v145, v157
v_mov_b32 v59, 0x3727c5ac
v_permlane16_swap_b32 v120, v132
v_mul_f32 v157, s48, v157
v_add_f32_e64 v120, v120, v132
v_fma_f32 v120, v120, s49, v59
v_fma_f32 v120, -v157, v157, v120
v_max_f32 v120, v120, v59
v_rsq_f32 v57, v120
v_add_u32 v6, 132864, v2
v_mul_f32 v56, 0xbfb8aa3b, v57
v_mul_f32_e64 v58, v157, v57
ds_write_b128 v6, v[56:59] offset:1024
s_waitcnt lgkmcnt(0)
s_barrier
ds_read_b128 v[224:227], v7 offset:1024
ds_read_b128 v[228:231], v7 offset:1280
ds_read_b128 v[232:235], v7 offset:1536
ds_read_b128 v[236:239], v7 offset:1792
s_waitcnt lgkmcnt(3)
v_pk_fma_f32 v[56:57], v[226:227], v[16:17], v[28:29] op_sel:[0,0,0] op_sel_hi:[0,1,1] neg_lo:[1,0,0] neg_hi:[1,0,0]
v_pk_fma_f32 v[58:59], v[226:227], v[18:19], v[30:31] op_sel:[0,0,0] op_sel_hi:[0,1,1] neg_lo:[1,0,0] neg_hi:[1,0,0]
v_pk_fma_f32 v[56:57], v[224:225], v[112:113], v[56:57] op_sel:[0,0,0] op_sel_hi:[0,1,1]
v_exp_f32 v56, v56
v_exp_f32 v57, v57
v_pk_fma_f32 v[58:59], v[224:225], v[114:115], v[58:59] op_sel:[1,0,0] op_sel_hi:[1,1,1]
v_pk_add_f32 v[56:57], v[56:57], 1.0 op_sel_hi:[1,0]
v_rcp_f32 v56, v56
v_rcp_f32 v57, v57
s_waitcnt lgkmcnt(2)
v_pk_fma_f32 v[60:61], v[230:231], v[16:17], v[28:29] op_sel:[0,0,0] op_sel_hi:[0,1,1] neg_lo:[1,0,0] neg_hi:[1,0,0]
v_pk_mul_f32 v[56:57], v[56:57], v[58:59]
v_cvt_pk_bf16_f32 v112, v56, v57
v_pk_fma_f32 v[62:63], v[230:231], v[18:19], v[30:31] op_sel:[0,0,0] op_sel_hi:[0,1,1] neg_lo:[1,0,0] neg_hi:[1,0,0]
v_pk_fma_f32 v[60:61], v[228:229], v[124:125], v[60:61] op_sel:[0,0,0] op_sel_hi:[0,1,1]
v_exp_f32 v60, v60
v_exp_f32 v61, v61
v_pk_fma_f32 v[62:63], v[228:229], v[126:127], v[62:63] op_sel:[1,0,0] op_sel_hi:[1,1,1]
v_pk_add_f32 v[60:61], v[60:61], 1.0 op_sel_hi:[1,0]
v_rcp_f32 v60, v60
v_rcp_f32_e64 v61, v61
s_waitcnt lgkmcnt(1)
v_pk_fma_f32 v[56:57], v[234:235], v[16:17], v[28:29] op_sel:[0,0,0] op_sel_hi:[0,1,1] neg_lo:[1,0,0] neg_hi:[1,0,0]
v_pk_mul_f32 v[60:61], v[60:61], v[62:63]
v_cvt_pk_bf16_f32 v113, v60, v61
v_pk_fma_f32 v[58:59], v[234:235], v[18:19], v[30:31] op_sel:[0,0,0] op_sel_hi:[0,1,1] neg_lo:[1,0,0] neg_hi:[1,0,0]
v_pk_fma_f32 v[56:57], v[232:233], v[136:137], v[56:57] op_sel:[0,0,0] op_sel_hi:[0,1,1]
v_exp_f32 v56, v56
v_exp_f32 v57, v57
v_pk_fma_f32 v[58:59], v[232:233], v[138:139], v[58:59] op_sel:[1,0,0] op_sel_hi:[1,1,1]
v_pk_add_f32 v[56:57], v[56:57], 1.0 op_sel_hi:[1,0]
v_rcp_f32 v56, v56
v_rcp_f32_e64 v57, v57
s_waitcnt lgkmcnt(0)
v_pk_fma_f32 v[60:61], v[238:239], v[16:17], v[28:29] op_sel:[0,0,0] op_sel_hi:[0,1,1] neg_lo:[1,0,0] neg_hi:[1,0,0]
v_pk_mul_f32 v[56:57], v[56:57], v[58:59]
v_cvt_pk_bf16_f32 v114, v56, v57
v_pk_fma_f32 v[62:63], v[238:239], v[18:19], v[30:31] op_sel:[0,0,0] op_sel_hi:[0,1,1] neg_lo:[1,0,0] neg_hi:[1,0,0]
v_pk_fma_f32 v[60:61], v[236:237], v[148:149], v[60:61] op_sel:[0,0,0] op_sel_hi:[0,1,1]
v_exp_f32 v60, v60
v_exp_f32 v61, v61
v_pk_fma_f32 v[62:63], v[236:237], v[150:151], v[62:63] op_sel:[1,0,0] op_sel_hi:[1,1,1]
v_pk_add_f32 v[60:61], v[60:61], 1.0 op_sel_hi:[1,0]
v_rcp_f32 v60, v60
v_rcp_f32 v61, v61
v_pk_fma_f32 v[56:57], v[226:227], v[20:21], v[32:33] op_sel:[0,0,0] op_sel_hi:[0,1,1] neg_lo:[1,0,0] neg_hi:[1,0,0]
v_pk_mul_f32 v[60:61], v[60:61], v[62:63]
v_permlane32_swap_b32_e64 v112, v114
v_cvt_pk_bf16_f32 v115, v60, v61
v_pk_fma_f32 v[58:59], v[226:227], v[22:23], v[34:35] op_sel:[0,0,0] op_sel_hi:[0,1,1] neg_lo:[1,0,0] neg_hi:[1,0,0]
v_pk_fma_f32 v[56:57], v[224:225], v[116:117], v[56:57] op_sel:[0,0,0] op_sel_hi:[0,1,1]
v_permlane32_swap_b32 v113, v115
v_exp_f32 v56, v56
v_exp_f32 v57, v57
v_permlane16_swap_b32 v112, v113
v_permlane16_swap_b32_e64 v114, v115
buffer_store_dwordx4 v[112:115], v15, s[4:7], s53 offen sc1
v_pk_fma_f32 v[58:59], v[224:225], v[118:119], v[58:59] op_sel:[1,0,0] op_sel_hi:[1,1,1]
v_pk_add_f32 v[56:57], v[56:57], 1.0 op_sel_hi:[1,0]
v_rcp_f32 v56, v56
v_rcp_f32 v57, v57
v_pk_fma_f32 v[60:61], v[230:231], v[20:21], v[32:33] op_sel:[0,0,0] op_sel_hi:[0,1,1] neg_lo:[1,0,0] neg_hi:[1,0,0]
v_pk_mul_f32 v[56:57], v[56:57], v[58:59]
v_cvt_pk_bf16_f32 v116, v56, v57
v_pk_fma_f32 v[62:63], v[230:231], v[22:23], v[34:35] op_sel:[0,0,0] op_sel_hi:[0,1,1] neg_lo:[1,0,0] neg_hi:[1,0,0]
v_pk_fma_f32 v[60:61], v[228:229], v[128:129], v[60:61] op_sel:[0,0,0] op_sel_hi:[0,1,1]
v_exp_f32 v60, v60
v_exp_f32 v61, v61
v_pk_fma_f32 v[62:63], v[228:229], v[130:131], v[62:63] op_sel:[1,0,0] op_sel_hi:[1,1,1]
v_pk_add_f32 v[60:61], v[60:61], 1.0 op_sel_hi:[1,0]
v_rcp_f32 v60, v60
v_rcp_f32 v61, v61
v_pk_fma_f32 v[56:57], v[234:235], v[20:21], v[32:33] op_sel:[0,0,0] op_sel_hi:[0,1,1] neg_lo:[1,0,0] neg_hi:[1,0,0]
v_pk_mul_f32 v[60:61], v[60:61], v[62:63]
v_cvt_pk_bf16_f32 v117, v60, v61
v_pk_fma_f32 v[58:59], v[234:235], v[22:23], v[34:35] op_sel:[0,0,0] op_sel_hi:[0,1,1] neg_lo:[1,0,0] neg_hi:[1,0,0]
v_pk_fma_f32 v[56:57], v[232:233], v[140:141], v[56:57] op_sel:[0,0,0] op_sel_hi:[0,1,1]
v_exp_f32 v56, v56
v_exp_f32 v57, v57
v_pk_fma_f32 v[58:59], v[232:233], v[142:143], v[58:59] op_sel:[1,0,0] op_sel_hi:[1,1,1]
v_pk_add_f32 v[56:57], v[56:57], 1.0 op_sel_hi:[1,0]
v_rcp_f32 v56, v56
v_rcp_f32 v57, v57
v_pk_fma_f32 v[60:61], v[238:239], v[20:21], v[32:33] op_sel:[0,0,0] op_sel_hi:[0,1,1] neg_lo:[1,0,0] neg_hi:[1,0,0]
v_pk_mul_f32 v[56:57], v[56:57], v[58:59]
v_cvt_pk_bf16_f32 v118, v56, v57
v_pk_fma_f32 v[62:63], v[238:239], v[22:23], v[34:35] op_sel:[0,0,0] op_sel_hi:[0,1,1] neg_lo:[1,0,0] neg_hi:[1,0,0]
v_pk_fma_f32 v[60:61], v[236:237], v[152:153], v[60:61] op_sel:[0,0,0] op_sel_hi:[0,1,1]
v_exp_f32 v60, v60
v_exp_f32 v61, v61
v_pk_fma_f32 v[62:63], v[236:237], v[154:155], v[62:63] op_sel:[1,0,0] op_sel_hi:[1,1,1]
v_pk_add_f32 v[60:61], v[60:61], 1.0 op_sel_hi:[1,0]
v_rcp_f32 v60, v60
v_rcp_f32 v61, v61
v_permlane32_swap_b32 v116, v118
v_pk_mul_f32 v[60:61], v[60:61], v[62:63]
v_cvt_pk_bf16_f32 v119, v60, v61
s_nop 1
v_permlane32_swap_b32 v117, v119
s_nop 1
v_permlane16_swap_b32 v116, v117
v_permlane16_swap_b32 v118, v119
buffer_store_dwordx4 v[116:119], v15, s[4:7], s93 offen sc1
v_mov_b32_e64 v13, 0
buffer_atomic_add v13, v10, s[4:7], s55 offen offset:12 sc0 sc1
buffer_load_dwordx4 a[48:51], v2, s[4:7], s85 offen offset:0
buffer_load_dwordx4 a[52:55], v2, s[4:7], s85 offen offset:1024
buffer_load_dwordx4 a[56:59], v2, s[4:7], s85 offen offset:2048
buffer_load_dwordx4 a[60:63], v2, s[4:7], s85 offen offset:3072
s_add_u32 s85, s85, 4096
buffer_load_dwordx4 a[64:67], v2, s[4:7], s85 offen offset:0
buffer_load_dwordx4 a[68:71], v2, s[4:7], s85 offen offset:1024
buffer_load_dwordx4 a[72:75], v2, s[4:7], s85 offen offset:2048
buffer_load_dwordx4 a[76:79], v2, s[4:7], s85 offen offset:3072
s_add_u32 s85, s85, 4096
s_lshl_b32 s53, s35, 3
s_add_u32 s53, s53, s3
s_lshl_b32 s53, s53, 14
s_lshl_b32 s54, s62, 6
s_add_u32 s53, s53, s54
s_add_u32 s54, s53, 65536
s_xor_b32 s87, s33, 0
s_mul_i32 s88, s87, 6144
v_add_u32 v15, s88, v2
s_xor_b32 s87, s33, 1
s_mul_i32 s88, s87, 6144
v_add_u32 v58, s88, v2
s_xor_b32 s87, s33, 2
s_mul_i32 s88, s87, 6144
v_add_u32 v59, s88, v2
s_xor_b32 s87, s33, 3
s_mul_i32 s88, s87, 6144
v_add_u32 v60, s88, v2
s_lshl_b32 s87, s33, 11
s_add_u32 s87, s87, 49152
v_bfe_u32 v62, v3, 1, 2
v_xor_b32 v62, v62, v4
v_lshlrev_b32 v61, 6, v3
v_lshl_add_u32 v61, v62, 4, v61
v_add_u32_e64 v61, s87, v61
v_bfe_u32 v62, v1, 3, 2
v_xor_b32 v62, v62, v1
v_lshl_add_u32 v62, v62, 4, s87
v_lshrrev_b32 v7, 2, v1
v_lshlrev_b32 v7, 10, v7
v_and_b32 v6, 3, v1
v_lshl_add_u32 v7, v6, 4, v7
s_waitcnt vmcnt(9)
s_add_u32 s58, s56, 8192
buffer_atomic_add v12, v9, s[4:7], s58 offen offset:12 sc1
s_waitcnt vmcnt(9)
v_cmp_ne_u32 vcc, v14, v13
s_nop 1
s_cbranch_vccnz L_sp_s30_slow
L_sp_s30_ok:
s_barrier

L_g1_join:
L_pad_d_0:
s_cbranch_execz L_pad_d_1
buffer_load_dwordx4 a[80:83], v249, s[4:7], s86 offen
s_nop 0
buffer_load_dwordx4 a[84:87], v248, s[4:7], s86 offen
s_add_u32 s86, s86, 4096
buffer_load_dwordx4 a[88:91], v249, s[4:7], s86 offen
buffer_load_dwordx4 a[92:95], v248, s[4:7], s86 offen
s_add_u32 s86, s86, 4096
buffer_load_dwordx4 a[96:99], v249, s[4:7], s86 offen
buffer_load_dwordx4 a[100:103], v248, s[4:7], s86 offen
s_add_u32 s86, s86, 4096
buffer_load_dwordx4 a[104:107], v249, s[4:7], s86 offen
s_waitcnt vmcnt(8)
s_add_u32 s58, s56, 16384
s_nop 0
buffer_atomic_add v12, v9, s[4:7], s58 offen offset:12 sc1
buffer_load_dwordx4 a[108:111], v248, s[4:7], s86 offen
s_add_u32 s86, s86, 4096
buffer_load_dwordx4 a[112:115], v249, s[4:7], s86 offen
buffer_load_dwordx4 a[116:119], v248, s[4:7], s86 offen
s_add_u32 s86, s86, 4096
buffer_load_dwordx4 a[120:123], v249, s[4:7], s86 offen
buffer_load_dwordx4 a[124:127], v248, s[4:7], s86 offen
s_add_u32 s86, s86, 4096
buffer_load_dwordx4 a[128:131], v249, s[4:7], s86 offen
s_waitcnt vmcnt(13)
v_mfma_f32_16x16x32_bf16 v[88:91], a[232:235], a[80:83], 0
v_mov_b32_dpp v16, v11 row_newbcast:0 row_mask:0xf bank_mask:0xf
v_mfma_f32_16x16x32_bf16 v[92:95], a[236:239], a[80:83], 0
buffer_load_dwordx4 a[132:135], v248, s[4:7], s86 offen
v_mfma_f32_16x16x32_bf16 v[80:83], a[224:227], a[80:83], 0
v_mov_b32_e64 v13, 0
s_add_u32 s59, s55, 8192
buffer_atomic_add v13, v10, s[4:7], s59 offen offset:12 sc0 sc1
v_mfma_f32_16x16x32_bf16 v[84:87], a[228:231], a[80:83], 0
s_waitcnt vmcnt(14)
v_mov_b32_dpp v17, v11 row_newbcast:1 row_mask:0xf bank_mask:0xf
v_mfma_f32_16x16x32_bf16 v[72:75], a[232:235], a[84:87], 0
v_mov_b32_dpp v18, v11 row_newbcast:2 row_mask:0xf bank_mask:0xf
v_mfma_f32_16x16x32_bf16 v[76:79], a[236:239], a[84:87], 0
s_add_u32 s86, s86, 4096
buffer_load_dwordx4 a[136:139], v249, s[4:7], s86 offen
v_mfma_f32_16x16x32_bf16 v[64:67], a[224:227], a[84:87], 0
v_mov_b32_dpp v19, v11 row_newbcast:3 row_mask:0xf bank_mask:0xf
v_mfma_f32_16x16x32_bf16 v[68:71], a[228:231], a[84:87], 0
s_waitcnt vmcnt(14)
v_mov_b32_dpp v20, v11 row_newbcast:4 row_mask:0xf bank_mask:0xf
v_mfma_f32_16x16x32_bf16 v[88:91], a[248:251], a[88:91], v[88:91]
v_mov_b32_dpp v21, v11 row_newbcast:5 row_mask:0xf bank_mask:0xf
v_mfma_f32_16x16x32_bf16 v[92:95], a[252:255], a[88:91], v[92:95]
buffer_load_dwordx4 a[140:143], v248, s[4:7], s86 offen
v_mfma_f32_16x16x32_bf16 v[80:83], a[240:243], a[88:91], v[80:83]
v_mov_b32_dpp v22, v11 row_newbcast:6 row_mask:0xf bank_mask:0xf
v_mfma_f32_16x16x32_bf16 v[84:87], a[244:247], a[88:91], v[84:87]
s_waitcnt vmcnt(14)
v_mov_b32_dpp v23, v11 row_newbcast:7 row_mask:0xf bank_mask:0xf
v_mfma_f32_16x16x32_bf16 v[72:75], a[248:251], a[92:95], v[72:75]
v_lshlrev_b32_e64 v32, 16, v48
v_mfma_f32_16x16x32_bf16 v[76:79], a[252:255], a[92:95], v[76:79]
s_add_u32 s86, s86, 4096
buffer_load_dwordx4 a[144:147], v249, s[4:7], s86 offen
v_mfma_f32_16x16x32_bf16 v[64:67], a[240:243], a[92:95], v[64:67]
v_and_b32 v33, 0xffff0000, v48
v_mfma_f32_16x16x32_bf16 v[68:71], a[244:247], a[92:95], v[68:71]
s_waitcnt vmcnt(14)
v_lshlrev_b32 v34, 16, v49
v_mfma_f32_16x16x32_bf16 v[88:91], v[168:171], a[96:99], v[88:91]
v_and_b32 v35, 0xffff0000, v49
v_mfma_f32_16x16x32_bf16 v[92:95], v[172:175], a[96:99], v[92:95]
buffer_load_dwordx4 a[148:151], v248, s[4:7], s86 offen
v_mfma_f32_16x16x32_bf16 v[80:83], v[160:163], a[96:99], v[80:83]
v_lshlrev_b32 v36, 16, v50
v_mfma_f32_16x16x32_bf16 v[84:87], v[164:167], a[96:99], v[84:87]
s_waitcnt vmcnt(14)
v_and_b32 v37, 0xffff0000, v50
v_mfma_f32_16x16x32_bf16 v[72:75], v[168:171], a[100:103], v[72:75]
v_lshlrev_b32_e64 v38, 16, v51
v_mfma_f32_16x16x32_bf16 v[76:79], v[172:175], a[100:103], v[76:79]
s_add_u32 s86, s86, 4096
buffer_load_dwordx4 a[152:155], v249, s[4:7], s86 offen
v_mfma_f32_16x16x32_bf16 v[64:67], v[160:163], a[100:103], v[64:67]
v_and_b32 v39, 0xffff0000, v51
v_mfma_f32_16x16x32_bf16 v[68:71], v[164:167], a[100:103], v[68:71]
s_waitcnt vmcnt(14)
v_lshlrev_b32 v40, 16, v52
v_mfma_f32_16x16x32_bf16 v[88:91], v[184:187], a[104:107], v[88:91]
v_and_b32 v41, 0xffff0000, v52
v_mfma_f32_16x16x32_bf16 v[92:95], v[188:191], a[104:107], v[92:95]
buffer_load_dwordx4 a[156:159], v248, s[4:7], s86 offen
v_mfma_f32_16x16x32_bf16 v[80:83], v[176:179], a[104:107], v[80:83]
v_lshlrev_b32 v42, 16, v53
v_mfma_f32_16x16x32_bf16 v[84:87], v[180:183], a[104:107], v[84:87]
s_waitcnt vmcnt(13)
v_and_b32 v43, 0xffff0000, v53
v_mfma_f32_16x16x32_bf16 v[72:75], v[184:187], a[108:111], v[72:75]
v_lshlrev_b32_e64 v44, 16, v54
v_mfma_f32_16x16x32_bf16 v[76:79], v[188:191], a[108:111], v[76:79]
s_add_u32 s86, s86, 4096
buffer_load_dwordx4 a[160:163], v249, s[4:7], s86 offen
v_mfma_f32_16x16x32_bf16 v[64:67], v[176:179], a[108:111], v[64:67]
v_and_b32 v45, 0xffff0000, v54
v_mfma_f32_16x16x32_bf16 v[68:71], v[180:183], a[108:111], v[68:71]
s_waitcnt vmcnt(13)
v_lshlrev_b32 v46, 16, v55
v_mfma_f32_16x16x32_bf16 v[88:91], v[200:203], a[112:115], v[88:91]
v_and_b32 v47, 0xffff0000, v55
v_mfma_f32_16x16x32_bf16 v[92:95], v[204:207], a[112:115], v[92:95]
buffer_load_dwordx4 a[164:167], v248, s[4:7], s86 offen
v_mfma_f32_16x16x32_bf16 v[80:83], v[192:195], a[112:115], v[80:83]
v_mfma_f32_16x16x32_bf16 v[84:87], v[196:199], a[112:115], v[84:87]
s_waitcnt vmcnt(13)
v_mfma_f32_16x16x32_bf16 v[72:75], v[200:203], a[116:119], v[72:75]
v_mfma_f32_16x16x32_bf16 v[76:79], v[204:207], a[116:119], v[76:79]
v_mfma_f32_16x16x32_bf16 v[64:67], v[192:195], a[116:119], v[64:67]
v_mfma_f32_16x16x32_bf16 v[68:71], v[196:199], a[116:119], v[68:71]
s_waitcnt vmcnt(12)
v_mfma_f32_16x16x32_bf16 v[88:91], v[216:219], a[120:123], v[88:91]
v_mfma_f32_16x16x32_bf16 v[92:95], v[220:223], a[120:123], v[92:95]
v_mfma_f32_16x16x32_bf16 v[80:83], v[208:211], a[120:123], v[80:83]
v_mfma_f32_16x16x32_bf16 v[84:87], v[212:215], a[120:123], v[84:87]
s_waitcnt vmcnt(11)
v_mfma_f32_16x16x32_bf16 v[72:75], v[216:219], a[124:127], v[72:75]
s_waitcnt vmcnt(8)
v_cmp_ne_u32 vcc, v14, v13
s_nop 1
s_cbranch_vccnz L_sp_s31_slow
L_sp_s31_ok:
s_barrier
v_mfma_f32_16x16x32_bf16 v[76:79], v[220:223], a[124:127], v[76:79]
s_add_u32 s86, s86, 139264
buffer_load_dwordx4 a[168:171], v249, s[4:7], s86 offen
v_mfma_f32_16x16x32_bf16 v[64:67], v[208:211], a[124:127], v[64:67]
v_mfma_f32_16x16x32_bf16 v[68:71], v[212:215], a[124:127], v[68:71]
buffer_load_dwordx4 a[172:175], v248, s[4:7], s86 offen
v_mfma_f32_16x16x32_bf16 v[88:91], a[8:11], a[128:131], v[88:91]
v_mfma_f32_16x16x32_bf16 v[92:95], a[12:15], a[128:131], v[92:95]
s_add_u32 s86, s86, 4096
buffer_load_dwordx4 a[176:179], v249, s[4:7], s86 offen
v_mfma_f32_16x16x32_bf16 v[80:83], a[0:3], a[128:131], v[80:83]
v_mov_b32_e64 v13, 0
s_add_u32 s59, s55, 16384
buffer_atomic_add v13, v10, s[4:7], s59 offen offset:12 sc0 sc1
v_mfma_f32_16x16x32_bf16 v[84:87], a[4:7], a[128:131], v[84:87]
buffer_load_dwordx4 a[180:183], v248, s[4:7], s86 offen
v_mfma_f32_16x16x32_bf16 v[72:75], a[8:11], a[132:135], v[72:75]
v_mfma_f32_16x16x32_bf16 v[76:79], a[12:15], a[132:135], v[76:79]
s_add_u32 s86, s86, 4096
buffer_load_dwordx4 a[184:187], v249, s[4:7], s86 offen
v_mfma_f32_16x16x32_bf16 v[64:67], a[0:3], a[132:135], v[64:67]
v_mfma_f32_16x16x32_bf16 v[68:71], a[4:7], a[132:135], v[68:71]
s_waitcnt vmcnt(13)
v_mfma_f32_16x16x32_bf16 v[88:91], a[24:27], a[136:139], v[88:91]
v_mfma_f32_16x16x32_bf16 v[92:95], a[28:31], a[136:139], v[92:95]
buffer_load_dwordx4 a[188:191], v248, s[4:7], s86 offen
v_mfma_f32_16x16x32_bf16 v[80:83], a[16:19], a[136:139], v[80:83]
v_mfma_f32_16x16x32_bf16 v[84:87], a[20:23], a[136:139], v[84:87]
s_waitcnt vmcnt(13)
v_mfma_f32_16x16x32_bf16 v[72:75], a[24:27], a[140:143], v[72:75]
v_mfma_f32_16x16x32_bf16 v[76:79], a[28:31], a[140:143], v[76:79]
s_add_u32 s86, s86, 4096
buffer_load_dwordx4 a[192:195], v249, s[4:7], s86 offen
v_mfma_f32_16x16x32_bf16 v[64:67], a[16:19], a[140:143], v[64:67]
v_mfma_f32_16x16x32_bf16 v[68:71], a[20:23], a[140:143], v[68:71]
s_waitcnt vmcnt(13)
v_mfma_f32_16x16x32_bf16 v[88:91], a[40:43], a[144:147], v[88:91]
v_mfma_f32_16x16x32_bf16 v[92:95], a[44:47], a[144:147], v[92:95]
buffer_load_dwordx4 a[196:199], v248, s[4:7], s86 offen
v_mfma_f32_16x16x32_bf16 v[80:83], a[32:35], a[144:147], v[80:83]
v_mfma_f32_16x16x32_bf16 v[84:87], a[36:39], a[144:147], v[84:87]
s_waitcnt vmcnt(13)
v_mfma_f32_16x16x32_bf16 v[72:75], a[40:43], a[148:151], v[72:75]
v_mfma_f32_16x16x32_bf16 v[76:79], a[44:47], a[148:151], v[76:79]
s_add_u32 s86, s86, 4096
buffer_load_dwordx4 a[200:203], v249, s[4:7], s86 offen
v_mfma_f32_16x16x32_bf16 v[64:67], a[32:35], a[148:151], v[64:67]
v_mfma_f32_16x16x32_bf16 v[68:71], a[36:39], a[148:151], v[68:71]
s_waitcnt vmcnt(13)
v_mfma_f32_16x16x32_bf16 v[88:91], a[56:59], a[152:155], v[88:91]
v_mfma_f32_16x16x32_bf16 v[92:95], a[60:63], a[152:155], v[92:95]
buffer_load_dwordx4 a[204:207], v248, s[4:7], s86 offen
v_mfma_f32_16x16x32_bf16 v[80:83], a[48:51], a[152:155], v[80:83]
v_mfma_f32_16x16x32_bf16 v[84:87], a[52:55], a[152:155], v[84:87]
s_waitcnt vmcnt(13)
v_mfma_f32_16x16x32_bf16 v[72:75], a[56:59], a[156:159], v[72:75]
v_mfma_f32_16x16x32_bf16 v[76:79], a[60:63], a[156:159], v[76:79]
s_add_u32 s86, s86, 4096
buffer_load_dwordx4 a[208:211], v249, s[4:7], s86 offen
v_mfma_f32_16x16x32_bf16 v[64:67], a[48:51], a[156:159], v[64:67]
v_mfma_f32_16x16x32_bf16 v[68:71], a[52:55], a[156:159], v[68:71]
s_waitcnt vmcnt(13)
v_mfma_f32_16x16x32_bf16 v[88:91], a[72:75], a[160:163], v[88:91]
v_mfma_f32_16x16x32_bf16 v[92:95], a[76:79], a[160:163], v[92:95]
buffer_load_dwordx4 a[212:215], v248, s[4:7], s86 offen
v_mfma_f32_16x16x32_bf16 v[80:83], a[64:67], a[160:163], v[80:83]
v_mfma_f32_16x16x32_bf16 v[84:87], a[68:71], a[160:163], v[84:87]
s_waitcnt vmcnt(13)
v_mfma_f32_16x16x32_bf16 v[72:75], a[72:75], a[164:167], v[72:75]
v_mfma_f32_16x16x32_bf16 v[76:79], a[76:79], a[164:167], v[76:79]
s_add_u32 s86, s86, 4096
buffer_load_dwordx4 a[216:219], v249, s[4:7], s86 offen
v_mfma_f32_16x16x32_bf16 v[64:67], a[64:67], a[164:167], v[64:67]
ds_write_b128 v60, v[88:91] offset:4096
v_mfma_f32_16x16x32_bf16 v[68:71], a[68:71], a[164:167], v[68:71]
s_waitcnt vmcnt(13)
v_mfma_f32_16x16x32_bf16 v[120:123], a[232:235], a[168:171], 0
ds_write_b128 v60, v[92:95] offset:5120
v_mfma_f32_16x16x32_bf16 v[124:127], a[236:239], a[168:171], 0
buffer_load_dwordx4 a[220:223], v248, s[4:7], s86 offen
v_mfma_f32_16x16x32_bf16 v[112:115], a[224:227], a[168:171], 0
ds_write_b128 v59, v[80:83] offset:2048
v_mfma_f32_16x16x32_bf16 v[116:119], a[228:231], a[168:171], 0
s_waitcnt vmcnt(13)
v_mfma_f32_16x16x32_bf16 v[104:107], a[232:235], a[172:175], 0
s_waitcnt vmcnt(11)
v_cmp_ne_u32_e64 vcc, v14, v13
s_nop 1
s_cbranch_vccnz L_sp_s32_slow
L_sp_s32_ok:
s_barrier
v_mfma_f32_16x16x32_bf16 v[108:111], a[236:239], a[172:175], 0
s_add_u32 s86, s86, 4096
buffer_load_dwordx4 v[128:131], v249, s[4:7], s86 offen
v_mfma_f32_16x16x32_bf16 v[96:99], a[224:227], a[172:175], 0
ds_write_b128 v59, v[84:87] offset:3072
v_mfma_f32_16x16x32_bf16 v[100:103], a[228:231], a[172:175], 0
buffer_load_dwordx4 v[132:135], v248, s[4:7], s86 offen
v_mfma_f32_16x16x32_bf16 v[120:123], a[248:251], a[176:179], v[120:123]
ds_write_b128 v58, v[72:75] offset:0
v_mfma_f32_16x16x32_bf16 v[124:127], a[252:255], a[176:179], v[124:127]
s_add_u32 s86, s86, 4096
buffer_load_dwordx4 v[136:139], v249, s[4:7], s86 offen
v_mfma_f32_16x16x32_bf16 v[112:115], a[240:243], a[176:179], v[112:115]
ds_write_b128 v58, v[76:79] offset:1024
v_mfma_f32_16x16x32_bf16 v[116:119], a[244:247], a[176:179], v[116:119]
buffer_load_dwordx4 v[140:143], v248, s[4:7], s86 offen
s_waitcnt vmcnt(14)
v_mfma_f32_16x16x32_bf16 v[104:107], a[248:251], a[180:183], v[104:107]
v_mfma_f32_16x16x32_bf16 v[108:111], a[252:255], a[180:183], v[108:111]
s_add_u32 s86, s86, 4096
buffer_load_dwordx4 v[144:147], v249, s[4:7], s86 offen
v_mfma_f32_16x16x32_bf16 v[96:99], a[240:243], a[180:183], v[96:99]
s_waitcnt lgkmcnt(0)
s_barrier
v_mfma_f32_16x16x32_bf16 v[100:103], a[244:247], a[180:183], v[100:103]
s_waitcnt vmcnt(14)
ds_read_b128 v[224:227], v15 offset:0
ds_read_b128 v[228:231], v15 offset:2048
v_mfma_f32_16x16x32_bf16 v[120:123], v[168:171], a[184:187], v[120:123]
ds_read_b128 v[232:235], v15 offset:4096
ds_read_b128 v[236:239], v15 offset:1024
v_mfma_f32_16x16x32_bf16 v[124:127], v[172:175], a[184:187], v[124:127]
buffer_load_dwordx4 v[148:151], v248, s[4:7], s86 offen
v_mfma_f32_16x16x32_bf16 v[112:115], v[160:163], a[184:187], v[112:115]
ds_read_b128 v[240:243], v15 offset:3072
ds_read_b128 v[244:247], v15 offset:5120
v_mfma_f32_16x16x32_bf16 v[116:119], v[164:167], a[184:187], v[116:119]
s_waitcnt vmcnt(14)
v_mfma_f32_16x16x32_bf16 v[104:107], v[168:171], a[188:191], v[104:107]
v_mfma_f32_16x16x32_bf16 v[108:111], v[172:175], a[188:191], v[108:111]
s_add_u32 s86, s86, 4096
buffer_load_dwordx4 v[152:155], v249, s[4:7], s86 offen
s_waitcnt vmcnt(14)
v_mfma_f32_16x16x32_bf16 v[120:123], v[184:187], a[192:195], v[120:123]
v_mfma_f32_16x16x32_bf16 v[124:127], v[188:191], a[192:195], v[124:127]
v_mfma_f32_16x16x32_bf16 v[112:115], v[176:179], a[192:195], v[112:115]
v_mfma_f32_16x16x32_bf16 v[116:119], v[180:183], a[192:195], v[116:119]
buffer_load_dwordx4 v[156:159], v248, s[4:7], s86 offen
s_waitcnt vmcnt(14)
v_mfma_f32_16x16x32_bf16 v[104:107], v[184:187], a[196:199], v[104:107]
s_waitcnt lgkmcnt(3)
v_pk_add_f32 v[64:65], v[64:65], v[224:225]
v_pk_add_f32 v[228:229], v[228:229], v[232:233]
v_pk_add_f32 v[66:67], v[66:67], v[226:227]
v_pk_add_f32 v[230:231], v[230:231], v[234:235]
v_pk_add_f32 v[64:65], v[64:65], v[228:229]
v_pk_add_f32 v[66:67], v[66:67], v[230:231]
s_waitcnt lgkmcnt(0)
v_pk_add_f32 v[68:69], v[68:69], v[236:237]
v_pk_add_f32 v[240:241], v[240:241], v[244:245]
s_nop 0
v_pk_add_f32 v[70:71], v[70:71], v[238:239]
v_pk_add_f32 v[242:243], v[242:243], v[246:247]
v_pk_add_f32 v[68:69], v[68:69], v[240:241]
v_pk_add_f32 v[70:71], v[70:71], v[242:243]
v_pk_fma_f32 v[32:33], v[64:65], v[16:17], v[32:33]
v_pk_fma_f32 v[34:35], v[66:67], v[18:19], v[34:35]
v_pk_fma_f32 v[36:37], v[68:69], v[20:21], v[36:37]
v_pk_fma_f32 v[38:39], v[70:71], v[22:23], v[38:39]
v_cvt_pk_bf16_f32 v24, v32, v33
v_cvt_pk_bf16_f32 v25, v34, v35
v_cvt_pk_bf16_f32 v26, v36, v37
v_cvt_pk_bf16_f32 v27, v38, v39
ds_write_b128 v61, v[24:27] offset:0
ds_read_b128 v[48:51], v62 offset:0
v_mfma_f32_16x16x32_bf16 v[108:111], v[188:191], a[196:199], v[108:111]
s_waitcnt vmcnt(13)
v_mfma_f32_16x16x32_bf16 v[120:123], v[200:203], a[200:203], v[120:123]
v_mfma_f32_16x16x32_bf16 v[124:127], v[204:207], a[200:203], v[124:127]
v_mfma_f32_16x16x32_bf16 v[112:115], v[192:195], a[200:203], v[112:115]
v_mfma_f32_16x16x32_bf16 v[116:119], v[196:199], a[200:203], v[116:119]
s_waitcnt vmcnt(12)
v_mfma_f32_16x16x32_bf16 v[104:107], v[200:203], a[204:207], v[104:107]
v_mfma_f32_16x16x32_bf16 v[108:111], v[204:207], a[204:207], v[108:111]
s_waitcnt vmcnt(11)
v_mfma_f32_16x16x32_bf16 v[120:123], v[216:219], a[208:211], v[120:123]
s_waitcnt lgkmcnt(0)
buffer_store_dwordx4 v[48:51], v7, s[28:31], s53 offen sc1
v_mfma_f32_16x16x32_bf16 v[124:127], v[220:223], a[208:211], v[124:127]
v_mfma_f32_16x16x32_bf16 v[112:115], v[208:211], a[208:211], v[112:115]
v_mfma_f32_16x16x32_bf16 v[116:119], v[212:215], a[208:211], v[116:119]
s_waitcnt vmcnt(11)
v_mfma_f32_16x16x32_bf16 v[104:107], v[216:219], a[212:215], v[104:107]
v_mfma_f32_16x16x32_bf16 v[108:111], v[220:223], a[212:215], v[108:111]
s_waitcnt vmcnt(10)
v_mfma_f32_16x16x32_bf16 v[120:123], a[8:11], a[216:219], v[120:123]
v_mfma_f32_16x16x32_bf16 v[124:127], a[12:15], a[216:219], v[124:127]
v_mfma_f32_16x16x32_bf16 v[112:115], a[0:3], a[216:219], v[112:115]
v_mfma_f32_16x16x32_bf16 v[116:119], a[4:7], a[216:219], v[116:119]
s_waitcnt vmcnt(9)
v_mfma_f32_16x16x32_bf16 v[104:107], a[8:11], a[220:223], v[104:107]
v_mfma_f32_16x16x32_bf16 v[108:111], a[12:15], a[220:223], v[108:111]
s_waitcnt vmcnt(8)
v_mfma_f32_16x16x32_bf16 v[120:123], a[24:27], v[128:131], v[120:123]
v_mfma_f32_16x16x32_bf16 v[124:127], a[28:31], v[128:131], v[124:127]
v_mfma_f32_16x16x32_bf16 v[112:115], a[16:19], v[128:131], v[112:115]
v_mfma_f32_16x16x32_bf16 v[116:119], a[20:23], v[128:131], v[116:119]
s_waitcnt vmcnt(7)
v_mfma_f32_16x16x32_bf16 v[104:107], a[24:27], v[132:135], v[104:107]
v_mfma_f32_16x16x32_bf16 v[108:111], a[28:31], v[132:135], v[108:111]
s_waitcnt vmcnt(6)
v_mfma_f32_16x16x32_bf16 v[120:123], a[40:43], v[136:139], v[120:123]
v_mfma_f32_16x16x32_bf16 v[124:127], a[44:47], v[136:139], v[124:127]
v_mfma_f32_16x16x32_bf16 v[112:115], a[32:35], v[136:139], v[112:115]
v_mfma_f32_16x16x32_bf16 v[116:119], a[36:39], v[136:139], v[116:119]
s_waitcnt vmcnt(5)
v_mfma_f32_16x16x32_bf16 v[104:107], a[40:43], v[140:143], v[104:107]
v_mfma_f32_16x16x32_bf16 v[108:111], a[44:47], v[140:143], v[108:111]
s_waitcnt vmcnt(4)
v_mfma_f32_16x16x32_bf16 v[120:123], a[56:59], v[144:147], v[120:123]
v_mfma_f32_16x16x32_bf16 v[124:127], a[60:63], v[144:147], v[124:127]
v_mfma_f32_16x16x32_bf16 v[112:115], a[48:51], v[144:147], v[112:115]
v_mfma_f32_16x16x32_bf16 v[116:119], a[52:55], v[144:147], v[116:119]
s_waitcnt vmcnt(3)
v_mfma_f32_16x16x32_bf16 v[104:107], a[56:59], v[148:151], v[104:107]
v_mfma_f32_16x16x32_bf16 v[108:111], a[60:63], v[148:151], v[108:111]
s_waitcnt vmcnt(2)
v_mfma_f32_16x16x32_bf16 v[120:123], a[72:75], v[152:155], v[120:123]
v_mfma_f32_16x16x32_bf16 v[124:127], a[76:79], v[152:155], v[124:127]
v_mfma_f32_16x16x32_bf16 v[112:115], a[64:67], v[152:155], v[112:115]
v_mfma_f32_16x16x32_bf16 v[116:119], a[68:71], v[152:155], v[116:119]
s_waitcnt vmcnt(1)
v_mfma_f32_16x16x32_bf16 v[104:107], a[72:75], v[156:159], v[104:107]
v_mfma_f32_16x16x32_bf16 v[108:111], a[76:79], v[156:159], v[108:111]
L_pad_d_1:
s_cbranch_execz L_ret_d
v_mfma_f32_16x16x32_bf16 v[96:99], v[160:163], a[188:191], v[96:99]
s_nop 0
s_nop 0
ds_write_b128 v60, v[120:123] offset:28672
v_mfma_f32_16x16x32_bf16 v[100:103], v[164:167], a[188:191], v[100:103]
v_mfma_f32_16x16x32_bf16 v[96:99], v[176:179], a[196:199], v[96:99]
ds_write_b128 v60, v[124:127] offset:29696
v_mfma_f32_16x16x32_bf16 v[100:103], v[180:183], a[196:199], v[100:103]
v_mfma_f32_16x16x32_bf16 v[96:99], v[192:195], a[204:207], v[96:99]
ds_write_b128 v59, v[112:115] offset:26624
v_mfma_f32_16x16x32_bf16 v[100:103], v[196:199], a[204:207], v[100:103]
v_mfma_f32_16x16x32_bf16 v[96:99], v[208:211], a[212:215], v[96:99]
ds_write_b128 v59, v[116:119] offset:27648
v_mfma_f32_16x16x32_bf16 v[100:103], v[212:215], a[212:215], v[100:103]
v_mfma_f32_16x16x32_bf16 v[96:99], a[0:3], a[220:223], v[96:99]
ds_write_b128 v58, v[104:107] offset:24576
v_mfma_f32_16x16x32_bf16 v[100:103], a[4:7], a[220:223], v[100:103]
v_mfma_f32_16x16x32_bf16 v[96:99], a[16:19], v[132:135], v[96:99]
ds_write_b128 v58, v[108:111] offset:25600
v_mfma_f32_16x16x32_bf16 v[100:103], a[20:23], v[132:135], v[100:103]
v_mfma_f32_16x16x32_bf16 v[96:99], a[32:35], v[140:143], v[96:99]
v_mfma_f32_16x16x32_bf16 v[100:103], a[36:39], v[140:143], v[100:103]
s_waitcnt lgkmcnt(0)
s_barrier
v_mfma_f32_16x16x32_bf16 v[96:99], a[48:51], v[148:151], v[96:99]
ds_read_b128 v[224:227], v15 offset:24576
ds_read_b128 v[228:231], v15 offset:26624
v_mfma_f32_16x16x32_bf16 v[100:103], a[52:55], v[148:151], v[100:103]
ds_read_b128 v[232:235], v15 offset:28672
ds_read_b128 v[236:239], v15 offset:25600
v_mfma_f32_16x16x32_bf16 v[96:99], a[64:67], v[156:159], v[96:99]
ds_read_b128 v[240:243], v15 offset:27648
ds_read_b128 v[244:247], v15 offset:29696
v_mfma_f32_16x16x32_bf16 v[100:103], a[68:71], v[156:159], v[100:103]
s_waitcnt lgkmcnt(3)
s_nop 3
v_pk_add_f32 v[96:97], v[96:97], v[224:225]
v_pk_add_f32 v[228:229], v[228:229], v[232:233]
v_pk_add_f32 v[98:99], v[98:99], v[226:227]
v_pk_add_f32 v[230:231], v[230:231], v[234:235]
v_pk_add_f32 v[96:97], v[96:97], v[228:229]
v_pk_add_f32 v[98:99], v[98:99], v[230:231]
s_waitcnt lgkmcnt(0)
v_pk_add_f32 v[100:101], v[100:101], v[236:237]
v_pk_add_f32 v[240:241], v[240:241], v[244:245]
s_nop 0
v_pk_add_f32 v[102:103], v[102:103], v[238:239]
v_pk_add_f32 v[242:243], v[242:243], v[246:247]
v_pk_add_f32 v[100:101], v[100:101], v[240:241]
v_pk_add_f32 v[102:103], v[102:103], v[242:243]
v_pk_fma_f32 v[40:41], v[96:97], v[16:17], v[40:41]
v_pk_fma_f32 v[42:43], v[98:99], v[18:19], v[42:43]
v_pk_fma_f32 v[44:45], v[100:101], v[20:21], v[44:45]
v_pk_fma_f32 v[46:47], v[102:103], v[22:23], v[46:47]
v_cvt_pk_bf16_f32 v24, v40, v41
v_cvt_pk_bf16_f32 v25, v42, v43
v_cvt_pk_bf16_f32 v26, v44, v45
v_cvt_pk_bf16_f32 v27, v46, v47
ds_write_b128 v61, v[24:27] offset:1024
ds_read_b128 v[52:55], v62 offset:1024
s_waitcnt lgkmcnt(0)
buffer_store_dwordx4 v[52:55], v7, s[28:31], s54 offen sc1

s_endpgm
L_end:
s_endpgm
L_sp_w_slow:
s_mov_b32 s70, 0
L_sp_w:
v_mov_b32 v234, 0
buffer_atomic_add v234, v232, s[4:7], s95 offen offset:12 sc0 sc1
s_waitcnt vmcnt(0)
v_cmp_ne_u32 vcc, v236, v234
s_nop 4
s_cbranch_vccz L_sp_w_ok
s_add_u32 s70, s70, 1
s_cmp_lt_u32 s70, 2097152
s_cbranch_scc1 L_sp_w
s_branch L_sp_w_ok
L_sp_s2b_slow:
s_mov_b32 s70, 0
L_sp_s2b:
v_mov_b32 v53, 0
buffer_atomic_add v53, v54, s[4:7], s79 offen offset:16 sc0 sc1
s_waitcnt vmcnt(0)
v_cmp_ne_u32 vcc, v52, v53
s_nop 4
s_cbranch_vccz L_sp_s2b_ok
s_add_u32 s70, s70, 1
s_cmp_lt_u32 s70, 2097152
s_cbranch_scc1 L_sp_s2b
s_branch L_sp_s2b_ok
L_sp_s30_slow:
s_mov_b32 s70, 0
L_sp_s30:
v_mov_b32 v13, 0
buffer_atomic_add v13, v10, s[4:7], s55 offen offset:12 sc0 sc1
s_waitcnt vmcnt(0)
v_cmp_ne_u32 vcc, v14, v13
s_nop 4
s_cbranch_vccz L_sp_s30_ok
s_add_u32 s70, s70, 1
s_cmp_lt_u32 s70, 2097152
s_cbranch_scc1 L_sp_s30
s_branch L_sp_s30_ok
s_nop 0
L_sp_s31_slow:
s_mov_b32 s70, 0
L_sp_s31:
v_mov_b32 v13, 0
buffer_atomic_add v13, v10, s[4:7], s59 offen offset:12 sc0 sc1
s_waitcnt vmcnt(0)
v_cmp_ne_u32 vcc, v14, v13
s_nop 4
s_cbranch_vccz L_sp_s31_ok
s_add_u32 s70, s70, 1
s_cmp_lt_u32 s70, 2097152
s_cbranch_scc1 L_sp_s31
s_branch L_sp_s31_ok
L_sp_s32_slow:
s_mov_b32 s70, 0
L_sp_s32:
v_mov_b32 v13, 0
buffer_atomic_add v13, v10, s[4:7], s59 offen offset:12 sc0 sc1
s_waitcnt vmcnt(0)
v_cmp_ne_u32 vcc, v14, v13
s_nop 4
s_cbranch_vccz L_sp_s32_ok
s_add_u32 s70, s70, 1
s_cmp_lt_u32 s70, 2097152
s_cbranch_scc1 L_sp_s32
s_branch L_sp_s32_ok
L_last:
s_endpgm
.section .rodata,"a"
.p2align 6
.amdhsa_kernel adaLN_cond__ssm_conv_s4d__glu_gated_glu__prompt_kernel
  .amdhsa_next_free_vgpr 512
  .amdhsa_next_free_sgpr 102
  .amdhsa_accum_offset 256
  .amdhsa_group_segment_fixed_size 0
  .amdhsa_kernarg_size 128
  .amdhsa_user_sgpr_count 2
  .amdhsa_user_sgpr_kernarg_segment_ptr 1
  .amdhsa_system_sgpr_workgroup_id_x 1
  .amdhsa_float_denorm_mode_32 3
  .amdhsa_float_denorm_mode_16_64 3
.end_amdhsa_kernel
```
